```python
import torch

def _softmax(x, axis=-1):
    return torch.softmax(x, dim=axis)

def _gelu(x):
    return torch.nn.functional.gelu(x, approximate='tanh')

def _silu(x):
    return torch.nn.functional.silu(x)

def _sigmoid(x):
    return torch.sigmoid(x)

def _layernorm(x, axis=-1, eps=1e-05):
    m = x.mean(dim=axis, keepdim=True)
    v = x.var(dim=axis, keepdim=True, unbiased=False)
    return (x - m) / torch.sqrt(v + eps)

def _scatter_add(tgt, idx, src, axis=0):
    return tgt.clone().index_add_(axis, idx, src)

def _segment_sum(src, seg, n):
    out = torch.zeros((n,) + src.shape[1:], dtype=src.dtype)
    return out.index_add_(0, seg, src)

def _pad(x, pw):
    flat = tuple((v for pair in reversed(pw) for v in pair))
    return torch.nn.functional.pad(x, flat)
kernel_name = 'adaLN_cond__softmax_full_mha__mixer_gmlp__prompt'

def setup_inputs():

    _w = lambda a: (lambda t: t.to(torch.bfloat16) if t.is_floating_point() else t)(torch.as_tensor(a))

    def _A_setup():
        B, S, D = (1, 2048, 1024)
        return {'x': _w((lambda *s: torch.randn(*s, dtype=torch.bfloat16) * 0.05)(B, S, D)), 'wqkv': _w((lambda *s: torch.randn(*s, dtype=torch.bfloat16) * 0.05)(D, 3 * D)), 'wo': _w((lambda *s: torch.randn(*s, dtype=torch.bfloat16) * 0.05)(D, D))}
    _A_in = _A_setup()

    def _B_setup():
        B, S, D, F = (1, 2048, 1024, 3584)
        Fh = F // 2
        return {'x': _w((lambda *s: torch.randn(*s, dtype=torch.bfloat16) * 0.05)(B, S, D)), 'w_in': _w((lambda *s: torch.randn(*s, dtype=torch.bfloat16) * 0.8)(D, 2 * Fh)), 'w_sp': _w(0.01 * (lambda *s: torch.randn(*s, dtype=torch.bfloat16) * 0.8)(S, S)), 'b_sp': _w(1.0 + 0.01 * (lambda *s: torch.randn(*s, dtype=torch.bfloat16) * 0.05)(S)), 'w_out': _w((lambda *s: torch.randn(*s, dtype=torch.bfloat16) * 0.05)(Fh, D))}
    _B_in = _B_setup()
    return {'A_x': _A_in['x'], 'A_wqkv': _A_in['wqkv'], 'A_wo': _A_in['wo'], 'B_x': _B_in['x'], 'B_w_in': _B_in['w_in'], 'B_w_sp': _B_in['w_sp'], 'B_b_sp': _B_in['b_sp'], 'B_w_out': _B_in['w_out'], 'c': _w((lambda *s: torch.randn(*s, dtype=torch.bfloat16) * 0.2)(1, 1024) * 8.0), 'w_mod': _w((lambda *s: torch.randn(*s, dtype=torch.bfloat16) * 0.2)(1024, 6 * 1024) * 1024 ** (-0.5) * 8.0)}

def reference(A_x, A_wqkv, A_wo, B_x, B_w_in, B_w_sp, B_b_sp, B_w_out, c, w_mod):

    def _A_ref(x, wqkv, wo):
        B, S, D = x.shape
        H = 32
        Dh = D // H
        qkv = (lambda x, *d: x.permute(*d))((x @ wqkv).reshape(B, S, 3, H, Dh), 2, 0, 3, 1, 4)
        q, k, v = (qkv[0], qkv[1], qkv[2])
        scale = Dh ** (-0.5)
        scores = torch.einsum('bhqd,bhkd->bhqk', q, k) * scale
        p = _softmax(scores, axis=-1)
        o = torch.einsum('bhqk,bhkd->bhqd', p, v)
        return (lambda x, *d: x.permute(*d))(o, 0, 2, 1, 3).reshape(B, S, D) @ wo

    def _B_ref(x, w_in, w_sp, b_sp, w_out):
        B, S, D = x.shape
        F = w_in.shape[-1]
        Fh = F // 2
        z = _gelu(torch.einsum('bsd,df->bsf', x, w_in))
        z1 = z[..., :Fh].clone()
        z2 = _layernorm(z[..., Fh:], axis=-1)
        g = torch.einsum('ts,bsf->btf', w_sp, z2) + b_sp[None, :, None]
        return torch.einsum('bsf,fd->bsd', z1 * g, w_out)
    x = A_x
    mod = (_silu(c) @ w_mod).reshape(c.shape[0], 6, 1, -1)
    sa, ca, ga, sb, cb, gb = (mod[:, 0].clone(), mod[:, 1].clone(), mod[:, 2].clone(), mod[:, 3].clone(), mod[:, 4].clone(), mod[:, 5].clone())
    h = _layernorm(x, axis=-1) * (1 + ca) + sa
    x = x + ga * _A_ref(h, A_wqkv, A_wo)
    h = _layernorm(x, axis=-1) * (1 + cb) + sb
    x = x + gb * _B_ref(h, B_w_in, B_w_sp, B_b_sp, B_w_out)
    return x
```

```asm
; @launch kernel=mp0_kernel grid=(256,1,1) block=(512,1,1) lds=163840
.amdgcn_target "amdgcn-amd-amdhsa--gfx950"
.text
.globl mp0_kernel
.p2align 8
.type mp0_kernel,@function
mp0_kernel:
    s_load_dwordx16 s[4:19], s[0:1], 0
    s_load_dwordx8 s[20:27], s[0:1], 64
    s_load_dwordx2 s[28:29], s[0:1], 96
    s_cmp_ge_u32 s2, 256
    s_cbranch_scc1 L_mp0_end
    v_lshrrev_b32 v1, 6, v0
    s_nop 0
    v_readfirstlane_b32 s3, v1
L_p0_entry:
    s_cmp_ge_u32 s3, 1
    s_cbranch_scc1 L_mp0_c01
    s_lshl_b32 s44, s3, 13
    s_getpc_b64 s[64:65]
L_mp0_pc2:
    s_add_u32 s64, s64, L_mp0_c01-L_mp0_pc2
    s_addc_u32 s65, s65, 0
    v_and_b32 v196, 63, v0
    v_lshl_add_u32 v196, v196, 7, s44
    v_min_u32 v196, L_text_end-L_mp0_c01-4, v196
    v_mov_b32 v197, s65
    v_add_co_u32 v196, vcc, s64, v196
    s_nop 1
    v_addc_co_u32 v197, vcc, 0, v197, vcc
    global_load_dword v198, v[196:197], off
L_mp0_c01:
    v_and_b32 v1, 63, v0
    v_lshlrev_b32 v6, 4, v0
    s_lshr_b32 s30, s2, 4
    s_lshl_b32 s30, s30, 3
    s_and_b32 s47, s2, 7
    s_add_u32 s30, s30, s47
    s_bitcmp1_b32 s2, 3
    s_cbranch_scc1 L_p0_stats
    s_lshr_b32 s48, s30, 2
    s_and_b32 s49, s30, 3
    v_lshrrev_b32 v2, 3, v0
    v_and_b32 v3, 7, v0
    v_lshlrev_b32_e64 v4, 3, v2
    v_mul_u32_u24 v5, 49152, v2
    v_lshl_add_u32 v5, v3, 4, v5
    s_lshl_b32 s31, s48, 7
    s_mul_i32 s44, s49, 3145728
    s_add_u32 s31, s31, s44
    s_lshl_b32 s45, s49, 9
    s_waitcnt lgkmcnt(0)
    s_load_dwordx2 s[84:85], s[28:29], 0x3c000
    s_mov_b32 s36, s22
    s_and_b32 s37, s23, 0xffff
    s_mov_b32 s38, 0xc00000
    s_mov_b32 s39, 0x20000
    s_mov_b32 s32, s20
    s_and_b32 s33, s21, 0xffff
    s_mov_b32 s34, 0x800
    s_mov_b32 s35, 0x20000
    buffer_load_dwordx2 v[8:9], v4, s[32:35], s45 offen
    buffer_load_dwordx4 v[12:15], v5, s[36:39], s31 offen
    s_add_u32 s31, s31, 12288
    buffer_load_dwordx4 v[16:19], v5, s[36:39], s31 offen
    s_add_u32 s31, s31, 12288
    buffer_load_dwordx4 v[20:23], v5, s[36:39], s31 offen
    s_add_u32 s31, s31, 12288
    buffer_load_dwordx4 v[24:27], v5, s[36:39], s31 offen
    s_add_u32 s31, s31, 12288
    s_mov_b32 s40, s28
    s_and_b32 s41, s29, 0xffff
    s_mov_b32 s42, 0x40000
    s_mov_b32 s43, 0x20000
    s_waitcnt vmcnt(4)
    v_lshlrev_b32_e64 v44, 16, v8
    v_and_b32 v45, 0xffff0000, v8
    v_lshlrev_b32_e64 v46, 16, v9
    v_and_b32 v47, 0xffff0000, v9
    v_mul_f32 v52, 0xbfb8aa3b, v44
    v_mul_f32 v53, 0xbfb8aa3b, v45
    v_mul_f32 v54, 0xbfb8aa3b, v46
    v_mul_f32 v55, 0xbfb8aa3b, v47
    v_exp_f32 v52, v52
    v_exp_f32 v53, v53
    v_exp_f32 v54, v54
    v_exp_f32 v55, v55
    v_add_f32 v52, 1.0, v52
    v_add_f32 v53, 1.0, v53
    v_add_f32 v54, 1.0, v54
    v_add_f32 v55, 1.0, v55
    v_rcp_f32 v52, v52
    v_rcp_f32 v53, v53
    v_rcp_f32 v54, v54
    v_rcp_f32 v55, v55
    v_mul_f32 v44, v44, v52
    v_mul_f32 v45, v45, v53
    v_mul_f32 v46, v46, v54
    v_mul_f32 v47, v47, v55
    v_cvt_pk_bf16_f32 v52, v44, v45
    v_lshlrev_b32_e64 v44, 16, v52
    v_and_b32 v45, 0xffff0000, v52
    v_cvt_pk_bf16_f32 v52, v46, v47
    v_lshlrev_b32_e64 v46, 16, v52
    v_and_b32 v47, 0xffff0000, v52
L_mp0_nosc4:
    s_waitcnt vmcnt(3)
    v_lshlrev_b32 v52, 16, v12
    v_and_b32 v53, 0xffff0000, v12
    v_mul_f32 v56, v52, v44
    v_mul_f32 v57, v53, v44
    v_lshlrev_b32_e64 v52, 16, v13
    v_and_b32 v53, 0xffff0000, v13
    v_mul_f32 v58, v52, v44
    v_mul_f32 v59, v53, v44
    v_lshlrev_b32_e64 v52, 16, v14
    v_and_b32 v53, 0xffff0000, v14
    v_mul_f32 v60, v52, v44
    v_mul_f32 v61, v53, v44
    v_lshlrev_b32_e64 v52, 16, v15
    v_and_b32 v53, 0xffff0000, v15
    v_mul_f32 v62, v52, v44
    v_mul_f32 v63, v53, v44
    s_waitcnt vmcnt(2)
    v_lshlrev_b32 v52, 16, v16
    v_and_b32 v53, 0xffff0000, v16
    v_fmac_f32 v56, v52, v45
    v_fmac_f32 v57, v53, v45
    v_lshlrev_b32_e64 v52, 16, v17
    v_and_b32 v53, 0xffff0000, v17
    v_fmac_f32 v58, v52, v45
    v_fmac_f32 v59, v53, v45
    v_lshlrev_b32_e64 v52, 16, v18
    v_and_b32 v53, 0xffff0000, v18
    v_fmac_f32 v60, v52, v45
    v_fmac_f32 v61, v53, v45
    v_lshlrev_b32_e64 v52, 16, v19
    v_and_b32 v53, 0xffff0000, v19
    v_fmac_f32 v62, v52, v45
    v_fmac_f32 v63, v53, v45
    s_waitcnt vmcnt(1)
    v_lshlrev_b32 v52, 16, v20
    v_and_b32 v53, 0xffff0000, v20
    v_fmac_f32 v56, v52, v46
    v_fmac_f32 v57, v53, v46
    v_lshlrev_b32_e64 v52, 16, v21
    v_and_b32 v53, 0xffff0000, v21
    v_fmac_f32 v58, v52, v46
    v_fmac_f32 v59, v53, v46
    v_lshlrev_b32_e64 v52, 16, v22
    v_and_b32 v53, 0xffff0000, v22
    v_fmac_f32 v60, v52, v46
    v_fmac_f32 v61, v53, v46
    v_lshlrev_b32_e64 v52, 16, v23
    v_and_b32 v53, 0xffff0000, v23
    v_fmac_f32 v62, v52, v46
    v_fmac_f32 v63, v53, v46
    s_waitcnt vmcnt(0)
    v_lshlrev_b32 v52, 16, v24
    v_and_b32 v53, 0xffff0000, v24
    v_fmac_f32 v56, v52, v47
    v_fmac_f32 v57, v53, v47
    v_lshlrev_b32_e64 v52, 16, v25
    v_and_b32 v53, 0xffff0000, v25
    v_fmac_f32 v58, v52, v47
    v_fmac_f32 v59, v53, v47
    v_lshlrev_b32_e64 v52, 16, v26
    v_and_b32 v53, 0xffff0000, v26
    v_fmac_f32 v60, v52, v47
    v_fmac_f32 v61, v53, v47
    v_lshlrev_b32_e64 v52, 16, v27
    v_and_b32 v53, 0xffff0000, v27
    v_fmac_f32 v62, v52, v47
    v_fmac_f32 v63, v53, v47
    s_nop 1
    v_permlane32_swap_b32 v56, v60
    v_permlane32_swap_b32 v57, v61
    v_permlane32_swap_b32 v58, v62
    v_permlane32_swap_b32 v59, v63
    s_nop 1
    v_add_f32 v56, v56, v60
    v_add_f32 v57, v57, v61
    v_add_f32 v58, v58, v62
    v_add_f32 v59, v59, v63
    s_nop 1
    v_permlane16_swap_b32 v56, v58
    v_permlane16_swap_b32 v57, v59
    s_nop 1
    v_add_f32 v56, v56, v58
    v_add_f32_e64 v57, v57, v59
    s_nop 1
    v_add_f32_dpp v56, v56, v56 row_ror:8 row_mask:0xf bank_mask:0xf
    v_add_f32_dpp v57, v57, v57 row_ror:8 row_mask:0xf bank_mask:0xf
    v_lshlrev_b32 v2, 5, v3
    v_lshrrev_b32 v7, 4, v1
    v_lshl_add_u32 v2, v7, 3, v2
    s_lshl_b32 s44, s3, 8
    s_add_u32 s44, s44, 131072
    v_add_u32 v2, s44, v2
    ds_write_b64 v2, v[56:57]
    s_waitcnt lgkmcnt(0)
    s_add_u32 s84, s84, 1
    s_barrier
    s_cmp_lg_u32 s3, 0
    s_cbranch_scc1 L_mp0_nw5
    v_lshlrev_b32 v2, 2, v1
    v_add_u32 v7, 131072, v2
    ds_read_b32 v12, v7 offset:0
    ds_read_b32 v13, v7 offset:256
    ds_read_b32 v14, v7 offset:512
    ds_read_b32 v15, v7 offset:768
    ds_read_b32 v16, v7 offset:1024
    ds_read_b32 v17, v7 offset:1280
    ds_read_b32 v18, v7 offset:1536
    ds_read_b32 v19, v7 offset:1792
    s_add_u32 s96, s28, 0x3a00000
    s_addc_u32 s97, s29, 0
    s_and_b32 s97, s97, 0xffff
    s_mov_b32 s98, 0x200000
    s_mov_b32 s99, 0x20000
    v_mov_b32 v252, s84
    v_mov_b32 v253, s85
    v_mov_b32_e64 v254, 0
    s_lshl_b32 s31, s48, 8
    s_lshl_b32 s44, s49, 13
    s_add_u32 s31, s31, s44
    s_add_u32 s31, s31, 131072
    s_lshl_b32 s100, s30, 7
    s_add_u32 s100, s100, 1572864
    s_waitcnt lgkmcnt(0)
    v_add_f32 v12, v12, v13
    v_add_f32 v14, v14, v15
    v_add_f32 v16, v16, v17
    v_add_f32 v18, v18, v19
    v_add_f32 v12, v12, v14
    v_add_f32 v16, v16, v18
    v_add_f32_e64 v12, v12, v16
    s_add_u32 s96, s28, 0xc0000
    s_addc_u32 s97, s29, 0
    s_and_b32 s97, s97, 0xffff
    s_mov_b32 s98, 0x10000
    s_mov_b32 s99, 0x20000
    v_mov_b32 v14, s84
    v_mov_b32_e64 v15, s85
    v_mov_b32_dpp v13, v12 quad_perm:[1,1,3,3] row_mask:0xf bank_mask:0xf
    v_lshlrev_b32 v2, 3, v1
    s_lshl_b32 s31, s48, 9
    s_lshl_b32 s44, s49, 14
    s_add_u32 s31, s31, s44
    s_mov_b32 exec_lo, 0x55555555
    s_mov_b32 exec_hi, 0x55555555
    buffer_store_dwordx4 v[12:15], v2, s[96:99], s31 offen sc1
    s_mov_b64 exec, -1
    s_waitcnt vmcnt(0)
L_mp0_nw5:
    s_barrier
    s_mov_b32 s36, s6
    s_and_b32 s37, s7, 0xffff
    s_mov_b32 s38, 0x600000
    s_mov_b32 s39, 0x20000
    s_lshl_b32 s51, s30, 13
    s_add_u32 s51, s51, 0
    s_cmp_lg_u32 s3, 2
    s_cbranch_scc1 L_mp0_nc3
    s_cmp_ge_u32 s30, 64
    s_cbranch_scc1 L_mp0_nc3
    s_lshr_b32 s44, s30, 3
    s_lshl_b32 s44, s44, 13
    s_getpc_b64 s[64:65]
L_mp0_pc7:
    s_add_u32 s64, s64, L_qkv_entry-L_mp0_pc7
    s_addc_u32 s65, s65, 0
    v_and_b32_e64 v36, 63, v0
    v_lshl_add_u32 v36, v36, 7, s44
    v_min_u32 v36, L_text_end-L_qkv_entry-4, v36
    v_mov_b32 v37, s65
    v_add_co_u32 v36, vcc, s64, v36
    s_nop 1
    v_addc_co_u32 v37, vcc, 0, v37, vcc
    global_load_dword v38, v[36:37], off
L_mp0_nc3:
    s_mov_b32 s52, s22
    s_and_b32 s53, s23, 0xffff
    s_mov_b32 s54, 0xc00000
    s_mov_b32 s55, 0x20000
    s_mov_b32 s56, s20
    s_and_b32 s57, s21, 0xffff
    s_mov_b32 s58, 0x800
    s_mov_b32 s59, 0x20000
    v_lshrrev_b32 v164, 3, v0
    v_lshlrev_b32 v165, 4, v164
    v_mul_u32_u24 v164, 98304, v164
    v_and_b32_e64 v166, 7, v0
    v_lshl_add_u32 v164, v166, 4, v164
    s_lshr_b32 s60, s30, 1
    s_and_b32 s61, s30, 1
    s_lshl_b32 s62, s60, 7
    s_mul_i32 s63, s61, 6291456
    s_add_u32 s62, s62, s63
    s_add_u32 s62, s62, 4096
    s_lshl_b32 s63, s61, 10
    buffer_load_dwordx4 v[128:131], v165, s[56:59], s63 offen
    s_waitcnt vmcnt(0)
    buffer_load_dwordx4 v[132:135], v164, s[52:55], s62 offen
    s_add_u32 s62, s62, 12288
    buffer_load_dwordx4 v[136:139], v164, s[52:55], s62 offen
    s_add_u32 s62, s62, 12288
    buffer_load_dwordx4 v[140:143], v164, s[52:55], s62 offen
    s_add_u32 s62, s62, 12288
    buffer_load_dwordx4 v[144:147], v164, s[52:55], s62 offen
    s_add_u32 s62, s62, 12288
    buffer_load_dwordx4 v[148:151], v164, s[52:55], s62 offen
    s_add_u32 s62, s62, 12288
    buffer_load_dwordx4 v[152:155], v164, s[52:55], s62 offen
    s_add_u32 s62, s62, 12288
    buffer_load_dwordx4 v[156:159], v164, s[52:55], s62 offen
    s_add_u32 s62, s62, 12288
    buffer_load_dwordx4 v[160:163], v164, s[52:55], s62 offen
    s_add_u32 s62, s62, 12288
    s_waitcnt vmcnt(8)
    v_lshlrev_b32 v168, 16, v128
    v_and_b32 v169, 0xffff0000, v128
    v_lshlrev_b32_e64 v170, 16, v129
    v_and_b32 v171, 0xffff0000, v129
    v_lshlrev_b32_e64 v172, 16, v130
    v_and_b32 v173, 0xffff0000, v130
    v_lshlrev_b32_e64 v174, 16, v131
    v_and_b32 v175, 0xffff0000, v131
    v_mul_f32 v176, 0xbfb8aa3b, v168
    v_mul_f32 v177, 0xbfb8aa3b, v169
    v_mul_f32 v178, 0xbfb8aa3b, v170
    v_mul_f32 v179, 0xbfb8aa3b, v171
    v_mul_f32 v180, 0xbfb8aa3b, v172
    v_mul_f32 v181, 0xbfb8aa3b, v173
    v_mul_f32 v182, 0xbfb8aa3b, v174
    v_mul_f32 v183, 0xbfb8aa3b, v175
    v_exp_f32 v176, v176
    v_exp_f32 v177, v177
    v_exp_f32 v178, v178
    v_exp_f32 v179, v179
    v_exp_f32 v180, v180
    v_exp_f32 v181, v181
    v_exp_f32 v182, v182
    v_exp_f32 v183, v183
    v_add_f32 v176, 1.0, v176
    v_add_f32 v177, 1.0, v177
    v_add_f32 v178, 1.0, v178
    v_add_f32 v179, 1.0, v179
    v_add_f32 v180, 1.0, v180
    v_add_f32 v181, 1.0, v181
    v_add_f32 v182, 1.0, v182
    v_add_f32 v183, 1.0, v183
    v_rcp_f32 v176, v176
    v_rcp_f32 v177, v177
    v_rcp_f32 v178, v178
    v_rcp_f32 v179, v179
    v_rcp_f32 v180, v180
    v_rcp_f32 v181, v181
    v_rcp_f32 v182, v182
    v_rcp_f32 v183, v183
    v_mul_f32 v168, v168, v176
    v_mul_f32 v169, v169, v177
    v_mul_f32 v170, v170, v178
    v_mul_f32 v171, v171, v179
    v_mul_f32 v172, v172, v180
    v_mul_f32 v173, v173, v181
    v_mul_f32 v174, v174, v182
    v_mul_f32 v175, v175, v183
    v_cvt_pk_bf16_f32 v176, v168, v169
    v_lshlrev_b32_e64 v168, 16, v176
    v_and_b32 v169, 0xffff0000, v176
    v_cvt_pk_bf16_f32 v176, v170, v171
    v_lshlrev_b32_e64 v170, 16, v176
    v_and_b32 v171, 0xffff0000, v176
    v_cvt_pk_bf16_f32 v176, v172, v173
    v_lshlrev_b32_e64 v172, 16, v176
    v_and_b32 v173, 0xffff0000, v176
    v_cvt_pk_bf16_f32 v176, v174, v175
    v_lshlrev_b32_e64 v174, 16, v176
    v_and_b32 v175, 0xffff0000, v176
    s_waitcnt vmcnt(7)
    v_lshlrev_b32 v176, 16, v132
    v_and_b32 v177, 0xffff0000, v132
    v_mul_f32 v184, v176, v168
    v_mul_f32 v185, v177, v168
    v_lshlrev_b32_e64 v176, 16, v133
    v_and_b32 v177, 0xffff0000, v133
    v_mul_f32 v186, v176, v168
    v_mul_f32 v187, v177, v168
    v_lshlrev_b32_e64 v176, 16, v134
    v_and_b32 v177, 0xffff0000, v134
    v_mul_f32 v188, v176, v168
    v_mul_f32 v189, v177, v168
    v_lshlrev_b32_e64 v176, 16, v135
    v_and_b32 v177, 0xffff0000, v135
    v_mul_f32 v190, v176, v168
    v_mul_f32 v191, v177, v168
    s_waitcnt vmcnt(6)
    v_lshlrev_b32 v176, 16, v136
    v_and_b32 v177, 0xffff0000, v136
    v_fmac_f32 v184, v176, v169
    v_fmac_f32 v185, v177, v169
    v_lshlrev_b32_e64 v176, 16, v137
    v_and_b32 v177, 0xffff0000, v137
    v_fmac_f32 v186, v176, v169
    v_fmac_f32 v187, v177, v169
    v_lshlrev_b32_e64 v176, 16, v138
    v_and_b32 v177, 0xffff0000, v138
    v_fmac_f32 v188, v176, v169
    v_fmac_f32 v189, v177, v169
    v_lshlrev_b32_e64 v176, 16, v139
    v_and_b32 v177, 0xffff0000, v139
    v_fmac_f32 v190, v176, v169
    v_fmac_f32 v191, v177, v169
    s_waitcnt vmcnt(5)
    v_lshlrev_b32 v176, 16, v140
    v_and_b32 v177, 0xffff0000, v140
    v_fmac_f32 v184, v176, v170
    v_fmac_f32 v185, v177, v170
    v_lshlrev_b32_e64 v176, 16, v141
    v_and_b32 v177, 0xffff0000, v141
    v_fmac_f32 v186, v176, v170
    v_fmac_f32 v187, v177, v170
    v_lshlrev_b32_e64 v176, 16, v142
    v_and_b32 v177, 0xffff0000, v142
    v_fmac_f32 v188, v176, v170
    v_fmac_f32 v189, v177, v170
    v_lshlrev_b32_e64 v176, 16, v143
    v_and_b32 v177, 0xffff0000, v143
    v_fmac_f32 v190, v176, v170
    v_fmac_f32 v191, v177, v170
    s_waitcnt vmcnt(4)
    v_lshlrev_b32 v176, 16, v144
    v_and_b32 v177, 0xffff0000, v144
    v_fmac_f32 v184, v176, v171
    v_fmac_f32 v185, v177, v171
    v_lshlrev_b32_e64 v176, 16, v145
    v_and_b32 v177, 0xffff0000, v145
    v_fmac_f32 v186, v176, v171
    v_fmac_f32 v187, v177, v171
    v_lshlrev_b32_e64 v176, 16, v146
    v_and_b32 v177, 0xffff0000, v146
    v_fmac_f32 v188, v176, v171
    v_fmac_f32 v189, v177, v171
    v_lshlrev_b32_e64 v176, 16, v147
    v_and_b32 v177, 0xffff0000, v147
    v_fmac_f32 v190, v176, v171
    v_fmac_f32 v191, v177, v171
    s_waitcnt vmcnt(3)
    v_lshlrev_b32 v176, 16, v148
    v_and_b32 v177, 0xffff0000, v148
    v_fmac_f32 v184, v176, v172
    v_fmac_f32 v185, v177, v172
    v_lshlrev_b32_e64 v176, 16, v149
    v_and_b32 v177, 0xffff0000, v149
    v_fmac_f32 v186, v176, v172
    v_fmac_f32 v187, v177, v172
    v_lshlrev_b32_e64 v176, 16, v150
    v_and_b32 v177, 0xffff0000, v150
    v_fmac_f32 v188, v176, v172
    v_fmac_f32 v189, v177, v172
    v_lshlrev_b32_e64 v176, 16, v151
    v_and_b32 v177, 0xffff0000, v151
    v_fmac_f32 v190, v176, v172
    v_fmac_f32 v191, v177, v172
    s_waitcnt vmcnt(2)
    v_lshlrev_b32 v176, 16, v152
    v_and_b32 v177, 0xffff0000, v152
    v_fmac_f32 v184, v176, v173
    v_fmac_f32 v185, v177, v173
    v_lshlrev_b32_e64 v176, 16, v153
    v_and_b32 v177, 0xffff0000, v153
    v_fmac_f32 v186, v176, v173
    v_fmac_f32 v187, v177, v173
    v_lshlrev_b32_e64 v176, 16, v154
    v_and_b32 v177, 0xffff0000, v154
    v_fmac_f32 v188, v176, v173
    v_fmac_f32 v189, v177, v173
    v_lshlrev_b32_e64 v176, 16, v155
    v_and_b32 v177, 0xffff0000, v155
    v_fmac_f32 v190, v176, v173
    v_fmac_f32 v191, v177, v173
    s_waitcnt vmcnt(1)
    v_lshlrev_b32 v176, 16, v156
    v_and_b32 v177, 0xffff0000, v156
    v_fmac_f32 v184, v176, v174
    v_fmac_f32 v185, v177, v174
    v_lshlrev_b32_e64 v176, 16, v157
    v_and_b32 v177, 0xffff0000, v157
    v_fmac_f32 v186, v176, v174
    v_fmac_f32 v187, v177, v174
    v_lshlrev_b32_e64 v176, 16, v158
    v_and_b32 v177, 0xffff0000, v158
    v_fmac_f32 v188, v176, v174
    v_fmac_f32 v189, v177, v174
    v_lshlrev_b32_e64 v176, 16, v159
    v_and_b32 v177, 0xffff0000, v159
    v_fmac_f32 v190, v176, v174
    v_fmac_f32 v191, v177, v174
    s_waitcnt vmcnt(0)
    v_lshlrev_b32 v176, 16, v160
    v_and_b32 v177, 0xffff0000, v160
    v_fmac_f32 v184, v176, v175
    v_fmac_f32 v185, v177, v175
    v_lshlrev_b32_e64 v176, 16, v161
    v_and_b32 v177, 0xffff0000, v161
    v_fmac_f32 v186, v176, v175
    v_fmac_f32 v187, v177, v175
    v_lshlrev_b32_e64 v176, 16, v162
    v_and_b32 v177, 0xffff0000, v162
    v_fmac_f32 v188, v176, v175
    v_fmac_f32 v189, v177, v175
    v_lshlrev_b32_e64 v176, 16, v163
    v_and_b32 v177, 0xffff0000, v163
    v_fmac_f32 v190, v176, v175
    v_fmac_f32 v191, v177, v175
    s_nop 1
    v_permlane32_swap_b32 v184, v188
    v_permlane32_swap_b32 v185, v189
    v_permlane32_swap_b32 v186, v190
    v_permlane32_swap_b32 v187, v191
    s_nop 1
    v_add_f32 v184, v184, v188
    v_add_f32 v185, v185, v189
    v_add_f32 v186, v186, v190
    v_add_f32 v187, v187, v191
    s_nop 1
    v_permlane16_swap_b32 v184, v186
    v_permlane16_swap_b32 v185, v187
    s_nop 1
    v_add_f32 v184, v184, v186
    v_add_f32_e64 v185, v185, v187
    s_nop 1
    v_add_f32_dpp v184, v184, v184 row_ror:8 row_mask:0xf bank_mask:0xf
    v_add_f32_dpp v185, v185, v185 row_ror:8 row_mask:0xf bank_mask:0xf
    v_lshlrev_b32 v164, 5, v166
    v_lshrrev_b32 v165, 4, v1
    v_lshl_add_u32 v164, v165, 3, v164
    s_lshl_b32 s62, s3, 8
    s_add_u32 s62, s62, 139264
    v_add_u32 v164, s62, v164
    ds_write_b64 v164, v[184:185]
    s_waitcnt lgkmcnt(0)
    s_barrier
    s_cmp_lg_u32 s3, 7
    s_cbranch_scc1 L_mp0_nw8
    v_lshlrev_b32_e64 v164, 2, v1
    v_add_u32 v165, 139264, v164
    ds_read_b32 v176, v165 offset:0
    ds_read_b32 v177, v165 offset:256
    ds_read_b32 v178, v165 offset:512
    ds_read_b32 v179, v165 offset:768
    ds_read_b32 v180, v165 offset:1024
    ds_read_b32 v181, v165 offset:1280
    ds_read_b32 v182, v165 offset:1536
    ds_read_b32 v183, v165 offset:1792
    s_lshl_b32 s62, s60, 8
    s_lshl_b32 s63, s61, 14
    s_add_u32 s62, s62, s63
    s_add_u32 s62, s62, 163840
    s_waitcnt lgkmcnt(0)
    v_add_f32 v176, v176, v177
    v_add_f32 v178, v178, v179
    v_add_f32 v180, v180, v181
    v_add_f32 v182, v182, v183
    v_add_f32 v176, v176, v178
    v_add_f32 v180, v180, v182
    v_add_f32_e64 v176, v176, v180
    buffer_store_dword v176, v164, s[40:43], s62 offen sc1
L_mp0_nw8:
    s_waitcnt vmcnt(0)
    s_mov_b64 exec, -1
    s_setprio 0
    s_branch L_qkv_entry
L_p0_stats:
    s_lshl_b32 s44, s3, 12
    v_lshl_add_u32 v3, v1, 4, s44
    s_lshl_b32 s31, s30, 15
    s_waitcnt lgkmcnt(0)
    s_load_dwordx2 s[84:85], s[28:29], 0x3c000
    s_mov_b32 s32, s4
    s_and_b32 s33, s5, 0xffff
    s_mov_b32 s34, 0x400000
    s_mov_b32 s35, 0x20000
    buffer_load_dwordx4 v[8:11], v3, s[32:35], s31 offen offset:0
    buffer_load_dwordx4 v[12:15], v3, s[32:35], s31 offen offset:1024
    buffer_load_dwordx4 v[16:19], v3, s[32:35], s31 offen offset:2048
    buffer_load_dwordx4 v[20:23], v3, s[32:35], s31 offen offset:3072
    s_add_u32 s36, s28, 0x100000
    s_addc_u32 s37, s29, 0
    s_and_b32 s37, s37, 0xffff
    s_mov_b32 s38, 0x400000
    s_mov_b32 s39, 0x20000
    s_mov_b32 s40, s28
    s_and_b32 s41, s29, 0xffff
    s_mov_b32 s42, 0x40000
    s_mov_b32 s43, 0x20000
    s_lshr_b32 s100, s30, 3
    s_lshl_b32 s100, s100, 8
    s_and_b32 s101, s30, 7
    s_lshl_b32 s101, s101, 2
    s_add_u32 s100, s100, s101
    s_add_u32 s100, s100, 0
    s_lshl_b32 s87, s100, 5
    s_waitcnt vmcnt(0) lgkmcnt(0)
    s_add_u32 s84, s84, 1
    v_lshlrev_b32 v24, 16, v8
    v_and_b32 v25, 0xffff0000, v8
    v_lshlrev_b32_e64 v26, 16, v9
    v_and_b32 v27, 0xffff0000, v9
    v_lshlrev_b32_e64 v28, 16, v10
    v_and_b32 v29, 0xffff0000, v10
    v_lshlrev_b32_e64 v30, 16, v11
    v_and_b32 v31, 0xffff0000, v11
    v_lshlrev_b32_e64 v32, 16, v12
    v_and_b32 v33, 0xffff0000, v12
    v_lshlrev_b32_e64 v34, 16, v13
    v_and_b32 v35, 0xffff0000, v13
    v_lshlrev_b32_e64 v36, 16, v14
    v_and_b32 v37, 0xffff0000, v14
    v_lshlrev_b32_e64 v38, 16, v15
    v_and_b32 v39, 0xffff0000, v15
    v_lshlrev_b32_e64 v40, 16, v16
    v_and_b32 v41, 0xffff0000, v16
    v_lshlrev_b32_e64 v42, 16, v17
    v_and_b32 v43, 0xffff0000, v17
    v_lshlrev_b32_e64 v44, 16, v18
    v_and_b32 v45, 0xffff0000, v18
    v_lshlrev_b32_e64 v46, 16, v19
    v_and_b32 v47, 0xffff0000, v19
    v_lshlrev_b32_e64 v48, 16, v20
    v_and_b32 v49, 0xffff0000, v20
    v_lshlrev_b32_e64 v50, 16, v21
    v_and_b32 v51, 0xffff0000, v21
    v_lshlrev_b32_e64 v52, 16, v22
    v_and_b32 v53, 0xffff0000, v22
    v_lshlrev_b32_e64 v54, 16, v23
    v_and_b32 v55, 0xffff0000, v23
    v_pk_add_f32 v[8:9], v[24:25], v[26:27]
    v_pk_mul_f32 v[10:11], v[24:25], v[24:25]
    v_pk_fma_f32 v[10:11], v[26:27], v[26:27], v[10:11]
    v_pk_add_f32 v[8:9], v[8:9], v[28:29]
    v_pk_fma_f32 v[10:11], v[28:29], v[28:29], v[10:11]
    v_pk_add_f32 v[8:9], v[8:9], v[30:31]
    v_pk_fma_f32 v[10:11], v[30:31], v[30:31], v[10:11]
    v_pk_add_f32 v[8:9], v[8:9], v[32:33]
    v_pk_fma_f32 v[10:11], v[32:33], v[32:33], v[10:11]
    v_pk_add_f32 v[8:9], v[8:9], v[34:35]
    v_pk_fma_f32 v[10:11], v[34:35], v[34:35], v[10:11]
    v_pk_add_f32 v[8:9], v[8:9], v[36:37]
    v_pk_fma_f32 v[10:11], v[36:37], v[36:37], v[10:11]
    v_pk_add_f32 v[8:9], v[8:9], v[38:39]
    v_pk_fma_f32 v[10:11], v[38:39], v[38:39], v[10:11]
    v_add_f32 v56, v8, v9
    v_add_f32 v60, v10, v11
    v_pk_add_f32 v[12:13], v[40:41], v[42:43]
    v_pk_mul_f32 v[14:15], v[40:41], v[40:41]
    v_pk_fma_f32 v[14:15], v[42:43], v[42:43], v[14:15]
    v_pk_add_f32 v[12:13], v[12:13], v[44:45]
    v_pk_fma_f32 v[14:15], v[44:45], v[44:45], v[14:15]
    v_pk_add_f32 v[12:13], v[12:13], v[46:47]
    v_pk_fma_f32 v[14:15], v[46:47], v[46:47], v[14:15]
    v_pk_add_f32 v[12:13], v[12:13], v[48:49]
    v_pk_fma_f32 v[14:15], v[48:49], v[48:49], v[14:15]
    v_pk_add_f32 v[12:13], v[12:13], v[50:51]
    v_pk_fma_f32 v[14:15], v[50:51], v[50:51], v[14:15]
    v_pk_add_f32 v[12:13], v[12:13], v[52:53]
    v_pk_fma_f32 v[14:15], v[52:53], v[52:53], v[14:15]
    v_pk_add_f32 v[12:13], v[12:13], v[54:55]
    v_pk_fma_f32 v[14:15], v[54:55], v[54:55], v[14:15]
    v_add_f32 v58, v12, v13
    v_add_f32_e64 v62, v14, v15
    s_nop 1
    v_add_f32_dpp v56, v56, v56 row_ror:8 row_mask:0xf bank_mask:0xf
    v_add_f32_dpp v58, v58, v58 row_ror:8 row_mask:0xf bank_mask:0xf
    v_add_f32_dpp v60, v60, v60 row_ror:8 row_mask:0xf bank_mask:0xf
    v_add_f32_dpp v62, v62, v62 row_ror:8 row_mask:0xf bank_mask:0xf
    s_nop 1
    v_add_f32_dpp v56, v56, v56 row_ror:4 row_mask:0xf bank_mask:0xf
    v_add_f32_dpp v58, v58, v58 row_ror:4 row_mask:0xf bank_mask:0xf
    v_add_f32_dpp v60, v60, v60 row_ror:4 row_mask:0xf bank_mask:0xf
    v_add_f32_dpp v62, v62, v62 row_ror:4 row_mask:0xf bank_mask:0xf
    s_nop 1
    v_add_f32_dpp v56, v56, v56 row_ror:2 row_mask:0xf bank_mask:0xf
    v_add_f32_dpp v58, v58, v58 row_ror:2 row_mask:0xf bank_mask:0xf
    v_add_f32_dpp v60, v60, v60 row_ror:2 row_mask:0xf bank_mask:0xf
    v_add_f32_dpp v62, v62, v62 row_ror:2 row_mask:0xf bank_mask:0xf
    s_nop 1
    v_add_f32_dpp v56, v56, v56 row_ror:1 row_mask:0xf bank_mask:0xf
    v_add_f32_dpp v58, v58, v58 row_ror:1 row_mask:0xf bank_mask:0xf
    v_add_f32_dpp v60, v60, v60 row_ror:1 row_mask:0xf bank_mask:0xf
    v_add_f32_dpp v62, v62, v62 row_ror:1 row_mask:0xf bank_mask:0xf
    v_mov_b32 v8, v56
    v_mov_b32 v9, v58
    v_mov_b32 v10, v60
    v_mov_b32 v11, v62
    s_nop 1
    v_permlane16_swap_b32 v56, v8
    v_permlane16_swap_b32 v58, v9
    v_permlane16_swap_b32 v60, v10
    v_permlane16_swap_b32 v62, v11
    s_nop 1
    v_add_f32 v56, v56, v8
    v_add_f32 v58, v58, v9
    v_add_f32 v60, v60, v10
    v_add_f32 v62, v62, v11
    v_mov_b32 v8, v56
    v_mov_b32 v9, v58
    v_mov_b32 v10, v60
    v_mov_b32 v11, v62
    s_nop 1
    v_permlane32_swap_b32 v56, v8
    v_permlane32_swap_b32 v58, v9
    v_permlane32_swap_b32 v60, v10
    v_permlane32_swap_b32 v62, v11
    s_nop 1
    v_add_f32 v56, v56, v8
    v_add_f32 v58, v58, v9
    v_add_f32 v60, v60, v10
    v_add_f32_e64 v62, v62, v11
    v_mul_f32 v56, 0xba800000, v56
    v_mul_f32 v60, 0x3a800000, v60
    v_fma_f32 v60, -v56, v56, v60
    v_max_f32_e64 v60, 0, v60
    v_mul_f32 v58, 0xba800000, v58
    v_mul_f32 v62, 0x3a800000, v62
    v_fma_f32 v62, -v58, v58, v62
    v_max_f32_e64 v62, 0, v62
    v_cvt_pk_bf16_f32 v8, v56, v60
    v_lshlrev_b32_e64 v56, 16, v8
    v_and_b32 v60, 0xffff0000, v8
    v_add_f32 v60, 0x3727c5ac, v60
    v_cvt_pk_bf16_f32 v8, v58, v62
    v_lshlrev_b32_e64 v58, 16, v8
    v_and_b32 v62, 0xffff0000, v8
    v_add_f32 v62, 0x3727c5ac, v62
    v_cvt_pk_bf16_f32 v8, v60, v62
    v_lshlrev_b32_e64 v60, 16, v8
    v_and_b32 v62, 0xffff0000, v8
    v_sqrt_f32 v60, v60
    v_sqrt_f32_e64 v62, v62
    s_nop 0
    v_cvt_pk_bf16_f32 v8, v60, v62
    v_lshlrev_b32_e64 v60, 16, v8
    v_and_b32 v62, 0xffff0000, v8
    v_rcp_f32 v60, v60
    v_rcp_f32 v62, v62
    v_lshrrev_b32_e64 v5, 1, v1
    v_mul_u32_u24 v5, 544, v5
    v_and_b32_e64 v7, 1, v1
    v_lshl_add_u32 v5, v7, 3, v5
    s_lshl_b32 s44, s3, 5
    v_add_u32 v5, s44, v5
    v_pk_add_f32 v[24:25], v[24:25], v[56:57] op_sel_hi:[1,0]
    v_pk_add_f32 v[26:27], v[26:27], v[56:57] op_sel_hi:[1,0]
    v_pk_add_f32 v[28:29], v[28:29], v[56:57] op_sel_hi:[1,0]
    v_pk_add_f32 v[30:31], v[30:31], v[56:57] op_sel_hi:[1,0]
    v_pk_add_f32 v[32:33], v[32:33], v[56:57] op_sel_hi:[1,0]
    v_pk_add_f32 v[34:35], v[34:35], v[56:57] op_sel_hi:[1,0]
    v_pk_add_f32 v[36:37], v[36:37], v[56:57] op_sel_hi:[1,0]
    v_pk_add_f32 v[38:39], v[38:39], v[56:57] op_sel_hi:[1,0]
    v_cvt_pk_bf16_f32 v8, v24, v25
    v_lshlrev_b32_e64 v24, 16, v8
    v_and_b32 v25, 0xffff0000, v8
    v_cvt_pk_bf16_f32 v9, v26, v27
    v_lshlrev_b32_e64 v26, 16, v9
    v_and_b32 v27, 0xffff0000, v9
    v_cvt_pk_bf16_f32 v10, v28, v29
    v_lshlrev_b32_e64 v28, 16, v10
    v_and_b32 v29, 0xffff0000, v10
    v_cvt_pk_bf16_f32 v11, v30, v31
    v_lshlrev_b32_e64 v30, 16, v11
    v_and_b32 v31, 0xffff0000, v11
    v_cvt_pk_bf16_f32 v12, v32, v33
    v_lshlrev_b32_e64 v32, 16, v12
    v_and_b32 v33, 0xffff0000, v12
    v_cvt_pk_bf16_f32 v13, v34, v35
    v_lshlrev_b32_e64 v34, 16, v13
    v_and_b32 v35, 0xffff0000, v13
    v_cvt_pk_bf16_f32 v14, v36, v37
    v_lshlrev_b32_e64 v36, 16, v14
    v_and_b32 v37, 0xffff0000, v14
    v_cvt_pk_bf16_f32 v15, v38, v39
    v_lshlrev_b32_e64 v38, 16, v15
    v_and_b32 v39, 0xffff0000, v15
    v_pk_mul_f32 v[24:25], v[24:25], v[60:61] op_sel_hi:[1,0]
    v_pk_mul_f32 v[26:27], v[26:27], v[60:61] op_sel_hi:[1,0]
    v_pk_mul_f32 v[28:29], v[28:29], v[60:61] op_sel_hi:[1,0]
    v_pk_mul_f32 v[30:31], v[30:31], v[60:61] op_sel_hi:[1,0]
    v_pk_mul_f32 v[32:33], v[32:33], v[60:61] op_sel_hi:[1,0]
    v_pk_mul_f32 v[34:35], v[34:35], v[60:61] op_sel_hi:[1,0]
    v_pk_mul_f32 v[36:37], v[36:37], v[60:61] op_sel_hi:[1,0]
    v_pk_mul_f32 v[38:39], v[38:39], v[60:61] op_sel_hi:[1,0]
    v_cvt_pk_bf16_f32 v8, v24, v25
    v_cvt_pk_bf16_f32 v9, v26, v27
    v_cvt_pk_bf16_f32 v10, v28, v29
    v_cvt_pk_bf16_f32 v11, v30, v31
    v_cvt_pk_bf16_f32 v12, v32, v33
    v_cvt_pk_bf16_f32 v13, v34, v35
    v_cvt_pk_bf16_f32 v14, v36, v37
    v_cvt_pk_bf16_f32 v15, v38, v39
    ds_write_b64 v5, v[8:9] offset:0
    ds_write_b64 v5, v[10:11] offset:272
    ds_write_b64 v5, v[12:13] offset:17408
    ds_write_b64 v5, v[14:15] offset:17680
    v_pk_add_f32 v[40:41], v[40:41], v[58:59] op_sel_hi:[1,0]
    v_pk_add_f32 v[42:43], v[42:43], v[58:59] op_sel_hi:[1,0]
    v_pk_add_f32 v[44:45], v[44:45], v[58:59] op_sel_hi:[1,0]
    v_pk_add_f32 v[46:47], v[46:47], v[58:59] op_sel_hi:[1,0]
    v_pk_add_f32 v[48:49], v[48:49], v[58:59] op_sel_hi:[1,0]
    v_pk_add_f32 v[50:51], v[50:51], v[58:59] op_sel_hi:[1,0]
    v_pk_add_f32 v[52:53], v[52:53], v[58:59] op_sel_hi:[1,0]
    v_pk_add_f32 v[54:55], v[54:55], v[58:59] op_sel_hi:[1,0]
    v_cvt_pk_bf16_f32 v16, v40, v41
    v_lshlrev_b32_e64 v40, 16, v16
    v_and_b32 v41, 0xffff0000, v16
    v_cvt_pk_bf16_f32 v17, v42, v43
    v_lshlrev_b32_e64 v42, 16, v17
    v_and_b32 v43, 0xffff0000, v17
    v_cvt_pk_bf16_f32 v18, v44, v45
    v_lshlrev_b32_e64 v44, 16, v18
    v_and_b32 v45, 0xffff0000, v18
    v_cvt_pk_bf16_f32 v19, v46, v47
    v_lshlrev_b32_e64 v46, 16, v19
    v_and_b32 v47, 0xffff0000, v19
    v_cvt_pk_bf16_f32 v20, v48, v49
    v_lshlrev_b32_e64 v48, 16, v20
    v_and_b32 v49, 0xffff0000, v20
    v_cvt_pk_bf16_f32 v21, v50, v51
    v_lshlrev_b32_e64 v50, 16, v21
    v_and_b32 v51, 0xffff0000, v21
    v_cvt_pk_bf16_f32 v22, v52, v53
    v_lshlrev_b32_e64 v52, 16, v22
    v_and_b32 v53, 0xffff0000, v22
    v_cvt_pk_bf16_f32 v23, v54, v55
    v_lshlrev_b32_e64 v54, 16, v23
    v_and_b32 v55, 0xffff0000, v23
    v_pk_mul_f32 v[40:41], v[40:41], v[62:63] op_sel_hi:[1,0]
    v_pk_mul_f32 v[42:43], v[42:43], v[62:63] op_sel_hi:[1,0]
    v_pk_mul_f32 v[44:45], v[44:45], v[62:63] op_sel_hi:[1,0]
    v_pk_mul_f32 v[46:47], v[46:47], v[62:63] op_sel_hi:[1,0]
    v_pk_mul_f32 v[48:49], v[48:49], v[62:63] op_sel_hi:[1,0]
    v_pk_mul_f32 v[50:51], v[50:51], v[62:63] op_sel_hi:[1,0]
    v_pk_mul_f32 v[52:53], v[52:53], v[62:63] op_sel_hi:[1,0]
    v_pk_mul_f32 v[54:55], v[54:55], v[62:63] op_sel_hi:[1,0]
    v_cvt_pk_bf16_f32 v16, v40, v41
    v_cvt_pk_bf16_f32 v17, v42, v43
    v_cvt_pk_bf16_f32 v18, v44, v45
    v_cvt_pk_bf16_f32 v19, v46, v47
    v_cvt_pk_bf16_f32 v20, v48, v49
    v_cvt_pk_bf16_f32 v21, v50, v51
    v_cvt_pk_bf16_f32 v22, v52, v53
    v_cvt_pk_bf16_f32 v23, v54, v55
    ds_write_b64 v5, v[16:17] offset:16
    ds_write_b64 v5, v[18:19] offset:288
    ds_write_b64 v5, v[20:21] offset:17424
    ds_write_b64 v5, v[22:23] offset:17696
    v_lshrrev_b32 v5, 4, v0
    v_and_b32 v7, 15, v0
    v_mul_u32_u24 v2, 272, v5
    v_lshl_add_u32 v2, v7, 4, v2
    v_lshlrev_b32_e64 v4, 9, v5
    v_lshl_add_u32 v4, v7, 4, v4
    v_lshrrev_b32 v3, 1, v5
    v_lshlrev_b32 v3, 6, v3
    v_and_b32_e64 v5, 1, v5
    v_lshl_add_u32 v3, v5, 4, v3
    v_add_u32 v3, 131072, v3
    s_lshr_b32 s44, s30, 1
    s_lshl_b32 s44, s44, 16
    s_and_b32 s45, s30, 1
    s_lshl_b32 s45, s45, 8
    s_add_u32 s44, s44, s45
    s_mov_b32 s48, 131072
    s_cmp_lt_u32 s3, 4
    s_cselect_b32 s49, 0, 1.0
    s_waitcnt lgkmcnt(0)
    s_cmp_gt_u32 s3, 3
    s_cbranch_scc1 L_mp0_nr9
    v_mov_b32 v132, -1
    v_mov_b32 v133, -1
    v_mov_b32 v134, -1
    v_mov_b32 v135, -1
    s_add_u32 s52, s28, 0x3900000
    s_addc_u32 s53, s29, 0
    s_and_b32 s53, s53, 0xffff
    s_mov_b32 s54, 0x80000
    s_mov_b32 s55, 0x20000
    s_mul_i32 s50, s30, 4096
    v_cmp_gt_u32 vcc, 256, v0
    s_and_saveexec_b64 s[46:47], vcc
    buffer_store_dwordx4 v[132:135], v6, s[52:55], s50 offen sc1
    s_mov_b64 exec, s[46:47]
    s_mov_b32 s52, s28
    s_and_b32 s53, s29, 0xffff
    s_mov_b32 s54, 0x10000
    s_mov_b32 s55, 0x20000
    s_mul_i32 s50, s30, 512
    v_cmp_gt_u32 vcc, 32, v0
    s_and_saveexec_b64 s[46:47], vcc
    buffer_store_dwordx4 v[132:135], v6, s[52:55], s50 offen sc1
    s_mov_b64 exec, s[46:47]
L_mp0_nr9:
    s_barrier
    ds_read_b128 v[8:11], v2 offset:0
    ds_read_b128 v[12:15], v2 offset:8704
    ds_read_b128 v[16:19], v2 offset:17408
    ds_read_b128 v[20:23], v2 offset:26112
    s_waitcnt lgkmcnt(3)
    v_lshlrev_b32 v24, 16, v8
    v_and_b32 v25, 0xffff0000, v8
    v_lshlrev_b32_e64 v26, 16, v9
    v_and_b32 v27, 0xffff0000, v9
    v_lshlrev_b32_e64 v28, 16, v10
    v_and_b32 v29, 0xffff0000, v10
    v_lshlrev_b32_e64 v30, 16, v11
    v_and_b32 v31, 0xffff0000, v11
    s_waitcnt lgkmcnt(2)
    v_lshlrev_b32 v32, 16, v12
    v_and_b32 v33, 0xffff0000, v12
    v_lshlrev_b32_e64 v34, 16, v13
    v_and_b32 v35, 0xffff0000, v13
    v_lshlrev_b32_e64 v36, 16, v14
    v_and_b32 v37, 0xffff0000, v14
    v_lshlrev_b32_e64 v38, 16, v15
    v_and_b32 v39, 0xffff0000, v15
    s_waitcnt lgkmcnt(1)
    v_lshlrev_b32 v40, 16, v16
    v_and_b32 v41, 0xffff0000, v16
    v_lshlrev_b32_e64 v42, 16, v17
    v_and_b32 v43, 0xffff0000, v17
    v_lshlrev_b32_e64 v44, 16, v18
    v_and_b32 v45, 0xffff0000, v18
    v_lshlrev_b32_e64 v46, 16, v19
    v_and_b32 v47, 0xffff0000, v19
    s_waitcnt lgkmcnt(0)
    v_lshlrev_b32 v48, 16, v20
    v_and_b32 v49, 0xffff0000, v20
    v_lshlrev_b32_e64 v50, 16, v21
    v_and_b32 v51, 0xffff0000, v21
    v_lshlrev_b32_e64 v52, 16, v22
    v_and_b32 v53, 0xffff0000, v22
    v_lshlrev_b32_e64 v54, 16, v23
    v_and_b32 v55, 0xffff0000, v23
    s_add_u32 s96, s28, 0xc0000
    s_addc_u32 s97, s29, 0
    s_and_b32 s97, s97, 0xffff
    s_mov_b32 s98, 0x10000
    s_mov_b32 s99, 0x20000
    v_lshlrev_b32 v81, 4, v1
    s_lshl_b32 s100, s3, 11
    v_add_u32 v81, s100, v81
    v_lshlrev_b32 v80, 3, v1
    s_lshl_b32 s100, s3, 10
    s_add_u32 s100, s100, 131072
    v_add_u32_e64 v80, s100, v80
    s_mov_b32 s101, 0x100000
L_mp0_wf10:
    s_mov_b32 s56, 0
    s_nop 0
    buffer_load_dwordx4 v[96:99], v81, s[96:99], s56 offen offset:0 sc1
    buffer_load_dwordx4 v[100:103], v81, s[96:99], s56 offen offset:1024 sc1
    s_mov_b32 s56, 16384
    buffer_load_dwordx4 v[104:107], v81, s[96:99], s56 offen offset:0 sc1
    buffer_load_dwordx4 v[108:111], v81, s[96:99], s56 offen offset:1024 sc1
    s_mov_b32 s56, 32768
    buffer_load_dwordx4 v[112:115], v81, s[96:99], s56 offen offset:0 sc1
    buffer_load_dwordx4 v[116:119], v81, s[96:99], s56 offen offset:1024 sc1
    s_mov_b32 s56, 49152
    buffer_load_dwordx4 v[120:123], v81, s[96:99], s56 offen offset:0 sc1
    buffer_load_dwordx4 v[124:127], v81, s[96:99], s56 offen offset:1024 sc1
L_mp0_wf10c:
    s_mov_b64 s[50:51], 0
    s_waitcnt vmcnt(7)
    v_cmp_ne_u64 vcc, s[84:85], v[98:99]
    s_or_b64 s[50:51], s[50:51], vcc
    s_waitcnt vmcnt(6)
    v_cmp_ne_u64 vcc, s[84:85], v[102:103]
    s_or_b64 s[50:51], s[50:51], vcc
    s_waitcnt vmcnt(5)
    v_cmp_ne_u64 vcc, s[84:85], v[106:107]
    s_or_b64 s[50:51], s[50:51], vcc
    s_waitcnt vmcnt(4)
    v_cmp_ne_u64 vcc, s[84:85], v[110:111]
    s_or_b64 s[50:51], s[50:51], vcc
    s_waitcnt vmcnt(3)
    v_cmp_ne_u64 vcc, s[84:85], v[114:115]
    s_or_b64 s[50:51], s[50:51], vcc
    s_waitcnt vmcnt(2)
    v_cmp_ne_u64 vcc, s[84:85], v[118:119]
    s_or_b64 s[50:51], s[50:51], vcc
    s_waitcnt vmcnt(1)
    v_cmp_ne_u64 vcc, s[84:85], v[122:123]
    s_or_b64 s[50:51], s[50:51], vcc
    s_waitcnt vmcnt(0)
    v_cmp_ne_u64 vcc, s[84:85], v[126:127]
    s_or_b64 s[50:51], s[50:51], vcc
    s_cbranch_scc0 L_mp0_we11
    s_sub_u32 s101, s101, 1
    s_sleep 1
    s_cmp_lg_u32 s101, 0
    s_cbranch_scc1 L_mp0_wf10
L_mp0_we11:
    v_pk_add_f32 v[96:97], v[96:97], v[104:105]
    v_pk_add_f32 v[112:113], v[112:113], v[120:121]
    v_pk_add_f32 v[64:65], v[96:97], v[112:113]
    v_pk_add_f32 v[100:101], v[100:101], v[108:109]
    v_pk_add_f32 v[116:117], v[116:117], v[124:125]
    v_pk_add_f32 v[66:67], v[100:101], v[116:117]
    v_cvt_pk_bf16_f32 v68, v64, v65
    v_lshlrev_b32_e64 v64, 16, v68
    v_and_b32 v65, 0xffff0000, v68
    v_cvt_pk_bf16_f32 v68, v66, v67
    v_lshlrev_b32_e64 v66, 16, v68
    v_and_b32 v67, 0xffff0000, v68
    v_add_f32 v64, s49, v64
    v_add_f32 v65, s49, v65
    v_add_f32 v66, s49, v66
    v_add_f32 v67, s49, v67
    v_cvt_pk_bf16_f32 v68, v64, v65
    v_lshlrev_b32_e64 v64, 16, v68
    v_and_b32 v65, 0xffff0000, v68
    v_cvt_pk_bf16_f32 v68, v66, v67
    v_lshlrev_b32_e64 v66, 16, v68
    v_and_b32 v67, 0xffff0000, v68
    ds_write_b64 v80, v[64:65]
    ds_write_b64 v80, v[66:67] offset:512
    s_waitcnt lgkmcnt(0)
    s_barrier
    ds_read_b128 v[64:67], v3 offset:4096
    ds_read_b128 v[96:99], v3 offset:0
    ds_read_b128 v[68:71], v3 offset:4128
    ds_read_b128 v[100:103], v3 offset:32
    ds_read_b128 v[72:75], v3 offset:5120
    ds_read_b128 v[104:107], v3 offset:1024
    ds_read_b128 v[76:79], v3 offset:5152
    ds_read_b128 v[108:111], v3 offset:1056
    ds_read_b128 v[80:83], v3 offset:6144
    ds_read_b128 v[112:115], v3 offset:2048
    ds_read_b128 v[84:87], v3 offset:6176
    ds_read_b128 v[116:119], v3 offset:2080
    ds_read_b128 v[88:91], v3 offset:7168
    ds_read_b128 v[120:123], v3 offset:3072
    ds_read_b128 v[92:95], v3 offset:7200
    ds_read_b128 v[124:127], v3 offset:3104
    s_waitcnt lgkmcnt(12)
    v_pk_mul_f32 v[24:25], v[24:25], v[64:65]
    v_pk_mul_f32 v[26:27], v[26:27], v[66:67]
    v_pk_mul_f32 v[28:29], v[28:29], v[68:69]
    v_pk_mul_f32 v[30:31], v[30:31], v[70:71]
    v_cvt_pk_bf16_f32 v8, v24, v25
    v_lshlrev_b32 v24, 16, v8
    v_and_b32 v25, 0xffff0000, v8
    v_cvt_pk_bf16_f32 v9, v26, v27
    v_lshlrev_b32_e64 v26, 16, v9
    v_and_b32 v27, 0xffff0000, v9
    v_cvt_pk_bf16_f32 v10, v28, v29
    v_lshlrev_b32_e64 v28, 16, v10
    v_and_b32 v29, 0xffff0000, v10
    v_cvt_pk_bf16_f32 v11, v30, v31
    v_lshlrev_b32_e64 v30, 16, v11
    v_and_b32 v31, 0xffff0000, v11
    v_pk_add_f32 v[24:25], v[24:25], v[96:97]
    v_pk_add_f32 v[26:27], v[26:27], v[98:99]
    v_pk_add_f32 v[28:29], v[28:29], v[100:101]
    v_pk_add_f32 v[30:31], v[30:31], v[102:103]
    v_cvt_pk_bf16_f32 v8, v24, v25
    v_cvt_pk_bf16_f32 v9, v26, v27
    v_cvt_pk_bf16_f32 v10, v28, v29
    v_cvt_pk_bf16_f32 v11, v30, v31
    buffer_store_dwordx4 v[8:11], v4, s[36:39], s44 offen sc1
    s_add_u32 s44, s44, 16384
    s_waitcnt lgkmcnt(8)
    v_pk_mul_f32 v[32:33], v[32:33], v[72:73]
    v_pk_mul_f32 v[34:35], v[34:35], v[74:75]
    v_pk_mul_f32 v[36:37], v[36:37], v[76:77]
    v_pk_mul_f32 v[38:39], v[38:39], v[78:79]
    v_cvt_pk_bf16_f32 v12, v32, v33
    v_lshlrev_b32 v32, 16, v12
    v_and_b32 v33, 0xffff0000, v12
    v_cvt_pk_bf16_f32 v13, v34, v35
    v_lshlrev_b32_e64 v34, 16, v13
    v_and_b32 v35, 0xffff0000, v13
    v_cvt_pk_bf16_f32 v14, v36, v37
    v_lshlrev_b32_e64 v36, 16, v14
    v_and_b32 v37, 0xffff0000, v14
    v_cvt_pk_bf16_f32 v15, v38, v39
    v_lshlrev_b32_e64 v38, 16, v15
    v_and_b32 v39, 0xffff0000, v15
    v_pk_add_f32 v[32:33], v[32:33], v[104:105]
    v_pk_add_f32 v[34:35], v[34:35], v[106:107]
    v_pk_add_f32 v[36:37], v[36:37], v[108:109]
    v_pk_add_f32 v[38:39], v[38:39], v[110:111]
    v_cvt_pk_bf16_f32 v12, v32, v33
    v_cvt_pk_bf16_f32 v13, v34, v35
    v_cvt_pk_bf16_f32 v14, v36, v37
    v_cvt_pk_bf16_f32 v15, v38, v39
    buffer_store_dwordx4 v[12:15], v4, s[36:39], s44 offen sc1
    s_add_u32 s44, s44, 16384
    s_waitcnt lgkmcnt(4)
    v_pk_mul_f32 v[40:41], v[40:41], v[80:81]
    v_pk_mul_f32 v[42:43], v[42:43], v[82:83]
    v_pk_mul_f32 v[44:45], v[44:45], v[84:85]
    v_pk_mul_f32 v[46:47], v[46:47], v[86:87]
    v_cvt_pk_bf16_f32 v16, v40, v41
    v_lshlrev_b32 v40, 16, v16
    v_and_b32 v41, 0xffff0000, v16
    v_cvt_pk_bf16_f32 v17, v42, v43
    v_lshlrev_b32_e64 v42, 16, v17
    v_and_b32 v43, 0xffff0000, v17
    v_cvt_pk_bf16_f32 v18, v44, v45
    v_lshlrev_b32_e64 v44, 16, v18
    v_and_b32 v45, 0xffff0000, v18
    v_cvt_pk_bf16_f32 v19, v46, v47
    v_lshlrev_b32_e64 v46, 16, v19
    v_and_b32 v47, 0xffff0000, v19
    v_pk_add_f32 v[40:41], v[40:41], v[112:113]
    v_pk_add_f32 v[42:43], v[42:43], v[114:115]
    v_pk_add_f32 v[44:45], v[44:45], v[116:117]
    v_pk_add_f32 v[46:47], v[46:47], v[118:119]
    v_cvt_pk_bf16_f32 v16, v40, v41
    v_cvt_pk_bf16_f32 v17, v42, v43
    v_cvt_pk_bf16_f32 v18, v44, v45
    v_cvt_pk_bf16_f32 v19, v46, v47
    buffer_store_dwordx4 v[16:19], v4, s[36:39], s44 offen sc1
    s_add_u32 s44, s44, 16384
    s_waitcnt lgkmcnt(0)
    v_pk_mul_f32 v[48:49], v[48:49], v[88:89]
    v_pk_mul_f32 v[50:51], v[50:51], v[90:91]
    v_pk_mul_f32 v[52:53], v[52:53], v[92:93]
    v_pk_mul_f32 v[54:55], v[54:55], v[94:95]
    v_cvt_pk_bf16_f32 v20, v48, v49
    v_lshlrev_b32 v48, 16, v20
    v_and_b32 v49, 0xffff0000, v20
    v_cvt_pk_bf16_f32 v21, v50, v51
    v_lshlrev_b32_e64 v50, 16, v21
    v_and_b32 v51, 0xffff0000, v21
    v_cvt_pk_bf16_f32 v22, v52, v53
    v_lshlrev_b32_e64 v52, 16, v22
    v_and_b32 v53, 0xffff0000, v22
    v_cvt_pk_bf16_f32 v23, v54, v55
    v_lshlrev_b32_e64 v54, 16, v23
    v_and_b32 v55, 0xffff0000, v23
    v_pk_add_f32 v[48:49], v[48:49], v[120:121]
    v_pk_add_f32 v[50:51], v[50:51], v[122:123]
    v_pk_add_f32 v[52:53], v[52:53], v[124:125]
    v_pk_add_f32 v[54:55], v[54:55], v[126:127]
    v_cvt_pk_bf16_f32 v20, v48, v49
    v_cvt_pk_bf16_f32 v21, v50, v51
    v_cvt_pk_bf16_f32 v22, v52, v53
    v_cvt_pk_bf16_f32 v23, v54, v55
    buffer_store_dwordx4 v[20:23], v4, s[36:39], s44 offen sc1
    s_add_u32 s44, s44, 16384
    s_add_u32 s96, s28, 0x3a00000
    s_addc_u32 s97, s29, 0
    s_and_b32 s97, s97, 0xffff
    s_mov_b32 s98, 0x200000
    s_mov_b32 s99, 0x20000
    v_mov_b32 v252, s84
    v_mov_b32 v253, s85
    v_mov_b32_e64 v254, 0
    s_waitcnt vmcnt(0)
    s_barrier
    s_cmp_lg_u32 s3, 7
    s_cbranch_scc1 L_mp0_sg12
    s_mov_b64 exec, 1
    buffer_store_dwordx2 v[252:253], v254, s[96:99], s87 offen sc1
    s_mov_b64 exec, -1
L_mp0_sg12:
    s_mov_b64 exec, -1
    s_setprio 0
    s_branch L_qkv_entry
L_qkv_entry:
    v_and_b32_e64 v1, 63, v0
    s_mov_b32 s46, s3
    s_and_b32 s47, s2, 7
    s_lshr_b32 s48, s2, 3
    s_and_b32 s30, s47, 1
    s_lshl_b32 s30, s30, 3
    s_and_b32 s49, s48, 7
    s_add_u32 s30, s30, s49
    s_lshr_b32 s31, s47, 1
    s_mul_i32 s31, s31, 4
    s_lshr_b32 s49, s48, 3
    s_add_u32 s31, s31, s49
    s_lshl_b32 s100, s31, 8
    s_lshl_b32 s101, s30, 4
    s_add_u32 s100, s100, s101
    s_add_u32 s100, s100, 8192
    s_lshl_b32 s87, s100, 5
    s_cmp_ge_u32 s46, 4
    s_cbranch_scc1 L_qkv_comp
    s_mul_i32 s50, s30, 262144
    s_mul_i32 s51, s46, 2
    s_lshr_b32 s52, s51, 1
    s_and_b32 s51, s51, 1
    s_mul_i32 s52, s52, 65536
    s_lshl_b32 s51, s51, 10
    s_add_u32 s50, s50, s52
    s_add_u32 s50, s50, s51
    v_lshl_add_u32 v8, v1, 4, s50
    v_add_u32 v9, 1024, v8
    v_lshrrev_b32 v2, 4, v1
    v_bfe_u32 v3, v1, 2, 2
    v_and_b32 v4, 3, v1
    v_and_b32 v5, 2, v2
    v_xor_b32 v4, v4, v5
    v_lshrrev_b32 v5, 1, v2
    v_lshl_add_u32 v5, v5, 2, v3
    v_mul_u32_u24 v5, 6144, v5
    v_and_b32_e64 v6, 1, v2
    v_lshl_add_u32 v5, v6, 6, v5
    v_lshl_add_u32 v5, v4, 4, v5
    s_mul_i32 s50, s46, 49152
    s_mul_i32 s51, s31, 128
    s_add_u32 s50, s50, s51
    v_add_u32 v5, s50, v5
    v_add_u32_e64 v10, 0, v5
    v_add_u32 v11, 2048, v5
    v_add_u32 v12, 4096, v5
    s_mul_i32 s55, s46, 2048
    s_mul_i32 s56, s46, 3072
    s_add_u32 s56, s56, 8192
    s_waitcnt lgkmcnt(0)
    s_mov_b32 s36, s6
    s_and_b32 s37, s7, 0xffff
    s_mov_b32 s38, 0x600000
    s_mov_b32 s39, 0x20000
    s_add_u32 s32, s28, 0x100000
    s_addc_u32 s33, s29, 0
    s_and_b32 s33, s33, 0xffff
    s_mov_b32 s34, 0x400000
    s_mov_b32 s35, 0x20000
    s_mul_i32 s54, s31, 1
    s_add_u32 s54, s54, s30
    s_add_u32 s57, s54, 0
    s_and_b32 s57, s57, 3
    s_mul_i32 s57, s57, 196608
    s_add_u32 m0, s56, 0
    s_nop 0
    buffer_load_dwordx4 v10, s[36:39], s57 offen lds
    s_add_u32 m0, s56, 1024
    s_nop 0
    buffer_load_dwordx4 v11, s[36:39], s57 offen lds
    s_add_u32 m0, s56, 2048
    s_nop 0
    buffer_load_dwordx4 v12, s[36:39], s57 offen lds
    s_add_u32 s57, s54, 1
    s_and_b32 s57, s57, 3
    s_mul_i32 s57, s57, 196608
    s_add_u32 m0, s56, 20480
    s_nop 0
    buffer_load_dwordx4 v10, s[36:39], s57 offen lds
    s_add_u32 m0, s56, 21504
    s_nop 0
    buffer_load_dwordx4 v11, s[36:39], s57 offen lds
    s_add_u32 m0, s56, 22528
    s_nop 0
    buffer_load_dwordx4 v12, s[36:39], s57 offen lds
    s_add_u32 s57, s54, 2
    s_and_b32 s57, s57, 3
    s_mul_i32 s57, s57, 196608
    s_add_u32 m0, s56, 40960
    s_nop 0
    buffer_load_dwordx4 v10, s[36:39], s57 offen lds
    s_add_u32 m0, s56, 41984
    s_nop 0
    buffer_load_dwordx4 v11, s[36:39], s57 offen lds
    s_add_u32 m0, s56, 43008
    s_nop 0
    buffer_load_dwordx4 v12, s[36:39], s57 offen lds
    s_add_u32 s57, s54, 3
    s_and_b32 s57, s57, 3
    s_mul_i32 s57, s57, 196608
    s_add_u32 m0, s56, 61440
    s_nop 0
    buffer_load_dwordx4 v10, s[36:39], s57 offen lds
    s_add_u32 m0, s56, 62464
    s_nop 0
    buffer_load_dwordx4 v11, s[36:39], s57 offen lds
    s_add_u32 m0, s56, 63488
    s_nop 0
    buffer_load_dwordx4 v12, s[36:39], s57 offen lds
    s_barrier
    s_add_u32 s57, s54, 0
    s_and_b32 s57, s57, 3
    s_mul_i32 s57, s57, 2048
    s_add_u32 m0, s55, 0
    s_nop 0
    buffer_load_dwordx4 v8, s[32:35], s57 offen sc1 lds
    s_add_u32 m0, s55, 1024
    s_nop 0
    buffer_load_dwordx4 v9, s[32:35], s57 offen sc1 lds
    s_add_u32 s57, s54, 1
    s_and_b32 s57, s57, 3
    s_mul_i32 s57, s57, 2048
    s_add_u32 m0, s55, 20480
    s_nop 0
    buffer_load_dwordx4 v8, s[32:35], s57 offen sc1 lds
    s_add_u32 m0, s55, 21504
    s_nop 0
    buffer_load_dwordx4 v9, s[32:35], s57 offen sc1 lds
    s_waitcnt vmcnt(2)
    s_barrier
    s_add_u32 s57, s54, 2
    s_and_b32 s57, s57, 3
    s_mul_i32 s57, s57, 2048
    s_add_u32 m0, s55, 40960
    s_nop 0
    buffer_load_dwordx4 v8, s[32:35], s57 offen sc1 lds
    s_add_u32 m0, s55, 41984
    s_nop 0
    buffer_load_dwordx4 v9, s[32:35], s57 offen sc1 lds
    s_add_u32 s57, s54, 3
    s_and_b32 s57, s57, 3
    s_mul_i32 s57, s57, 2048
    s_add_u32 m0, s55, 61440
    s_nop 0
    buffer_load_dwordx4 v8, s[32:35], s57 offen sc1 lds
    s_add_u32 m0, s55, 62464
    s_nop 0
    buffer_load_dwordx4 v9, s[32:35], s57 offen sc1 lds
    s_waitcnt vmcnt(4)
    s_barrier
    s_add_u32 s57, s54, 4
    s_and_b32 s57, s57, 3
    s_mul_i32 s57, s57, 196608
    s_add_u32 s57, s57, 786432
    s_add_u32 m0, s56, 0
    s_nop 0
    buffer_load_dwordx4 v10, s[36:39], s57 offen lds
    s_add_u32 m0, s56, 1024
    s_nop 0
    buffer_load_dwordx4 v11, s[36:39], s57 offen lds
    s_add_u32 m0, s56, 2048
    s_nop 0
    buffer_load_dwordx4 v12, s[36:39], s57 offen lds
    s_add_u32 s57, s54, 4
    s_and_b32 s57, s57, 3
    s_mul_i32 s57, s57, 2048
    s_add_u32 s57, s57, 8192
    s_add_u32 m0, s55, 0
    s_nop 0
    buffer_load_dwordx4 v8, s[32:35], s57 offen sc1 lds
    s_add_u32 m0, s55, 1024
    s_nop 0
    buffer_load_dwordx4 v9, s[32:35], s57 offen sc1 lds
    s_waitcnt vmcnt(7)
    s_barrier
    s_add_u32 s57, s54, 5
    s_and_b32 s57, s57, 3
    s_mul_i32 s57, s57, 196608
    s_add_u32 s57, s57, 786432
    s_add_u32 m0, s56, 20480
    s_nop 0
    buffer_load_dwordx4 v10, s[36:39], s57 offen lds
    s_add_u32 m0, s56, 21504
    s_nop 0
    buffer_load_dwordx4 v11, s[36:39], s57 offen lds
    s_add_u32 m0, s56, 22528
    s_nop 0
    buffer_load_dwordx4 v12, s[36:39], s57 offen lds
    s_add_u32 s57, s54, 5
    s_and_b32 s57, s57, 3
    s_mul_i32 s57, s57, 2048
    s_add_u32 s57, s57, 8192
    s_add_u32 m0, s55, 20480
    s_nop 0
    buffer_load_dwordx4 v8, s[32:35], s57 offen sc1 lds
    s_add_u32 m0, s55, 21504
    s_nop 0
    buffer_load_dwordx4 v9, s[32:35], s57 offen sc1 lds
    s_waitcnt vmcnt(10)
    s_barrier
    s_add_u32 s57, s54, 6
    s_and_b32 s57, s57, 3
    s_mul_i32 s57, s57, 196608
    s_add_u32 s57, s57, 786432
    s_add_u32 m0, s56, 40960
    s_nop 0
    buffer_load_dwordx4 v10, s[36:39], s57 offen lds
    s_add_u32 m0, s56, 41984
    s_nop 0
    buffer_load_dwordx4 v11, s[36:39], s57 offen lds
    s_add_u32 m0, s56, 43008
    s_nop 0
    buffer_load_dwordx4 v12, s[36:39], s57 offen lds
    s_add_u32 s57, s54, 6
    s_and_b32 s57, s57, 3
    s_mul_i32 s57, s57, 2048
    s_add_u32 s57, s57, 8192
    s_add_u32 m0, s55, 40960
    s_nop 0
    buffer_load_dwordx4 v8, s[32:35], s57 offen sc1 lds
    s_add_u32 m0, s55, 41984
    s_nop 0
    buffer_load_dwordx4 v9, s[32:35], s57 offen sc1 lds
    s_add_u32 s60, s55, 81920
    s_add_u32 s55, s55, 61440
    s_add_u32 s56, s56, 61440
    s_mov_b32 s57, 14336
    s_mov_b32 s58, 1376256
    s_mov_b32 s59, 7
L_qkv_lloop:
    s_add_u32 s57, s54, s59
    s_and_b32 s57, s57, 3
    s_andn2_b32 s58, s59, 3
    s_or_b32 s57, s57, s58
    s_mul_i32 s58, s57, 196608
    s_mul_i32 s57, s57, 2048
    s_waitcnt vmcnt(10)
    s_barrier
    s_add_u32 m0, s56, 0
    s_nop 0
    buffer_load_dwordx4 v10, s[36:39], s58 offen lds
    s_add_u32 m0, s56, 1024
    s_nop 0
    buffer_load_dwordx4 v11, s[36:39], s58 offen lds
    s_add_u32 m0, s56, 2048
    s_nop 0
    buffer_load_dwordx4 v12, s[36:39], s58 offen lds
    s_add_u32 m0, s55, 0
    s_nop 0
    buffer_load_dwordx4 v8, s[32:35], s57 offen sc1 lds
    s_add_u32 m0, s55, 1024
    s_nop 0
    buffer_load_dwordx4 v9, s[32:35], s57 offen sc1 lds
    s_add_u32 s57, s57, 2048
    s_add_u32 s58, s58, 196608
    s_add_u32 s55, s55, 20480
    s_add_u32 s56, s56, 20480
    s_cmp_eq_u32 s55, s60
    s_cselect_b32 s61, 81920, 0
    s_sub_u32 s55, s55, s61
    s_sub_u32 s56, s56, s61
    s_add_u32 s59, s59, 1
    s_cmp_lt_u32 s59, 32
    s_cbranch_scc1 L_qkv_lloop
    s_and_b32 s44, s46, 1
    s_lshl_b32 s44, s44, 13
    s_cmp_ge_u32 s2, 32
    s_cbranch_scc1 L_mp0_ct13
    s_getpc_b64 s[64:65]
L_mp0_pc14:
    s_add_u32 s64, s64, L_qkv_epi-L_mp0_pc14
    s_addc_u32 s65, s65, 0
    v_and_b32 v60, 63, v0
    v_lshl_add_u32 v60, v60, 7, s44
    v_min_u32 v60, L_text_end-L_qkv_epi-4, v60
    v_mov_b32 v61, s65
    v_add_co_u32 v60, vcc, s64, v60
    s_nop 1
    v_addc_co_u32 v61, vcc, 0, v61, vcc
    global_load_dword v62, v[60:61], off
L_mp0_ct13:
    s_waitcnt vmcnt(10)
    s_barrier
    s_waitcnt vmcnt(5)
    s_barrier
    s_waitcnt vmcnt(0)
    s_barrier
    s_barrier
    s_waitcnt vmcnt(0)
    s_mov_b64 exec, -1
    s_setprio 0
    s_branch L_attn_entry
L_qkv_comp:
    s_setprio 1
    s_sub_u32 s46, s46, 4
    s_lshr_b32 s50, s46, 1
    s_and_b32 s51, s46, 1
    v_and_b32 v3, 31, v1
    v_lshrrev_b32 v4, 5, v1
    v_and_b32 v5, 15, v1
    v_lshrrev_b32_e64 v6, 4, v1
    s_mul_i32 s52, s50, 4096
    v_lshl_add_u32 v7, v5, 4, s52
    v_lshl_add_u32 v184, v6, 9, v7
    v_mul_u32_u24 v5, 6144, v4
    v_and_b32_e64 v6, 1, v6
    v_lshl_add_u32 v5, v6, 9, v5
    v_lshl_add_u32 v5, v6, 5, v5
    v_bfe_u32 v6, v1, 2, 2
    v_lshl_add_u32 v5, v6, 6, v5
    v_bfe_u32 v6, v1, 1, 1
    v_lshl_add_u32 v5, v6, 3, v5
    v_and_b32_e64 v6, 1, v1
    v_lshl_add_u32 v5, v6, 4, v5
    s_lshl_b32 s52, s51, 8
    s_add_u32 s52, s52, 8192
    v_add_u32 v186, s52, v5
    v_xor_b32 v187, 32, v186
    s_waitcnt lgkmcnt(0)
    s_add_u32 s32, s28, 0x500000
    s_addc_u32 s33, s29, 0
    s_and_b32 s33, s33, 0xffff
    s_mov_b32 s34, 0x400000
    s_mov_b32 s35, 0x20000
    s_add_u32 s36, s28, 0x900000
    s_addc_u32 s37, s29, 0
    s_and_b32 s37, s37, 0xffff
    s_mov_b32 s38, 0x800000
    s_mov_b32 s39, 0x20000
    v_lshlrev_b32 v190, 4, v1
    v_and_b32 v5, 3, v1
    v_lshl_add_u32 v5, v4, 4, v5
    v_bfe_u32 v6, v1, 2, 1
    v_lshl_add_u32 v5, v6, 3, v5
    v_bfe_u32 v6, v1, 3, 1
    v_lshl_add_u32 v5, v6, 2, v5
    v_bfe_u32 v6, v1, 4, 1
    v_lshl_add_u32 v5, v6, 5, v5
    v_lshlrev_b32 v191, 4, v5
    s_lshl_b32 s60, s31, 1
    s_add_u32 s60, s60, s51
    s_lshl_b32 s60, s60, 6
    s_lshl_b32 s61, s30, 2
    s_add_u32 s60, s60, s61
    s_lshl_b32 s61, s50, 1
    s_add_u32 s60, s60, s61
    s_lshl_b32 s61, s60, 11
    s_lshl_b32 s62, s60, 12
    s_add_u32 s63, s62, 4096
    s_mov_b32 s66, 0x3e8293ee
    s_mov_b32 s67, 0x3e8293ee
    s_mov_b32 s53, 0
    v_add_u32 v185, s53, v184
    v_add_u32 v188, s53, v186
    v_add_u32 v189, s53, v187
    s_cmp_lg_u32 s3, 4
    s_cbranch_scc1 L_mp0_wd15
    s_add_u32 s96, s28, 0x3a00000
    s_addc_u32 s97, s29, 0
    s_and_b32 s97, s97, 0xffff
    s_mov_b32 s98, 0x200000
    s_mov_b32 s99, 0x20000
    s_lshl_b32 s100, s30, 8
    s_add_u32 s100, s100, 0
    s_lshl_b32 s100, s100, 5
    v_lshlrev_b32_e64 v254, 7, v1
    s_mov_b32 s101, 0x100000
    s_bfm_b64 exec, 8, 0
L_mp0_wf16:
    buffer_load_dwordx2 v[252:253], v254, s[96:99], s100 offen sc1
    s_waitcnt vmcnt(0)
    v_cmp_ne_u64 vcc, s[84:85], v[252:253]
    s_sub_u32 s101, s101, 1
    s_nop 3
    s_cbranch_vccz L_mp0_we17
    s_mov_b64 exec, vcc
    s_sleep 1
    s_cmp_lg_u32 s101, 0
    s_cbranch_scc1 L_mp0_wf16
L_mp0_we17:
    s_mov_b64 exec, -1
L_mp0_wd15:
    s_barrier
    s_barrier
    s_nop 0
    ds_read_b128 v[104:107], v185 offset:0
    ds_read_b64_tr_b16 v[136:137], v188 offset:0
    ds_read_b64_tr_b16 v[138:139], v188 offset:3072
    ds_read_b128 v[108:111], v185 offset:256
    ds_read_b128 v[112:115], v185 offset:2048
    ds_read_b128 v[116:119], v185 offset:2304
    ds_read_b64_tr_b16 v[140:141], v189 offset:0
    ds_read_b64_tr_b16 v[142:143], v189 offset:3072
    ds_read_b64_tr_b16 v[144:145], v188 offset:1024
    ds_read_b64_tr_b16 v[146:147], v188 offset:4096
    ds_read_b64_tr_b16 v[148:149], v189 offset:1024
    ds_read_b64_tr_b16 v[150:151], v189 offset:4096
    ds_read_b64_tr_b16 v[152:153], v188 offset:2048
    ds_read_b64_tr_b16 v[154:155], v188 offset:5120
    ds_read_b64_tr_b16 v[156:157], v189 offset:2048
    ds_read_b64_tr_b16 v[158:159], v189 offset:5120
    s_add_u32 s53, s53, 20480
    s_cmp_eq_u32 s53, 81920
    s_cselect_b32 s53, 0, s53
    v_add_u32 v185, s53, v184
    v_add_u32 v188, s53, v186
    v_add_u32 v189, s53, v187
    s_waitcnt lgkmcnt(0)
    s_barrier
    v_mfma_f32_16x16x32_bf16 v[8:11], v[136:139], v[104:107], 0
    ds_read_b128 v[120:123], v185 offset:0
    v_mfma_f32_16x16x32_bf16 v[12:15], v[136:139], v[108:111], 0
    v_mfma_f32_16x16x32_bf16 v[56:59], v[136:139], v[112:115], 0
    ds_read_b64_tr_b16 v[160:161], v188 offset:0
    v_mfma_f32_16x16x32_bf16 v[60:63], v[136:139], v[116:119], 0
    v_mfma_f32_16x16x32_bf16 v[16:19], v[140:143], v[104:107], 0
    ds_read_b64_tr_b16 v[162:163], v188 offset:3072
    v_mfma_f32_16x16x32_bf16 v[20:23], v[140:143], v[108:111], 0
    v_mfma_f32_16x16x32_bf16 v[64:67], v[140:143], v[112:115], 0
    ds_read_b128 v[124:127], v185 offset:256
    v_mfma_f32_16x16x32_bf16 v[68:71], v[140:143], v[116:119], 0
    v_mfma_f32_16x16x32_bf16 v[24:27], v[144:147], v[104:107], 0
    ds_read_b128 v[128:131], v185 offset:2048
    v_mfma_f32_16x16x32_bf16 v[28:31], v[144:147], v[108:111], 0
    v_mfma_f32_16x16x32_bf16 v[72:75], v[144:147], v[112:115], 0
    ds_read_b128 v[132:135], v185 offset:2304
    v_mfma_f32_16x16x32_bf16 v[76:79], v[144:147], v[116:119], 0
    v_mfma_f32_16x16x32_bf16 v[32:35], v[148:151], v[104:107], 0
    ds_read_b64_tr_b16 v[164:165], v189 offset:0
    v_mfma_f32_16x16x32_bf16 v[36:39], v[148:151], v[108:111], 0
    v_mfma_f32_16x16x32_bf16 v[80:83], v[148:151], v[112:115], 0
    ds_read_b64_tr_b16 v[166:167], v189 offset:3072
    v_mfma_f32_16x16x32_bf16 v[84:87], v[148:151], v[116:119], 0
    v_mfma_f32_16x16x32_bf16 v[40:43], v[104:107], v[152:155], 0
    ds_read_b64_tr_b16 v[168:169], v188 offset:1024
    v_mfma_f32_16x16x32_bf16 v[48:51], v[108:111], v[152:155], 0
    v_mfma_f32_16x16x32_bf16 v[88:91], v[112:115], v[152:155], 0
    ds_read_b64_tr_b16 v[170:171], v188 offset:4096
    v_mfma_f32_16x16x32_bf16 v[96:99], v[116:119], v[152:155], 0
    v_mfma_f32_16x16x32_bf16 v[44:47], v[104:107], v[156:159], 0
    ds_read_b64_tr_b16 v[172:173], v189 offset:1024
    v_mfma_f32_16x16x32_bf16 v[52:55], v[108:111], v[156:159], 0
    v_mfma_f32_16x16x32_bf16 v[92:95], v[112:115], v[156:159], 0
    ds_read_b64_tr_b16 v[174:175], v189 offset:4096
    v_mfma_f32_16x16x32_bf16 v[100:103], v[116:119], v[156:159], 0
    ds_read_b64_tr_b16 v[176:177], v188 offset:2048
    ds_read_b64_tr_b16 v[178:179], v188 offset:5120
    ds_read_b64_tr_b16 v[180:181], v189 offset:2048
    ds_read_b64_tr_b16 v[182:183], v189 offset:5120
    s_add_u32 s53, s53, 20480
    s_cmp_eq_u32 s53, 81920
    s_cselect_b32 s53, 0, s53
    v_add_u32 v185, s53, v184
    v_add_u32 v188, s53, v186
    v_add_u32_e64 v189, s53, v187
    s_mov_b32 s54, 4
L_qkv_loop:
    s_waitcnt lgkmcnt(0)
    s_barrier
    v_mfma_f32_16x16x32_bf16 v[8:11], v[160:163], v[120:123], v[8:11]
    ds_read_b128 v[104:107], v185 offset:0
    v_mfma_f32_16x16x32_bf16 v[12:15], v[160:163], v[124:127], v[12:15]
    v_mfma_f32_16x16x32_bf16 v[56:59], v[160:163], v[128:131], v[56:59]
    ds_read_b64_tr_b16 v[136:137], v188 offset:0
    v_mfma_f32_16x16x32_bf16 v[60:63], v[160:163], v[132:135], v[60:63]
    v_mfma_f32_16x16x32_bf16 v[16:19], v[164:167], v[120:123], v[16:19]
    ds_read_b64_tr_b16 v[138:139], v188 offset:3072
    v_mfma_f32_16x16x32_bf16 v[20:23], v[164:167], v[124:127], v[20:23]
    v_mfma_f32_16x16x32_bf16 v[64:67], v[164:167], v[128:131], v[64:67]
    ds_read_b128 v[108:111], v185 offset:256
    v_mfma_f32_16x16x32_bf16 v[68:71], v[164:167], v[132:135], v[68:71]
    v_mfma_f32_16x16x32_bf16 v[24:27], v[168:171], v[120:123], v[24:27]
    ds_read_b128 v[112:115], v185 offset:2048
    v_mfma_f32_16x16x32_bf16 v[28:31], v[168:171], v[124:127], v[28:31]
    v_mfma_f32_16x16x32_bf16 v[72:75], v[168:171], v[128:131], v[72:75]
    ds_read_b128 v[116:119], v185 offset:2304
    v_mfma_f32_16x16x32_bf16 v[76:79], v[168:171], v[132:135], v[76:79]
    v_mfma_f32_16x16x32_bf16 v[32:35], v[172:175], v[120:123], v[32:35]
    ds_read_b64_tr_b16 v[140:141], v189 offset:0
    v_mfma_f32_16x16x32_bf16 v[36:39], v[172:175], v[124:127], v[36:39]
    v_mfma_f32_16x16x32_bf16 v[80:83], v[172:175], v[128:131], v[80:83]
    ds_read_b64_tr_b16 v[142:143], v189 offset:3072
    v_mfma_f32_16x16x32_bf16 v[84:87], v[172:175], v[132:135], v[84:87]
    v_mfma_f32_16x16x32_bf16 v[40:43], v[120:123], v[176:179], v[40:43]
    ds_read_b64_tr_b16 v[144:145], v188 offset:1024
    v_mfma_f32_16x16x32_bf16 v[48:51], v[124:127], v[176:179], v[48:51]
    v_mfma_f32_16x16x32_bf16 v[88:91], v[128:131], v[176:179], v[88:91]
    ds_read_b64_tr_b16 v[146:147], v188 offset:4096
    v_mfma_f32_16x16x32_bf16 v[96:99], v[132:135], v[176:179], v[96:99]
    v_mfma_f32_16x16x32_bf16 v[44:47], v[120:123], v[180:183], v[44:47]
    ds_read_b64_tr_b16 v[148:149], v189 offset:1024
    v_mfma_f32_16x16x32_bf16 v[52:55], v[124:127], v[180:183], v[52:55]
    v_mfma_f32_16x16x32_bf16 v[92:95], v[128:131], v[180:183], v[92:95]
    ds_read_b64_tr_b16 v[150:151], v189 offset:4096
    v_mfma_f32_16x16x32_bf16 v[100:103], v[132:135], v[180:183], v[100:103]
    ds_read_b64_tr_b16 v[152:153], v188 offset:2048
    ds_read_b64_tr_b16 v[154:155], v188 offset:5120
    ds_read_b64_tr_b16 v[156:157], v189 offset:2048
    ds_read_b64_tr_b16 v[158:159], v189 offset:5120
    s_add_u32 s53, s53, 20480
    s_cmp_eq_u32 s53, 81920
    s_cselect_b32 s53, 0, s53
    v_add_u32 v185, s53, v184
    v_add_u32 v188, s53, v186
    v_add_u32 v189, s53, v187
    s_waitcnt lgkmcnt(0)
    s_barrier
    v_mfma_f32_16x16x32_bf16 v[8:11], v[136:139], v[104:107], v[8:11]
    ds_read_b128 v[120:123], v185 offset:0
    v_mfma_f32_16x16x32_bf16 v[12:15], v[136:139], v[108:111], v[12:15]
    v_mfma_f32_16x16x32_bf16 v[56:59], v[136:139], v[112:115], v[56:59]
    ds_read_b64_tr_b16 v[160:161], v188 offset:0
    v_mfma_f32_16x16x32_bf16 v[60:63], v[136:139], v[116:119], v[60:63]
    v_mfma_f32_16x16x32_bf16 v[16:19], v[140:143], v[104:107], v[16:19]
    ds_read_b64_tr_b16 v[162:163], v188 offset:3072
    v_mfma_f32_16x16x32_bf16 v[20:23], v[140:143], v[108:111], v[20:23]
    v_mfma_f32_16x16x32_bf16 v[64:67], v[140:143], v[112:115], v[64:67]
    ds_read_b128 v[124:127], v185 offset:256
    v_mfma_f32_16x16x32_bf16 v[68:71], v[140:143], v[116:119], v[68:71]
    v_mfma_f32_16x16x32_bf16 v[24:27], v[144:147], v[104:107], v[24:27]
    ds_read_b128 v[128:131], v185 offset:2048
    v_mfma_f32_16x16x32_bf16 v[28:31], v[144:147], v[108:111], v[28:31]
    v_mfma_f32_16x16x32_bf16 v[72:75], v[144:147], v[112:115], v[72:75]
    ds_read_b128 v[132:135], v185 offset:2304
    v_mfma_f32_16x16x32_bf16 v[76:79], v[144:147], v[116:119], v[76:79]
    v_mfma_f32_16x16x32_bf16 v[32:35], v[148:151], v[104:107], v[32:35]
    ds_read_b64_tr_b16 v[164:165], v189 offset:0
    v_mfma_f32_16x16x32_bf16 v[36:39], v[148:151], v[108:111], v[36:39]
    v_mfma_f32_16x16x32_bf16 v[80:83], v[148:151], v[112:115], v[80:83]
    ds_read_b64_tr_b16 v[166:167], v189 offset:3072
    v_mfma_f32_16x16x32_bf16 v[84:87], v[148:151], v[116:119], v[84:87]
    v_mfma_f32_16x16x32_bf16 v[40:43], v[104:107], v[152:155], v[40:43]
    ds_read_b64_tr_b16 v[168:169], v188 offset:1024
    v_mfma_f32_16x16x32_bf16 v[48:51], v[108:111], v[152:155], v[48:51]
    v_mfma_f32_16x16x32_bf16 v[88:91], v[112:115], v[152:155], v[88:91]
    ds_read_b64_tr_b16 v[170:171], v188 offset:4096
    v_mfma_f32_16x16x32_bf16 v[96:99], v[116:119], v[152:155], v[96:99]
    v_mfma_f32_16x16x32_bf16 v[44:47], v[104:107], v[156:159], v[44:47]
    ds_read_b64_tr_b16 v[172:173], v189 offset:1024
    v_mfma_f32_16x16x32_bf16 v[52:55], v[108:111], v[156:159], v[52:55]
    v_mfma_f32_16x16x32_bf16 v[92:95], v[112:115], v[156:159], v[92:95]
    ds_read_b64_tr_b16 v[174:175], v189 offset:4096
    v_mfma_f32_16x16x32_bf16 v[100:103], v[116:119], v[156:159], v[100:103]
    ds_read_b64_tr_b16 v[176:177], v188 offset:2048
    ds_read_b64_tr_b16 v[178:179], v188 offset:5120
    ds_read_b64_tr_b16 v[180:181], v189 offset:2048
    ds_read_b64_tr_b16 v[182:183], v189 offset:5120
    s_add_u32 s53, s53, 20480
    s_cmp_eq_u32 s53, 81920
    s_cselect_b32 s53, 0, s53
    v_add_u32 v185, s53, v184
    v_add_u32 v188, s53, v186
    v_add_u32 v189, s53, v187
    s_sub_u32 s54, s54, 1
    s_cmp_lg_u32 s54, 0
    s_cbranch_scc1 L_qkv_loop
    s_mov_b32 s54, 11
L_qkv_loop1:
    s_waitcnt lgkmcnt(0)
    s_barrier
    v_mfma_f32_16x16x32_bf16 v[8:11], v[160:163], v[120:123], v[8:11]
    ds_read_b128 v[104:107], v185 offset:0
    v_mfma_f32_16x16x32_bf16 v[12:15], v[160:163], v[124:127], v[12:15]
    ds_read_b64_tr_b16 v[136:137], v188 offset:0
    v_mfma_f32_16x16x32_bf16 v[56:59], v[160:163], v[128:131], v[56:59]
    ds_read_b64_tr_b16 v[138:139], v188 offset:3072
    v_mfma_f32_16x16x32_bf16 v[60:63], v[160:163], v[132:135], v[60:63]
    ds_read_b128 v[108:111], v185 offset:256
    v_mfma_f32_16x16x32_bf16 v[16:19], v[164:167], v[120:123], v[16:19]
    ds_read_b128 v[112:115], v185 offset:2048
    v_mfma_f32_16x16x32_bf16 v[20:23], v[164:167], v[124:127], v[20:23]
    ds_read_b128 v[116:119], v185 offset:2304
    v_mfma_f32_16x16x32_bf16 v[64:67], v[164:167], v[128:131], v[64:67]
    ds_read_b64_tr_b16 v[140:141], v189 offset:0
    v_mfma_f32_16x16x32_bf16 v[68:71], v[164:167], v[132:135], v[68:71]
    ds_read_b64_tr_b16 v[142:143], v189 offset:3072
    v_mfma_f32_16x16x32_bf16 v[24:27], v[168:171], v[120:123], v[24:27]
    ds_read_b64_tr_b16 v[144:145], v188 offset:1024
    v_mfma_f32_16x16x32_bf16 v[28:31], v[168:171], v[124:127], v[28:31]
    ds_read_b64_tr_b16 v[146:147], v188 offset:4096
    v_mfma_f32_16x16x32_bf16 v[72:75], v[168:171], v[128:131], v[72:75]
    ds_read_b64_tr_b16 v[148:149], v189 offset:1024
    v_mfma_f32_16x16x32_bf16 v[76:79], v[168:171], v[132:135], v[76:79]
    ds_read_b64_tr_b16 v[150:151], v189 offset:4096
    v_mfma_f32_16x16x32_bf16 v[32:35], v[172:175], v[120:123], v[32:35]
    ds_read_b64_tr_b16 v[152:153], v188 offset:2048
    v_mfma_f32_16x16x32_bf16 v[36:39], v[172:175], v[124:127], v[36:39]
    ds_read_b64_tr_b16 v[154:155], v188 offset:5120
    v_mfma_f32_16x16x32_bf16 v[80:83], v[172:175], v[128:131], v[80:83]
    ds_read_b64_tr_b16 v[156:157], v189 offset:2048
    v_mfma_f32_16x16x32_bf16 v[84:87], v[172:175], v[132:135], v[84:87]
    ds_read_b64_tr_b16 v[158:159], v189 offset:5120
    v_mfma_f32_16x16x32_bf16 v[40:43], v[120:123], v[176:179], v[40:43]
    s_add_u32 s53, s53, 20480
    s_cmp_eq_u32 s53, 81920
    v_mfma_f32_16x16x32_bf16 v[48:51], v[124:127], v[176:179], v[48:51]
    s_cselect_b32 s53, 0, s53
    v_add_u32 v185, s53, v184
    v_mfma_f32_16x16x32_bf16 v[88:91], v[128:131], v[176:179], v[88:91]
    v_add_u32 v188, s53, v186
    v_add_u32 v189, s53, v187
    v_mfma_f32_16x16x32_bf16 v[96:99], v[132:135], v[176:179], v[96:99]
    v_mfma_f32_16x16x32_bf16 v[44:47], v[120:123], v[180:183], v[44:47]
    v_mfma_f32_16x16x32_bf16 v[52:55], v[124:127], v[180:183], v[52:55]
    v_mfma_f32_16x16x32_bf16 v[92:95], v[128:131], v[180:183], v[92:95]
    v_mfma_f32_16x16x32_bf16 v[100:103], v[132:135], v[180:183], v[100:103]
    s_waitcnt lgkmcnt(0)
    s_barrier
    v_mfma_f32_16x16x32_bf16 v[8:11], v[136:139], v[104:107], v[8:11]
    ds_read_b128 v[120:123], v185 offset:0
    v_mfma_f32_16x16x32_bf16 v[12:15], v[136:139], v[108:111], v[12:15]
    ds_read_b64_tr_b16 v[160:161], v188 offset:0
    v_mfma_f32_16x16x32_bf16 v[56:59], v[136:139], v[112:115], v[56:59]
    ds_read_b64_tr_b16 v[162:163], v188 offset:3072
    v_mfma_f32_16x16x32_bf16 v[60:63], v[136:139], v[116:119], v[60:63]
    ds_read_b128 v[124:127], v185 offset:256
    v_mfma_f32_16x16x32_bf16 v[16:19], v[140:143], v[104:107], v[16:19]
    ds_read_b128 v[128:131], v185 offset:2048
    v_mfma_f32_16x16x32_bf16 v[20:23], v[140:143], v[108:111], v[20:23]
    ds_read_b128 v[132:135], v185 offset:2304
    v_mfma_f32_16x16x32_bf16 v[64:67], v[140:143], v[112:115], v[64:67]
    ds_read_b64_tr_b16 v[164:165], v189 offset:0
    v_mfma_f32_16x16x32_bf16 v[68:71], v[140:143], v[116:119], v[68:71]
    ds_read_b64_tr_b16 v[166:167], v189 offset:3072
    v_mfma_f32_16x16x32_bf16 v[24:27], v[144:147], v[104:107], v[24:27]
    ds_read_b64_tr_b16 v[168:169], v188 offset:1024
    v_mfma_f32_16x16x32_bf16 v[28:31], v[144:147], v[108:111], v[28:31]
    ds_read_b64_tr_b16 v[170:171], v188 offset:4096
    v_mfma_f32_16x16x32_bf16 v[72:75], v[144:147], v[112:115], v[72:75]
    ds_read_b64_tr_b16 v[172:173], v189 offset:1024
    v_mfma_f32_16x16x32_bf16 v[76:79], v[144:147], v[116:119], v[76:79]
    ds_read_b64_tr_b16 v[174:175], v189 offset:4096
    v_mfma_f32_16x16x32_bf16 v[32:35], v[148:151], v[104:107], v[32:35]
    ds_read_b64_tr_b16 v[176:177], v188 offset:2048
    v_mfma_f32_16x16x32_bf16 v[36:39], v[148:151], v[108:111], v[36:39]
    ds_read_b64_tr_b16 v[178:179], v188 offset:5120
    v_mfma_f32_16x16x32_bf16 v[80:83], v[148:151], v[112:115], v[80:83]
    ds_read_b64_tr_b16 v[180:181], v189 offset:2048
    v_mfma_f32_16x16x32_bf16 v[84:87], v[148:151], v[116:119], v[84:87]
    ds_read_b64_tr_b16 v[182:183], v189 offset:5120
    v_mfma_f32_16x16x32_bf16 v[40:43], v[104:107], v[152:155], v[40:43]
    s_add_u32 s53, s53, 20480
    s_cmp_eq_u32 s53, 81920
    v_mfma_f32_16x16x32_bf16 v[48:51], v[108:111], v[152:155], v[48:51]
    s_cselect_b32 s53, 0, s53
    v_add_u32 v185, s53, v184
    v_mfma_f32_16x16x32_bf16 v[88:91], v[112:115], v[152:155], v[88:91]
    v_add_u32 v188, s53, v186
    v_add_u32 v189, s53, v187
    v_mfma_f32_16x16x32_bf16 v[96:99], v[116:119], v[152:155], v[96:99]
    s_sub_u32 s54, s54, 1
    s_cmp_lg_u32 s54, 0
    v_mfma_f32_16x16x32_bf16 v[44:47], v[104:107], v[156:159], v[44:47]
    v_mfma_f32_16x16x32_bf16 v[52:55], v[108:111], v[156:159], v[52:55]
    v_mfma_f32_16x16x32_bf16 v[92:95], v[112:115], v[156:159], v[92:95]
    v_mfma_f32_16x16x32_bf16 v[100:103], v[116:119], v[156:159], v[100:103]
    s_cbranch_scc1 L_qkv_loop1
L_qkv_epi:
    s_waitcnt lgkmcnt(0)
    s_barrier
    s_nop 0
    v_mfma_f32_16x16x32_bf16 v[8:11], v[160:163], v[120:123], v[8:11]
    v_mfma_f32_16x16x32_bf16 v[12:15], v[160:163], v[124:127], v[12:15]
    v_mfma_f32_16x16x32_bf16 v[56:59], v[160:163], v[128:131], v[56:59]
    v_mfma_f32_16x16x32_bf16 v[60:63], v[160:163], v[132:135], v[60:63]
    v_mfma_f32_16x16x32_bf16 v[16:19], v[164:167], v[120:123], v[16:19]
    v_mfma_f32_16x16x32_bf16 v[20:23], v[164:167], v[124:127], v[20:23]
    v_mfma_f32_16x16x32_bf16 v[64:67], v[164:167], v[128:131], v[64:67]
    v_mfma_f32_16x16x32_bf16 v[68:71], v[164:167], v[132:135], v[68:71]
    v_mfma_f32_16x16x32_bf16 v[24:27], v[168:171], v[120:123], v[24:27]
    v_mfma_f32_16x16x32_bf16 v[28:31], v[168:171], v[124:127], v[28:31]
    v_mfma_f32_16x16x32_bf16 v[72:75], v[168:171], v[128:131], v[72:75]
    v_mfma_f32_16x16x32_bf16 v[76:79], v[168:171], v[132:135], v[76:79]
    v_mfma_f32_16x16x32_bf16 v[32:35], v[172:175], v[120:123], v[32:35]
    v_mfma_f32_16x16x32_bf16 v[36:39], v[172:175], v[124:127], v[36:39]
    v_mfma_f32_16x16x32_bf16 v[80:83], v[172:175], v[128:131], v[80:83]
    v_mfma_f32_16x16x32_bf16 v[84:87], v[172:175], v[132:135], v[84:87]
    v_mfma_f32_16x16x32_bf16 v[40:43], v[120:123], v[176:179], v[40:43]
    v_mfma_f32_16x16x32_bf16 v[48:51], v[124:127], v[176:179], v[48:51]
    v_mfma_f32_16x16x32_bf16 v[88:91], v[128:131], v[176:179], v[88:91]
    v_mfma_f32_16x16x32_bf16 v[96:99], v[132:135], v[176:179], v[96:99]
    v_mfma_f32_16x16x32_bf16 v[44:47], v[120:123], v[180:183], v[44:47]
    v_mfma_f32_16x16x32_bf16 v[52:55], v[124:127], v[180:183], v[52:55]
    v_mfma_f32_16x16x32_bf16 v[92:95], v[128:131], v[180:183], v[92:95]
    v_mfma_f32_16x16x32_bf16 v[100:103], v[132:135], v[180:183], v[100:103]
    s_nop 7
    v_permlane16_swap_b32 v24, v28
    v_permlane16_swap_b32 v25, v29
    v_permlane16_swap_b32 v26, v30
    v_permlane16_swap_b32 v27, v31
    v_permlane16_swap_b32 v32, v36
    v_permlane16_swap_b32 v33, v37
    v_permlane16_swap_b32 v34, v38
    v_permlane16_swap_b32 v35, v39
    s_nop 0
    v_cvt_pk_bf16_f32 v24, v24, v25
    v_cvt_pk_bf16_f32 v25, v26, v27
    v_cvt_pk_bf16_f32 v26, v28, v29
    v_cvt_pk_bf16_f32 v27, v30, v31
    v_cvt_pk_bf16_f32 v28, v32, v33
    v_cvt_pk_bf16_f32 v29, v34, v35
    v_cvt_pk_bf16_f32 v30, v36, v37
    v_cvt_pk_bf16_f32 v31, v38, v39
    buffer_store_dwordx4 v[24:27], v190, s[36:39], s62 offen offset:0 sc1
    buffer_store_dwordx4 v[28:31], v190, s[36:39], s62 offen offset:1024 sc1
    v_permlane16_swap_b32 v72, v76
    v_permlane16_swap_b32 v73, v77
    v_permlane16_swap_b32 v74, v78
    v_permlane16_swap_b32 v75, v79
    v_permlane16_swap_b32 v80, v84
    v_permlane16_swap_b32 v81, v85
    v_permlane16_swap_b32 v82, v86
    v_permlane16_swap_b32 v83, v87
    s_nop 0
    s_nop 0
    v_cvt_pk_bf16_f32 v72, v72, v73
    v_cvt_pk_bf16_f32 v73, v74, v75
    v_cvt_pk_bf16_f32 v74, v76, v77
    v_cvt_pk_bf16_f32 v75, v78, v79
    v_cvt_pk_bf16_f32 v76, v80, v81
    v_cvt_pk_bf16_f32 v77, v82, v83
    v_cvt_pk_bf16_f32 v78, v84, v85
    v_cvt_pk_bf16_f32 v79, v86, v87
    buffer_store_dwordx4 v[72:75], v190, s[36:39], s63 offen offset:0 sc1
    buffer_store_dwordx4 v[76:79], v190, s[36:39], s63 offen offset:1024 sc1
    v_permlane32_swap_b32 v40, v44
    v_permlane32_swap_b32 v41, v45
    v_permlane32_swap_b32 v42, v46
    v_permlane32_swap_b32 v43, v47
    v_permlane32_swap_b32 v48, v52
    v_permlane32_swap_b32 v49, v53
    v_permlane32_swap_b32 v50, v54
    v_permlane32_swap_b32 v51, v55
    s_nop 0
    s_nop 0
    v_cvt_pk_bf16_f32 v40, v40, v41
    v_cvt_pk_bf16_f32 v41, v42, v43
    v_cvt_pk_bf16_f32 v42, v44, v45
    v_cvt_pk_bf16_f32 v43, v46, v47
    v_cvt_pk_bf16_f32 v44, v48, v49
    v_cvt_pk_bf16_f32 v45, v50, v51
    v_cvt_pk_bf16_f32 v46, v52, v53
    v_cvt_pk_bf16_f32 v47, v54, v55
    buffer_store_dwordx4 v[40:43], v191, s[36:39], s62 offen offset:2048 sc1
    buffer_store_dwordx4 v[44:47], v191, s[36:39], s62 offen offset:3072 sc1
    v_permlane32_swap_b32 v88, v92
    v_permlane32_swap_b32 v89, v93
    v_permlane32_swap_b32 v90, v94
    v_permlane32_swap_b32 v91, v95
    v_permlane32_swap_b32 v96, v100
    v_permlane32_swap_b32 v97, v101
    v_permlane32_swap_b32 v98, v102
    v_permlane32_swap_b32 v99, v103
    s_nop 0
    s_nop 0
    v_cvt_pk_bf16_f32 v88, v88, v89
    v_cvt_pk_bf16_f32 v89, v90, v91
    v_cvt_pk_bf16_f32 v90, v92, v93
    v_cvt_pk_bf16_f32 v91, v94, v95
    v_cvt_pk_bf16_f32 v92, v96, v97
    v_cvt_pk_bf16_f32 v93, v98, v99
    v_cvt_pk_bf16_f32 v94, v100, v101
    v_cvt_pk_bf16_f32 v95, v102, v103
    buffer_store_dwordx4 v[88:91], v191, s[36:39], s63 offen offset:2048 sc1
    buffer_store_dwordx4 v[92:95], v191, s[36:39], s63 offen offset:3072 sc1
    v_permlane16_swap_b32 v8, v12
    v_permlane16_swap_b32 v9, v13
    v_permlane16_swap_b32 v10, v14
    v_permlane16_swap_b32 v11, v15
    v_permlane16_swap_b32 v16, v20
    v_permlane16_swap_b32 v17, v21
    v_permlane16_swap_b32 v18, v22
    v_permlane16_swap_b32 v19, v23
    s_nop 0
    s_nop 0
    v_pk_mul_f32 v[8:9], v[8:9], s[66:67]
    v_pk_mul_f32 v[10:11], v[10:11], s[66:67]
    v_pk_mul_f32 v[12:13], v[12:13], s[66:67]
    v_pk_mul_f32 v[14:15], v[14:15], s[66:67]
    v_pk_mul_f32 v[16:17], v[16:17], s[66:67]
    v_pk_mul_f32 v[18:19], v[18:19], s[66:67]
    v_pk_mul_f32 v[20:21], v[20:21], s[66:67]
    v_pk_mul_f32 v[22:23], v[22:23], s[66:67]
    v_cvt_pk_bf16_f32 v8, v8, v9
    v_cvt_pk_bf16_f32 v9, v10, v11
    v_cvt_pk_bf16_f32 v10, v12, v13
    v_cvt_pk_bf16_f32 v11, v14, v15
    v_cvt_pk_bf16_f32 v12, v16, v17
    v_cvt_pk_bf16_f32 v13, v18, v19
    v_cvt_pk_bf16_f32 v14, v20, v21
    v_cvt_pk_bf16_f32 v15, v22, v23
    v_permlane16_swap_b32 v56, v60
    v_permlane16_swap_b32 v57, v61
    v_permlane16_swap_b32 v58, v62
    v_permlane16_swap_b32 v59, v63
    v_permlane16_swap_b32 v64, v68
    v_permlane16_swap_b32 v65, v69
    v_permlane16_swap_b32 v66, v70
    v_permlane16_swap_b32 v67, v71
    s_nop 0
    s_nop 0
    v_pk_mul_f32 v[56:57], v[56:57], s[66:67]
    v_pk_mul_f32 v[58:59], v[58:59], s[66:67]
    v_pk_mul_f32 v[60:61], v[60:61], s[66:67]
    v_pk_mul_f32 v[62:63], v[62:63], s[66:67]
    v_pk_mul_f32 v[64:65], v[64:65], s[66:67]
    v_pk_mul_f32 v[66:67], v[66:67], s[66:67]
    v_pk_mul_f32 v[68:69], v[68:69], s[66:67]
    v_pk_mul_f32 v[70:71], v[70:71], s[66:67]
    v_cvt_pk_bf16_f32 v56, v56, v57
    v_cvt_pk_bf16_f32 v57, v58, v59
    v_cvt_pk_bf16_f32 v58, v60, v61
    v_cvt_pk_bf16_f32 v59, v62, v63
    v_cvt_pk_bf16_f32 v60, v64, v65
    v_cvt_pk_bf16_f32 v61, v66, v67
    v_cvt_pk_bf16_f32 v62, v68, v69
    v_cvt_pk_bf16_f32 v63, v70, v71
    s_mul_i32 s68, s46, 5120
    s_add_u32 s68, s68, 131072
    v_add_u32_e64 v5, s68, v190
    v_mfma_f32_32x32x16_bf16 v[104:119], v[24:27], v[8:11], 0
    v_mfma_f32_32x32x16_bf16 v[104:119], v[28:31], v[12:15], v[104:119]
    v_mfma_f32_32x32x16_bf16 v[120:135], v[72:75], v[8:11], 0
    v_mfma_f32_32x32x16_bf16 v[120:135], v[76:79], v[12:15], v[120:135]
    v_mfma_f32_32x32x16_bf16 v[136:151], v[24:27], v[56:59], 0
    v_mfma_f32_32x32x16_bf16 v[136:151], v[28:31], v[60:63], v[136:151]
    v_mfma_f32_32x32x16_bf16 v[152:167], v[72:75], v[56:59], 0
    v_mfma_f32_32x32x16_bf16 v[152:167], v[76:79], v[60:63], v[152:167]
    ds_write_b128 v5, v[8:11] offset:0
    ds_write_b128 v5, v[12:15] offset:1024
    ds_write_b128 v5, v[56:59] offset:2048
    ds_write_b128 v5, v[60:63] offset:3072
    s_lshl_b32 s69, s46, 15
    v_add_u32 v6, s69, v190
    v_add_u32_e64 v7, s69, v191
    ds_write_b128 v6, v[24:27] offset:0
    ds_write_b128 v7, v[40:43] offset:2048
    ds_write_b128 v6, v[28:31] offset:1024
    ds_write_b128 v7, v[44:47] offset:3072
    ds_write_b128 v6, v[72:75] offset:4096
    ds_write_b128 v7, v[88:91] offset:6144
    ds_write_b128 v6, v[76:79] offset:5120
    ds_write_b128 v7, v[92:95] offset:7168
    v_lshl_add_u32 v5, v1, 3, s68
    s_nop 7
    v_max_f32 v168, v104, v120
    v_max3_f32 v168, v168, v105, v121
    v_max3_f32 v168, v168, v106, v122
    v_max3_f32 v168, v168, v107, v123
    v_max3_f32 v168, v168, v108, v124
    v_max3_f32 v168, v168, v109, v125
    v_max3_f32 v168, v168, v110, v126
    v_max3_f32 v168, v168, v111, v127
    v_max3_f32 v168, v168, v112, v128
    v_max3_f32 v168, v168, v113, v129
    v_max3_f32 v168, v168, v114, v130
    v_max3_f32 v168, v168, v115, v131
    v_max3_f32 v168, v168, v116, v132
    v_max3_f32 v168, v168, v117, v133
    v_max3_f32 v168, v168, v118, v134
    v_max3_f32 v168, v168, v119, v135
    v_max_f32_e64 v169, v136, v152
    v_max3_f32 v169, v169, v137, v153
    v_max3_f32 v169, v169, v138, v154
    v_max3_f32 v169, v169, v139, v155
    v_max3_f32 v169, v169, v140, v156
    v_max3_f32 v169, v169, v141, v157
    v_max3_f32 v169, v169, v142, v158
    v_max3_f32 v169, v169, v143, v159
    v_max3_f32 v169, v169, v144, v160
    v_max3_f32 v169, v169, v145, v161
    v_max3_f32 v169, v169, v146, v162
    v_max3_f32 v169, v169, v147, v163
    v_max3_f32 v169, v169, v148, v164
    v_max3_f32 v169, v169, v149, v165
    v_max3_f32 v169, v169, v150, v166
    v_max3_f32 v169, v169, v151, v167
    v_mov_b32 v170, v168
    v_mov_b32 v171, v169
    s_nop 1
    v_permlane32_swap_b32 v168, v170
    v_permlane32_swap_b32 v169, v171
    s_nop 1
    v_max_f32 v168, v168, v170
    v_max_f32 v169, v169, v171
    v_sub_f32 v168, 0xc2200000, v168
    v_sub_f32 v169, 0xc2200000, v169
    ds_write_b64 v5, v[168:169] offset:4096
    s_waitcnt lgkmcnt(0)
    s_add_u32 s96, s28, 0x3a00000
    s_addc_u32 s97, s29, 0
    s_and_b32 s97, s97, 0xffff
    s_mov_b32 s98, 0x200000
    s_mov_b32 s99, 0x20000
    v_mov_b32 v252, s84
    v_mov_b32 v253, s85
    v_mov_b32 v254, 0
    s_and_b32 s100, s3, 3
    s_lshl_b32 s100, s100, 7
    s_add_u32 s100, s100, s87
    s_waitcnt vmcnt(0)
    s_mov_b64 exec, 1
    buffer_store_dwordx2 v[252:253], v254, s[96:99], s100 offen sc1
    s_mov_b64 exec, -1
    s_mov_b64 exec, -1
    s_setprio 0
    s_branch L_attn_entry
L_attn_entry:
    v_and_b32_e64 v1, 63, v0
    s_mov_b32 s46, s3
    s_and_b32 s47, s3, 1
    s_bfe_u32 s48, s3, 0x10001
    s_lshr_b32 s49, s3, 2
    s_lshl_b32 s50, s31, 1
    s_add_u32 s50, s50, s47
    s_lshl_b32 s52, s50, 18
    s_lshl_b32 s51, s49, 17
    s_add_u32 s51, s51, s52
    s_lshl_b32 s55, s49, 1
    s_add_u32 s55, s55, s47
    s_lshl_b32 s55, s55, 15
    s_lshl_b32 s56, s48, 12
    s_add_u32 s57, s55, s56
    s_lshl_b32 s53, s3, 12
    v_lshlrev_b32 v156, 4, v1
    v_add_u32 v157, s55, v156
    s_lshl_b32 s54, s30, 2
    s_lshl_b32 s58, s48, 1
    s_add_u32 s54, s54, s58
    s_add_u32 s54, s54, s49
    s_lshl_b32 s54, s54, 16
    s_lshl_b32 s58, s50, 11
    s_add_u32 s54, s54, s58
    s_lshl_b32 s62, s2, 13
    v_lshl_add_u32 v161, v0, 4, s62
    s_mov_b32 s62, 0
    v_and_b32 v3, 3, v1
    v_bfe_u32 v4, v1, 2, 1
    v_bfe_u32 v5, v1, 4, 1
    v_xor_b32 v4, v4, v5
    v_or_b32_e64 v3, v3, v4
    v_cmp_eq_u32 vcc, 0, v3
    v_mov_b32 v4, 0x3f803f80
    s_nop 1
    v_cndmask_b32 v128, 0, v4, vcc
    v_mov_b32 v129, v128
    v_mov_b32 v130, v128
    v_mov_b32_e64 v131, v128
    s_add_u32 s36, s28, 0x900000
    s_addc_u32 s37, s29, 0
    s_add_u32 s36, s36, s52
    s_addc_u32 s37, s37, 0
    s_and_b32 s37, s37, 0xffff
    s_mov_b32 s38, 0x40000
    s_mov_b32 s39, 0x20000
    s_mov_b32 s86, s87
    s_lshl_b32 s51, s30, 14
    s_add_u32 s51, s51, s56
    s_mul_i32 s58, s49, 122880
    s_add_u32 s56, s56, s58
    s_cmp_ge_u32 s56, s51
    s_cselect_b32 s58, 16384, 0
    s_add_u32 s56, s56, s58
    s_mov_b32 s80, s28
    s_and_b32 s81, s29, 0xffff
    s_mov_b32 s82, 0x40000
    s_mov_b32 s83, 0x20000
    s_mov_b32 s64, s12
    s_and_b32 s65, s13, 0xffff
    s_mov_b32 s66, 0x700000
    s_mov_b32 s67, 0x20000
    s_mov_b32 s68, s14
    s_and_b32 s69, s15, 0xffff
    s_mov_b32 s70, 0x800000
    s_mov_b32 s71, 0x20000
    s_mov_b32 s32, s8
    s_and_b32 s33, s9, 0xffff
    s_mov_b32 s34, 0x200000
    s_mov_b32 s35, 0x20000
    v_mov_b32 v40, 0
    v_mov_b32 v56, 0
    v_mov_b32 v41, 0
    v_mov_b32 v57, 0
    v_mov_b32 v42, 0
    v_mov_b32 v58, 0
    v_mov_b32 v43, 0
    v_mov_b32 v59, 0
    v_mov_b32 v44, 0
    v_mov_b32 v60, 0
    v_mov_b32 v45, 0
    v_mov_b32 v61, 0
    v_mov_b32 v46, 0
    v_mov_b32 v62, 0
    v_mov_b32 v47, 0
    v_mov_b32 v63, 0
    v_mov_b32 v48, 0
    v_mov_b32 v64, 0
    v_mov_b32 v49, 0
    v_mov_b32 v65, 0
    v_mov_b32 v50, 0
    v_mov_b32 v66, 0
    v_mov_b32 v51, 0
    v_mov_b32 v67, 0
    v_mov_b32 v52, 0
    v_mov_b32 v68, 0
    v_mov_b32 v53, 0
    v_mov_b32 v69, 0
    v_mov_b32 v54, 0
    v_mov_b32 v70, 0
    v_mov_b32 v55, 0
    v_mov_b32 v71, 0
    v_mov_b32 v104, 0
    v_mov_b32 v108, 0
    v_mov_b32 v152, 0
    v_mov_b32 v144, 0
    v_mov_b32 v105, 0
    v_mov_b32 v109, 0
    v_mov_b32 v153, 0
    v_mov_b32 v145, 0
    v_mov_b32 v106, 0
    v_mov_b32 v110, 0
    v_mov_b32 v154, 0
    v_mov_b32 v146, 0
    v_mov_b32 v107, 0
    v_mov_b32 v111, 0
    v_mov_b32 v155, 0
    v_mov_b32 v147, 0
    s_and_b32 s58, s2, 3
    s_lshl_b32 s58, s58, 3
    s_add_u32 s58, s58, s46
    s_mul_i32 s60, s58, 393216
    s_lshr_b32 s63, s2, 2
    s_lshl_b32 s63, s63, 7
    s_add_u32 s60, s60, s63
    s_add_u32 s60, s60, 4096
    s_add_u32 s61, s60, 12288
    s_and_b32 s44, s2, 3
    s_lshl_b32 s44, s44, 2
    s_and_b32 s63, s46, 3
    s_add_u32 s44, s44, s63
    s_lshl_b32 s44, s44, 8
    s_add_u32 s44, s44, 98304
    v_lshrrev_b32_e64 v164, 3, v1
    v_mul_u32_u24 v162, 49152, v164
    v_and_b32_e64 v165, 7, v1
    v_lshl_add_u32 v162, v165, 4, v162
    v_lshlrev_b32 v164, 4, v164
    s_and_b32 s58, s3, 3
    s_mul_i32 s58, s58, 5120
    s_add_u32 s58, s58, 131072
    s_lshl_b32 s63, s49, 11
    s_add_u32 s63, s63, s58
    v_add_u32 v2, s63, v156
    v_xor_b32 v3, 1, v2
    s_xor_b32 s63, s49, 1
    s_lshl_b32 s63, s63, 11
    s_add_u32 s63, s63, s58
    v_add_u32 v3, s63, v156
    s_lshl_b32 s63, s49, 2
    s_add_u32 s63, s63, s58
    v_lshl_add_u32 v4, v1, 3, s63
    v_xor_b32 v5, 4, v4
    s_lshl_b32 s100, s30, 8
    s_lshl_b32 s101, s31, 2
    s_add_u32 s100, s100, s101
    s_add_u32 s100, s100, 16384
    s_lshl_b32 s87, s100, 5
    s_barrier
    ds_read_b128 v[112:115], v2
    ds_read_b128 v[116:119], v2 offset:1024
    ds_read_b32 v72, v4 offset:4096
    ds_read_b128 v[120:123], v3
    ds_read_b128 v[124:127], v3 offset:1024
    ds_read_b32 v88, v5 offset:4096
    s_waitcnt lgkmcnt(0)
    v_mov_b32 v73, v72
    v_mov_b32 v89, v88
    v_mov_b32 v74, v72
    v_mov_b32 v90, v88
    v_mov_b32 v75, v72
    v_mov_b32 v91, v88
    v_mov_b32 v76, v72
    v_mov_b32 v92, v88
    v_mov_b32 v77, v72
    v_mov_b32 v93, v88
    v_mov_b32 v78, v72
    v_mov_b32 v94, v88
    v_mov_b32 v79, v72
    v_mov_b32 v95, v88
    v_mov_b32 v80, v72
    v_mov_b32 v96, v88
    v_mov_b32 v81, v72
    v_mov_b32 v97, v88
    v_mov_b32 v82, v72
    v_mov_b32 v98, v88
    v_mov_b32 v83, v72
    v_mov_b32 v99, v88
    v_mov_b32 v84, v72
    v_mov_b32 v100, v88
    v_mov_b32 v85, v72
    v_mov_b32 v101, v88
    v_mov_b32 v86, v72
    v_mov_b32 v102, v88
    v_mov_b32 v87, v72
    v_mov_b32_e64 v103, v88
    ds_read_b128 v[132:135], v157 offset:0
    ds_read_b128 v[136:139], v157 offset:1024
    ds_read_b128 v[140:143], v157 offset:2048
    s_waitcnt lgkmcnt(1)
    v_mfma_f32_32x32x16_bf16 v[8:23], v[132:135], v[112:115], v[72:87]
    v_mfma_f32_32x32x16_bf16 v[8:23], v[136:139], v[116:119], v[8:23]
    s_nop 11
    s_mov_b32 s59, 3
    s_cmp_lg_u32 s3, 4
    s_cbranch_scc1 L_mp0_wd18
    s_add_u32 s96, s28, 0x3a00000
    s_addc_u32 s97, s29, 0
    s_and_b32 s97, s97, 0xffff
    s_mov_b32 s98, 0x200000
    s_mov_b32 s99, 0x20000
    s_lshl_b32 s100, s31, 8
    s_add_u32 s100, s100, 8192
    s_lshl_b32 s100, s100, 5
    v_lshlrev_b32_e64 v254, 7, v1
    s_mov_b32 s101, 0x100000
L_mp0_wf19:
    buffer_load_dwordx2 v[252:253], v254, s[96:99], s100 offen sc1
    s_waitcnt vmcnt(0)
    v_cmp_ne_u64 vcc, s[84:85], v[252:253]
    s_sub_u32 s101, s101, 1
    s_nop 3
    s_cbranch_vccz L_mp0_we20
    s_mov_b64 exec, vcc
    s_sleep 1
    s_cmp_lg_u32 s101, 0
    s_cbranch_scc1 L_mp0_wf19
L_mp0_we20:
    s_mov_b64 exec, -1
L_mp0_wd18:
    s_barrier
    s_add_u32 m0, s57, 8192
    s_nop 0
    buffer_load_dwordx4 v156, s[36:39], s56 offen offset:0 sc1 lds
    buffer_load_dwordx4 v156, s[36:39], s56 offen offset:1024 sc1 lds
    buffer_load_dwordx4 v156, s[36:39], s56 offen offset:2048 sc1 lds
    buffer_load_dwordx4 v156, s[36:39], s56 offen offset:3072 sc1 lds
    s_add_u32 s56, s56, 8192
    s_cmp_eq_u32 s56, s51
    s_cselect_b32 s58, 16384, 0
    s_add_u32 s56, s56, s58
    s_add_u32 m0, s57, 16384
    s_nop 0
    buffer_load_dwordx4 v156, s[36:39], s56 offen offset:0 sc1 lds
    buffer_load_dwordx4 v156, s[36:39], s56 offen offset:1024 sc1 lds
    buffer_load_dwordx4 v156, s[36:39], s56 offen offset:2048 sc1 lds
    buffer_load_dwordx4 v156, s[36:39], s56 offen offset:3072 sc1 lds
    s_add_u32 s56, s56, 8192
    s_cmp_eq_u32 s56, s51
    s_cselect_b32 s58, 16384, 0
    s_add_u32 s56, s56, s58
    v_exp_f32 v8, v8
    v_exp_f32 v9, v9
    v_exp_f32 v10, v10
    v_mfma_f32_32x32x16_bf16 v[24:39], v[132:135], v[120:123], v[88:103]
    ds_read_b128 v[132:135], v157 offset:4096
    v_exp_f32 v11, v11
    v_exp_f32 v12, v12
    v_exp_f32_e64 v13, v13
    v_mfma_f32_32x32x16_bf16 v[56:71], v[144:147], v[152:155], v[56:71]
    ds_read_b128 v[144:147], v157 offset:3072
    v_exp_f32 v14, v14
    v_exp_f32 v15, v15
    v_cvt_pk_bf16_f32 v148, v8, v9
    v_cvt_pk_bf16_f32 v149, v10, v11
    v_mfma_f32_16x16x32_bf16 v[108:111], v[128:131], v[152:155], v[108:111]
    v_cvt_pk_bf16_f32 v150, v12, v13
    v_cvt_pk_bf16_f32 v151, v14, v15
    v_exp_f32 v16, v16
    v_exp_f32 v17, v17
    v_exp_f32_e64 v18, v18
    v_mfma_f32_32x32x16_bf16 v[24:39], v[136:139], v[124:127], v[24:39]
    ds_read_b128 v[136:139], v157 offset:5120
    v_exp_f32 v19, v19
    v_exp_f32 v20, v20
    v_exp_f32 v21, v21
    s_waitcnt lgkmcnt(3)
    v_mfma_f32_32x32x16_bf16 v[40:55], v[140:143], v[148:151], v[40:55]
    v_exp_f32 v22, v22
    v_exp_f32 v23, v23
    v_cvt_pk_bf16_f32 v152, v16, v17
    v_cvt_pk_bf16_f32 v153, v18, v19
    v_mfma_f32_16x16x32_bf16 v[104:107], v[128:131], v[148:151], v[104:107]
    v_cvt_pk_bf16_f32 v154, v20, v21
    v_cvt_pk_bf16_f32 v155, v22, v23
    v_exp_f32 v24, v24
    v_exp_f32 v25, v25
    v_exp_f32 v26, v26
    s_waitcnt lgkmcnt(0)
    v_mfma_f32_32x32x16_bf16 v[8:23], v[132:135], v[112:115], v[72:87]
    v_exp_f32 v27, v27
    v_exp_f32 v28, v28
    v_exp_f32_e64 v29, v29
    v_mfma_f32_32x32x16_bf16 v[40:55], v[144:147], v[152:155], v[40:55]
    v_exp_f32 v30, v30
    v_exp_f32 v31, v31
    v_cvt_pk_bf16_f32 v148, v24, v25
    v_cvt_pk_bf16_f32 v149, v26, v27
    v_mfma_f32_16x16x32_bf16 v[104:107], v[128:131], v[152:155], v[104:107]
    v_cvt_pk_bf16_f32 v150, v28, v29
    v_cvt_pk_bf16_f32 v151, v30, v31
    v_exp_f32 v32, v32
    v_exp_f32 v33, v33
    v_exp_f32_e64 v34, v34
    v_mfma_f32_32x32x16_bf16 v[8:23], v[136:139], v[116:119], v[8:23]
    v_exp_f32 v35, v35
    v_exp_f32 v36, v36
    v_exp_f32_e64 v37, v37
    v_mfma_f32_32x32x16_bf16 v[56:71], v[140:143], v[148:151], v[56:71]
    ds_read_b128 v[140:143], v157 offset:6144
    v_exp_f32 v38, v38
    v_exp_f32 v39, v39
    v_cvt_pk_bf16_f32 v152, v32, v33
    v_cvt_pk_bf16_f32 v153, v34, v35
    v_mfma_f32_16x16x32_bf16 v[108:111], v[128:131], v[148:151], v[108:111]
    v_cvt_pk_bf16_f32 v154, v36, v37
    v_cvt_pk_bf16_f32 v155, v38, v39
    s_waitcnt vmcnt(4)
    s_barrier
    v_exp_f32_e64 v8, v8
    s_add_u32 m0, s57, 24576
    v_exp_f32_e64 v9, v9
    buffer_load_dwordx4 v156, s[36:39], s56 offen offset:0 sc1 lds
    v_exp_f32_e64 v10, v10
    v_mfma_f32_32x32x16_bf16 v[24:39], v[132:135], v[120:123], v[88:103]
    ds_read_b128 v[132:135], v157 offset:8192
    v_exp_f32 v11, v11
    v_exp_f32 v12, v12
    v_exp_f32_e64 v13, v13
    v_mfma_f32_32x32x16_bf16 v[56:71], v[144:147], v[152:155], v[56:71]
    ds_read_b128 v[144:147], v157 offset:7168
    v_exp_f32 v14, v14
    v_exp_f32 v15, v15
    v_cvt_pk_bf16_f32 v148, v8, v9
    v_cvt_pk_bf16_f32 v149, v10, v11
    v_mfma_f32_16x16x32_bf16 v[108:111], v[128:131], v[152:155], v[108:111]
    v_cvt_pk_bf16_f32 v150, v12, v13
    v_cvt_pk_bf16_f32 v151, v14, v15
    v_exp_f32 v16, v16
    v_exp_f32 v17, v17
    buffer_load_dwordx4 v156, s[36:39], s56 offen offset:1024 sc1 lds
    v_exp_f32_e64 v18, v18
    v_mfma_f32_32x32x16_bf16 v[24:39], v[136:139], v[124:127], v[24:39]
    ds_read_b128 v[136:139], v157 offset:9216
    v_exp_f32 v19, v19
    v_exp_f32 v20, v20
    v_exp_f32 v21, v21
    s_waitcnt lgkmcnt(3)
    v_mfma_f32_32x32x16_bf16 v[40:55], v[140:143], v[148:151], v[40:55]
    v_exp_f32 v22, v22
    v_exp_f32 v23, v23
    v_cvt_pk_bf16_f32 v152, v16, v17
    v_cvt_pk_bf16_f32 v153, v18, v19
    v_mfma_f32_16x16x32_bf16 v[104:107], v[128:131], v[148:151], v[104:107]
    v_cvt_pk_bf16_f32 v154, v20, v21
    v_cvt_pk_bf16_f32 v155, v22, v23
    v_exp_f32_e64 v24, v24
    buffer_load_dwordx4 v156, s[36:39], s56 offen offset:2048 sc1 lds
    v_exp_f32 v25, v25
    v_exp_f32_e64 v26, v26
    s_waitcnt lgkmcnt(0)
    v_mfma_f32_32x32x16_bf16 v[8:23], v[132:135], v[112:115], v[72:87]
    v_exp_f32 v27, v27
    v_exp_f32 v28, v28
    v_exp_f32_e64 v29, v29
    v_mfma_f32_32x32x16_bf16 v[40:55], v[144:147], v[152:155], v[40:55]
    v_exp_f32 v30, v30
    v_exp_f32 v31, v31
    v_cvt_pk_bf16_f32 v148, v24, v25
    v_cvt_pk_bf16_f32 v149, v26, v27
    v_mfma_f32_16x16x32_bf16 v[104:107], v[128:131], v[152:155], v[104:107]
    v_cvt_pk_bf16_f32 v150, v28, v29
    v_cvt_pk_bf16_f32 v151, v30, v31
    v_exp_f32_e64 v32, v32
    buffer_load_dwordx4 v156, s[36:39], s56 offen offset:3072 sc1 lds
    v_exp_f32_e64 v33, v33
    s_add_u32 s56, s56, 8192
    s_cmp_eq_u32 s56, s51
    s_cselect_b32 s58, 16384, 0
    s_add_u32 s56, s56, s58
    v_exp_f32_e64 v34, v34
    v_mfma_f32_32x32x16_bf16 v[8:23], v[136:139], v[116:119], v[8:23]
    v_exp_f32 v35, v35
    v_exp_f32 v36, v36
    v_exp_f32_e64 v37, v37
    v_mfma_f32_32x32x16_bf16 v[56:71], v[140:143], v[148:151], v[56:71]
    ds_read_b128 v[140:143], v157 offset:10240
    v_exp_f32 v38, v38
    v_exp_f32 v39, v39
    v_cvt_pk_bf16_f32 v152, v32, v33
    v_cvt_pk_bf16_f32 v153, v34, v35
    v_mfma_f32_16x16x32_bf16 v[108:111], v[128:131], v[148:151], v[108:111]
    v_cvt_pk_bf16_f32 v154, v36, v37
    v_cvt_pk_bf16_f32 v155, v38, v39
    v_exp_f32_e64 v8, v8
    buffer_load_dwordx4 v[168:171], v161, s[32:35], s62 offen
    v_exp_f32 v9, v9
    v_exp_f32 v10, v10
    v_mfma_f32_32x32x16_bf16 v[24:39], v[132:135], v[120:123], v[88:103]
    ds_read_b128 v[132:135], v157 offset:12288
    v_exp_f32 v11, v11
    v_exp_f32 v12, v12
    v_exp_f32_e64 v13, v13
    v_mfma_f32_32x32x16_bf16 v[56:71], v[144:147], v[152:155], v[56:71]
    ds_read_b128 v[144:147], v157 offset:11264
    v_exp_f32 v14, v14
    v_exp_f32 v15, v15
    v_cvt_pk_bf16_f32 v148, v8, v9
    v_cvt_pk_bf16_f32 v149, v10, v11
    v_mfma_f32_16x16x32_bf16 v[108:111], v[128:131], v[152:155], v[108:111]
    v_cvt_pk_bf16_f32 v150, v12, v13
    v_cvt_pk_bf16_f32 v151, v14, v15
    v_exp_f32 v16, v16
    v_exp_f32 v17, v17
    v_exp_f32_e64 v18, v18
    v_mfma_f32_32x32x16_bf16 v[24:39], v[136:139], v[124:127], v[24:39]
    ds_read_b128 v[136:139], v157 offset:13312
    v_exp_f32 v19, v19
    v_exp_f32 v20, v20
    v_exp_f32 v21, v21
    s_waitcnt lgkmcnt(3)
    v_mfma_f32_32x32x16_bf16 v[40:55], v[140:143], v[148:151], v[40:55]
    v_exp_f32 v22, v22
    v_exp_f32 v23, v23
    v_cvt_pk_bf16_f32 v152, v16, v17
    v_cvt_pk_bf16_f32 v153, v18, v19
    v_mfma_f32_16x16x32_bf16 v[104:107], v[128:131], v[148:151], v[104:107]
    v_cvt_pk_bf16_f32 v154, v20, v21
    v_cvt_pk_bf16_f32 v155, v22, v23
    v_exp_f32_e64 v24, v24
    buffer_load_dwordx4 v[168:171], v161, s[64:67], s62 offen
    v_exp_f32 v25, v25
    v_exp_f32_e64 v26, v26
    s_waitcnt lgkmcnt(0)
    v_mfma_f32_32x32x16_bf16 v[8:23], v[132:135], v[112:115], v[72:87]
    v_exp_f32 v27, v27
    v_exp_f32 v28, v28
    v_exp_f32_e64 v29, v29
    v_mfma_f32_32x32x16_bf16 v[40:55], v[144:147], v[152:155], v[40:55]
    v_exp_f32 v30, v30
    v_exp_f32 v31, v31
    v_cvt_pk_bf16_f32 v148, v24, v25
    v_cvt_pk_bf16_f32 v149, v26, v27
    v_mfma_f32_16x16x32_bf16 v[104:107], v[128:131], v[152:155], v[104:107]
    v_cvt_pk_bf16_f32 v150, v28, v29
    v_cvt_pk_bf16_f32 v151, v30, v31
    v_exp_f32 v32, v32
    v_exp_f32 v33, v33
    v_exp_f32_e64 v34, v34
    v_mfma_f32_32x32x16_bf16 v[8:23], v[136:139], v[116:119], v[8:23]
    v_exp_f32 v35, v35
    v_exp_f32 v36, v36
    v_exp_f32_e64 v37, v37
    v_mfma_f32_32x32x16_bf16 v[56:71], v[140:143], v[148:151], v[56:71]
    ds_read_b128 v[140:143], v157 offset:14336
    v_exp_f32 v38, v38
    v_exp_f32 v39, v39
    v_cvt_pk_bf16_f32 v152, v32, v33
    v_cvt_pk_bf16_f32 v153, v34, v35
    v_mfma_f32_16x16x32_bf16 v[108:111], v[128:131], v[148:151], v[108:111]
    v_cvt_pk_bf16_f32 v154, v36, v37
    v_cvt_pk_bf16_f32 v155, v38, v39
    s_waitcnt vmcnt(6)
    s_barrier
    v_exp_f32 v8, v8
    s_add_u32 m0, s57, 0
    v_exp_f32_e64 v9, v9
    buffer_load_dwordx4 v156, s[36:39], s56 offen offset:0 sc1 lds
    v_exp_f32_e64 v10, v10
    v_mfma_f32_32x32x16_bf16 v[24:39], v[132:135], v[120:123], v[88:103]
    ds_read_b128 v[132:135], v157 offset:16384
    v_exp_f32 v11, v11
    v_exp_f32 v12, v12
    v_exp_f32_e64 v13, v13
    v_mfma_f32_32x32x16_bf16 v[56:71], v[144:147], v[152:155], v[56:71]
    ds_read_b128 v[144:147], v157 offset:15360
    v_exp_f32 v14, v14
    v_exp_f32 v15, v15
    v_cvt_pk_bf16_f32 v148, v8, v9
    v_cvt_pk_bf16_f32 v149, v10, v11
    v_mfma_f32_16x16x32_bf16 v[108:111], v[128:131], v[152:155], v[108:111]
    v_cvt_pk_bf16_f32 v150, v12, v13
    v_cvt_pk_bf16_f32 v151, v14, v15
    v_exp_f32 v16, v16
    v_exp_f32 v17, v17
    buffer_load_dwordx4 v156, s[36:39], s56 offen offset:1024 sc1 lds
    v_exp_f32_e64 v18, v18
    v_mfma_f32_32x32x16_bf16 v[24:39], v[136:139], v[124:127], v[24:39]
    ds_read_b128 v[136:139], v157 offset:17408
    v_exp_f32 v19, v19
    v_exp_f32 v20, v20
    v_exp_f32 v21, v21
    s_waitcnt lgkmcnt(3)
    v_mfma_f32_32x32x16_bf16 v[40:55], v[140:143], v[148:151], v[40:55]
    v_exp_f32 v22, v22
    v_exp_f32 v23, v23
    v_cvt_pk_bf16_f32 v152, v16, v17
    v_cvt_pk_bf16_f32 v153, v18, v19
    v_mfma_f32_16x16x32_bf16 v[104:107], v[128:131], v[148:151], v[104:107]
    v_cvt_pk_bf16_f32 v154, v20, v21
    v_cvt_pk_bf16_f32 v155, v22, v23
    v_exp_f32_e64 v24, v24
    buffer_load_dwordx4 v156, s[36:39], s56 offen offset:2048 sc1 lds
    v_exp_f32 v25, v25
    v_exp_f32_e64 v26, v26
    s_waitcnt lgkmcnt(0)
    v_mfma_f32_32x32x16_bf16 v[8:23], v[132:135], v[112:115], v[72:87]
    v_exp_f32 v27, v27
    v_exp_f32 v28, v28
    v_exp_f32_e64 v29, v29
    v_mfma_f32_32x32x16_bf16 v[40:55], v[144:147], v[152:155], v[40:55]
    v_exp_f32 v30, v30
    v_exp_f32 v31, v31
    v_cvt_pk_bf16_f32 v148, v24, v25
    v_cvt_pk_bf16_f32 v149, v26, v27
    v_mfma_f32_16x16x32_bf16 v[104:107], v[128:131], v[152:155], v[104:107]
    v_cvt_pk_bf16_f32 v150, v28, v29
    v_cvt_pk_bf16_f32 v151, v30, v31
    v_exp_f32_e64 v32, v32
    buffer_load_dwordx4 v156, s[36:39], s56 offen offset:3072 sc1 lds
    v_exp_f32_e64 v33, v33
    s_add_u32 s56, s56, 8192
    s_cmp_eq_u32 s56, s51
    s_cselect_b32 s58, 16384, 0
    s_add_u32 s56, s56, s58
    v_exp_f32_e64 v34, v34
    v_mfma_f32_32x32x16_bf16 v[8:23], v[136:139], v[116:119], v[8:23]
    v_exp_f32 v35, v35
    v_exp_f32 v36, v36
    v_exp_f32_e64 v37, v37
    v_mfma_f32_32x32x16_bf16 v[56:71], v[140:143], v[148:151], v[56:71]
    ds_read_b128 v[140:143], v157 offset:18432
    v_exp_f32 v38, v38
    v_exp_f32 v39, v39
    v_cvt_pk_bf16_f32 v152, v32, v33
    v_cvt_pk_bf16_f32 v153, v34, v35
    v_mfma_f32_16x16x32_bf16 v[108:111], v[128:131], v[148:151], v[108:111]
    v_cvt_pk_bf16_f32 v154, v36, v37
    v_cvt_pk_bf16_f32 v155, v38, v39
    v_exp_f32 v8, v8
    v_exp_f32 v9, v9
    v_exp_f32_e64 v10, v10
    v_mfma_f32_32x32x16_bf16 v[24:39], v[132:135], v[120:123], v[88:103]
    ds_read_b128 v[132:135], v157 offset:20480
    v_exp_f32 v11, v11
    v_exp_f32 v12, v12
    v_exp_f32_e64 v13, v13
    v_mfma_f32_32x32x16_bf16 v[56:71], v[144:147], v[152:155], v[56:71]
    ds_read_b128 v[144:147], v157 offset:19456
    v_exp_f32 v14, v14
    v_exp_f32 v15, v15
    v_cvt_pk_bf16_f32 v148, v8, v9
    v_cvt_pk_bf16_f32 v149, v10, v11
    v_mfma_f32_16x16x32_bf16 v[108:111], v[128:131], v[152:155], v[108:111]
    v_cvt_pk_bf16_f32 v150, v12, v13
    v_cvt_pk_bf16_f32 v151, v14, v15
    v_exp_f32 v16, v16
    v_exp_f32 v17, v17
    v_exp_f32_e64 v18, v18
    v_mfma_f32_32x32x16_bf16 v[24:39], v[136:139], v[124:127], v[24:39]
    ds_read_b128 v[136:139], v157 offset:21504
    v_exp_f32 v19, v19
    v_exp_f32 v20, v20
    v_exp_f32 v21, v21
    s_waitcnt lgkmcnt(3)
    v_mfma_f32_32x32x16_bf16 v[40:55], v[140:143], v[148:151], v[40:55]
    v_exp_f32 v22, v22
    v_exp_f32 v23, v23
    v_cvt_pk_bf16_f32 v152, v16, v17
    v_cvt_pk_bf16_f32 v153, v18, v19
    v_mfma_f32_16x16x32_bf16 v[104:107], v[128:131], v[148:151], v[104:107]
    v_cvt_pk_bf16_f32 v154, v20, v21
    v_cvt_pk_bf16_f32 v155, v22, v23
    v_exp_f32 v24, v24
    v_exp_f32 v25, v25
    v_exp_f32 v26, v26
    s_waitcnt lgkmcnt(0)
    v_mfma_f32_32x32x16_bf16 v[8:23], v[132:135], v[112:115], v[72:87]
    v_exp_f32 v27, v27
    v_exp_f32 v28, v28
    v_exp_f32_e64 v29, v29
    v_mfma_f32_32x32x16_bf16 v[40:55], v[144:147], v[152:155], v[40:55]
    v_exp_f32 v30, v30
    v_exp_f32 v31, v31
    v_cvt_pk_bf16_f32 v148, v24, v25
    v_cvt_pk_bf16_f32 v149, v26, v27
    v_mfma_f32_16x16x32_bf16 v[104:107], v[128:131], v[152:155], v[104:107]
    v_cvt_pk_bf16_f32 v150, v28, v29
    v_cvt_pk_bf16_f32 v151, v30, v31
    v_exp_f32 v32, v32
    v_exp_f32 v33, v33
    v_exp_f32_e64 v34, v34
    v_mfma_f32_32x32x16_bf16 v[8:23], v[136:139], v[116:119], v[8:23]
    v_exp_f32 v35, v35
    v_exp_f32 v36, v36
    v_exp_f32_e64 v37, v37
    v_mfma_f32_32x32x16_bf16 v[56:71], v[140:143], v[148:151], v[56:71]
    ds_read_b128 v[140:143], v157 offset:22528
    v_exp_f32 v38, v38
    v_exp_f32 v39, v39
    v_cvt_pk_bf16_f32 v152, v32, v33
    v_cvt_pk_bf16_f32 v153, v34, v35
    v_mfma_f32_16x16x32_bf16 v[108:111], v[128:131], v[148:151], v[108:111]
    v_cvt_pk_bf16_f32 v154, v36, v37
    v_cvt_pk_bf16_f32 v155, v38, v39
    s_waitcnt vmcnt(6)
    s_barrier
    v_exp_f32_e64 v8, v8
    s_add_u32 m0, s57, 8192
    v_exp_f32_e64 v9, v9
    buffer_load_dwordx4 v156, s[36:39], s56 offen offset:0 sc1 lds
    v_exp_f32_e64 v10, v10
    v_mfma_f32_32x32x16_bf16 v[24:39], v[132:135], v[120:123], v[88:103]
    ds_read_b128 v[132:135], v157 offset:24576
    v_exp_f32 v11, v11
    v_exp_f32 v12, v12
    v_exp_f32_e64 v13, v13
    v_mfma_f32_32x32x16_bf16 v[56:71], v[144:147], v[152:155], v[56:71]
    ds_read_b128 v[144:147], v157 offset:23552
    v_exp_f32 v14, v14
    v_exp_f32 v15, v15
    v_cvt_pk_bf16_f32 v148, v8, v9
    v_cvt_pk_bf16_f32 v149, v10, v11
    v_mfma_f32_16x16x32_bf16 v[108:111], v[128:131], v[152:155], v[108:111]
    v_cvt_pk_bf16_f32 v150, v12, v13
    v_cvt_pk_bf16_f32 v151, v14, v15
    v_exp_f32 v16, v16
    v_exp_f32 v17, v17
    buffer_load_dwordx4 v156, s[36:39], s56 offen offset:1024 sc1 lds
    v_exp_f32_e64 v18, v18
    v_mfma_f32_32x32x16_bf16 v[24:39], v[136:139], v[124:127], v[24:39]
    ds_read_b128 v[136:139], v157 offset:25600
    v_exp_f32 v19, v19
    v_exp_f32 v20, v20
    v_exp_f32 v21, v21
    s_waitcnt lgkmcnt(3)
    v_mfma_f32_32x32x16_bf16 v[40:55], v[140:143], v[148:151], v[40:55]
    v_exp_f32 v22, v22
    v_exp_f32 v23, v23
    v_cvt_pk_bf16_f32 v152, v16, v17
    v_cvt_pk_bf16_f32 v153, v18, v19
    v_mfma_f32_16x16x32_bf16 v[104:107], v[128:131], v[148:151], v[104:107]
    v_cvt_pk_bf16_f32 v154, v20, v21
    v_cvt_pk_bf16_f32 v155, v22, v23
    v_exp_f32_e64 v24, v24
    buffer_load_dwordx4 v156, s[36:39], s56 offen offset:2048 sc1 lds
    v_exp_f32 v25, v25
    v_exp_f32_e64 v26, v26
    s_waitcnt lgkmcnt(0)
    v_mfma_f32_32x32x16_bf16 v[8:23], v[132:135], v[112:115], v[72:87]
    v_exp_f32 v27, v27
    v_exp_f32 v28, v28
    v_exp_f32_e64 v29, v29
    v_mfma_f32_32x32x16_bf16 v[40:55], v[144:147], v[152:155], v[40:55]
    v_exp_f32 v30, v30
    v_exp_f32 v31, v31
    v_cvt_pk_bf16_f32 v148, v24, v25
    v_cvt_pk_bf16_f32 v149, v26, v27
    v_mfma_f32_16x16x32_bf16 v[104:107], v[128:131], v[152:155], v[104:107]
    v_cvt_pk_bf16_f32 v150, v28, v29
    v_cvt_pk_bf16_f32 v151, v30, v31
    v_exp_f32_e64 v32, v32
    buffer_load_dwordx4 v156, s[36:39], s56 offen offset:3072 sc1 lds
    v_exp_f32_e64 v33, v33
    s_add_u32 s56, s56, 8192
    s_cmp_eq_u32 s56, s51
    s_cselect_b32 s58, 16384, 0
    s_add_u32 s56, s56, s58
    v_exp_f32_e64 v34, v34
    v_mfma_f32_32x32x16_bf16 v[8:23], v[136:139], v[116:119], v[8:23]
    v_exp_f32 v35, v35
    v_exp_f32 v36, v36
    v_exp_f32_e64 v37, v37
    v_mfma_f32_32x32x16_bf16 v[56:71], v[140:143], v[148:151], v[56:71]
    ds_read_b128 v[140:143], v157 offset:26624
    v_exp_f32 v38, v38
    v_exp_f32 v39, v39
    v_cvt_pk_bf16_f32 v152, v32, v33
    v_cvt_pk_bf16_f32 v153, v34, v35
    v_mfma_f32_16x16x32_bf16 v[108:111], v[128:131], v[148:151], v[108:111]
    v_cvt_pk_bf16_f32 v154, v36, v37
    v_cvt_pk_bf16_f32 v155, v38, v39
    v_exp_f32 v8, v8
    v_exp_f32 v9, v9
    v_exp_f32_e64 v10, v10
    v_mfma_f32_32x32x16_bf16 v[24:39], v[132:135], v[120:123], v[88:103]
    ds_read_b128 v[132:135], v157 offset:28672
    v_exp_f32 v11, v11
    v_exp_f32 v12, v12
    v_exp_f32_e64 v13, v13
    v_mfma_f32_32x32x16_bf16 v[56:71], v[144:147], v[152:155], v[56:71]
    ds_read_b128 v[144:147], v157 offset:27648
    v_exp_f32 v14, v14
    v_exp_f32 v15, v15
    v_cvt_pk_bf16_f32 v148, v8, v9
    v_cvt_pk_bf16_f32 v149, v10, v11
    v_mfma_f32_16x16x32_bf16 v[108:111], v[128:131], v[152:155], v[108:111]
    v_cvt_pk_bf16_f32 v150, v12, v13
    v_cvt_pk_bf16_f32 v151, v14, v15
    v_exp_f32 v16, v16
    v_exp_f32 v17, v17
    v_exp_f32_e64 v18, v18
    v_mfma_f32_32x32x16_bf16 v[24:39], v[136:139], v[124:127], v[24:39]
    ds_read_b128 v[136:139], v157 offset:29696
    v_exp_f32 v19, v19
    v_exp_f32 v20, v20
    v_exp_f32 v21, v21
    s_waitcnt lgkmcnt(3)
    v_mfma_f32_32x32x16_bf16 v[40:55], v[140:143], v[148:151], v[40:55]
    v_exp_f32 v22, v22
    v_exp_f32 v23, v23
    v_cvt_pk_bf16_f32 v152, v16, v17
    v_cvt_pk_bf16_f32 v153, v18, v19
    v_mfma_f32_16x16x32_bf16 v[104:107], v[128:131], v[148:151], v[104:107]
    v_cvt_pk_bf16_f32 v154, v20, v21
    v_cvt_pk_bf16_f32 v155, v22, v23
    v_exp_f32_e64 v24, v24
    buffer_load_dwordx4 v[168:171], v161, s[68:71], s62 offen
    v_exp_f32_e64 v25, v25
    s_add_u32 s62, s62, 2097152
    v_exp_f32 v26, v26
    s_waitcnt lgkmcnt(0)
    v_mfma_f32_32x32x16_bf16 v[8:23], v[132:135], v[112:115], v[72:87]
    v_exp_f32 v27, v27
    v_exp_f32 v28, v28
    v_exp_f32_e64 v29, v29
    v_mfma_f32_32x32x16_bf16 v[40:55], v[144:147], v[152:155], v[40:55]
    v_exp_f32 v30, v30
    v_exp_f32 v31, v31
    v_cvt_pk_bf16_f32 v148, v24, v25
    v_cvt_pk_bf16_f32 v149, v26, v27
    v_mfma_f32_16x16x32_bf16 v[104:107], v[128:131], v[152:155], v[104:107]
    v_cvt_pk_bf16_f32 v150, v28, v29
    v_cvt_pk_bf16_f32 v151, v30, v31
    v_exp_f32 v32, v32
    v_exp_f32 v33, v33
    v_exp_f32_e64 v34, v34
    v_mfma_f32_32x32x16_bf16 v[8:23], v[136:139], v[116:119], v[8:23]
    v_exp_f32 v35, v35
    v_exp_f32 v36, v36
    v_exp_f32_e64 v37, v37
    v_mfma_f32_32x32x16_bf16 v[56:71], v[140:143], v[148:151], v[56:71]
    ds_read_b128 v[140:143], v157 offset:30720
    v_exp_f32 v38, v38
    v_exp_f32 v39, v39
    v_cvt_pk_bf16_f32 v152, v32, v33
    v_cvt_pk_bf16_f32 v153, v34, v35
    v_mfma_f32_16x16x32_bf16 v[108:111], v[128:131], v[148:151], v[108:111]
    v_cvt_pk_bf16_f32 v154, v36, v37
    v_cvt_pk_bf16_f32 v155, v38, v39
    s_waitcnt vmcnt(5)
    s_barrier
    v_exp_f32_e64 v8, v8
    s_add_u32 m0, s57, 16384
    v_exp_f32_e64 v9, v9
    buffer_load_dwordx4 v156, s[36:39], s56 offen offset:0 sc1 lds
    v_exp_f32_e64 v10, v10
    v_mfma_f32_32x32x16_bf16 v[24:39], v[132:135], v[120:123], v[88:103]
    ds_read_b128 v[132:135], v157 offset:0
    v_exp_f32 v11, v11
    v_exp_f32 v12, v12
    v_exp_f32_e64 v13, v13
    v_mfma_f32_32x32x16_bf16 v[56:71], v[144:147], v[152:155], v[56:71]
    ds_read_b128 v[144:147], v157 offset:31744
    v_exp_f32 v14, v14
    v_exp_f32 v15, v15
    v_cvt_pk_bf16_f32 v148, v8, v9
    v_cvt_pk_bf16_f32 v149, v10, v11
    v_mfma_f32_16x16x32_bf16 v[108:111], v[128:131], v[152:155], v[108:111]
    v_cvt_pk_bf16_f32 v150, v12, v13
    v_cvt_pk_bf16_f32 v151, v14, v15
    v_exp_f32 v16, v16
    v_exp_f32 v17, v17
    buffer_load_dwordx4 v156, s[36:39], s56 offen offset:1024 sc1 lds
    v_exp_f32_e64 v18, v18
    v_mfma_f32_32x32x16_bf16 v[24:39], v[136:139], v[124:127], v[24:39]
    ds_read_b128 v[136:139], v157 offset:1024
    v_exp_f32 v19, v19
    v_exp_f32 v20, v20
    v_exp_f32 v21, v21
    s_waitcnt lgkmcnt(3)
    v_mfma_f32_32x32x16_bf16 v[40:55], v[140:143], v[148:151], v[40:55]
    v_exp_f32 v22, v22
    v_exp_f32 v23, v23
    v_cvt_pk_bf16_f32 v152, v16, v17
    v_cvt_pk_bf16_f32 v153, v18, v19
    v_mfma_f32_16x16x32_bf16 v[104:107], v[128:131], v[148:151], v[104:107]
    v_cvt_pk_bf16_f32 v154, v20, v21
    v_cvt_pk_bf16_f32 v155, v22, v23
    v_exp_f32_e64 v24, v24
    buffer_load_dwordx4 v156, s[36:39], s56 offen offset:2048 sc1 lds
    v_exp_f32 v25, v25
    v_exp_f32_e64 v26, v26
    s_waitcnt lgkmcnt(0)
    v_mfma_f32_32x32x16_bf16 v[8:23], v[132:135], v[112:115], v[72:87]
    v_exp_f32 v27, v27
    v_exp_f32 v28, v28
    v_exp_f32_e64 v29, v29
    v_mfma_f32_32x32x16_bf16 v[40:55], v[144:147], v[152:155], v[40:55]
    v_exp_f32 v30, v30
    v_exp_f32 v31, v31
    v_cvt_pk_bf16_f32 v148, v24, v25
    v_cvt_pk_bf16_f32 v149, v26, v27
    v_mfma_f32_16x16x32_bf16 v[104:107], v[128:131], v[152:155], v[104:107]
    v_cvt_pk_bf16_f32 v150, v28, v29
    v_cvt_pk_bf16_f32 v151, v30, v31
    v_exp_f32_e64 v32, v32
    buffer_load_dwordx4 v156, s[36:39], s56 offen offset:3072 sc1 lds
    v_exp_f32_e64 v33, v33
    s_add_u32 s56, s56, 8192
    s_cmp_eq_u32 s56, s51
    s_cselect_b32 s58, 16384, 0
    s_add_u32 s56, s56, s58
    v_exp_f32_e64 v34, v34
    v_mfma_f32_32x32x16_bf16 v[8:23], v[136:139], v[116:119], v[8:23]
    v_exp_f32 v35, v35
    v_exp_f32 v36, v36
    v_exp_f32_e64 v37, v37
    v_mfma_f32_32x32x16_bf16 v[56:71], v[140:143], v[148:151], v[56:71]
    ds_read_b128 v[140:143], v157 offset:2048
    v_exp_f32 v38, v38
    v_exp_f32 v39, v39
    s_sub_u32 s59, s59, 1
    s_cmp_lg_u32 s59, 0
    v_cvt_pk_bf16_f32 v152, v32, v33
    v_cvt_pk_bf16_f32 v153, v34, v35
    v_mfma_f32_16x16x32_bf16 v[108:111], v[128:131], v[148:151], v[108:111]
    v_cvt_pk_bf16_f32 v154, v36, v37
    v_cvt_pk_bf16_f32 v155, v38, v39
L_attn_loop:
    v_exp_f32 v8, v8
    v_exp_f32 v9, v9
    v_exp_f32_e64 v10, v10
    v_mfma_f32_32x32x16_bf16 v[24:39], v[132:135], v[120:123], v[88:103]
    ds_read_b128 v[132:135], v157 offset:4096
    v_exp_f32 v11, v11
    v_exp_f32 v12, v12
    v_exp_f32_e64 v13, v13
    v_mfma_f32_32x32x16_bf16 v[56:71], v[144:147], v[152:155], v[56:71]
    ds_read_b128 v[144:147], v157 offset:3072
    v_exp_f32 v14, v14
    v_exp_f32 v15, v15
    v_cvt_pk_bf16_f32 v148, v8, v9
    v_cvt_pk_bf16_f32 v149, v10, v11
    v_mfma_f32_16x16x32_bf16 v[108:111], v[128:131], v[152:155], v[108:111]
    v_cvt_pk_bf16_f32 v150, v12, v13
    v_cvt_pk_bf16_f32 v151, v14, v15
    v_exp_f32 v16, v16
    v_exp_f32 v17, v17
    v_exp_f32_e64 v18, v18
    v_mfma_f32_32x32x16_bf16 v[24:39], v[136:139], v[124:127], v[24:39]
    ds_read_b128 v[136:139], v157 offset:5120
    v_exp_f32 v19, v19
    v_exp_f32 v20, v20
    v_exp_f32 v21, v21
    s_waitcnt lgkmcnt(3)
    v_mfma_f32_32x32x16_bf16 v[40:55], v[140:143], v[148:151], v[40:55]
    v_exp_f32 v22, v22
    v_exp_f32 v23, v23
    v_cvt_pk_bf16_f32 v152, v16, v17
    v_cvt_pk_bf16_f32 v153, v18, v19
    v_mfma_f32_16x16x32_bf16 v[104:107], v[128:131], v[148:151], v[104:107]
    v_cvt_pk_bf16_f32 v154, v20, v21
    v_cvt_pk_bf16_f32 v155, v22, v23
    v_exp_f32 v24, v24
    v_exp_f32 v25, v25
    v_exp_f32 v26, v26
    s_waitcnt lgkmcnt(0)
    v_mfma_f32_32x32x16_bf16 v[8:23], v[132:135], v[112:115], v[72:87]
    v_exp_f32 v27, v27
    v_exp_f32 v28, v28
    v_exp_f32_e64 v29, v29
    v_mfma_f32_32x32x16_bf16 v[40:55], v[144:147], v[152:155], v[40:55]
    v_exp_f32 v30, v30
    v_exp_f32 v31, v31
    v_cvt_pk_bf16_f32 v148, v24, v25
    v_cvt_pk_bf16_f32 v149, v26, v27
    v_mfma_f32_16x16x32_bf16 v[104:107], v[128:131], v[152:155], v[104:107]
    v_cvt_pk_bf16_f32 v150, v28, v29
    v_cvt_pk_bf16_f32 v151, v30, v31
    v_exp_f32 v32, v32
    v_exp_f32 v33, v33
    v_exp_f32_e64 v34, v34
    v_mfma_f32_32x32x16_bf16 v[8:23], v[136:139], v[116:119], v[8:23]
    v_exp_f32 v35, v35
    v_exp_f32 v36, v36
    v_exp_f32_e64 v37, v37
    v_mfma_f32_32x32x16_bf16 v[56:71], v[140:143], v[148:151], v[56:71]
    ds_read_b128 v[140:143], v157 offset:6144
    v_exp_f32 v38, v38
    v_exp_f32 v39, v39
    v_cvt_pk_bf16_f32 v152, v32, v33
    v_cvt_pk_bf16_f32 v153, v34, v35
    v_mfma_f32_16x16x32_bf16 v[108:111], v[128:131], v[148:151], v[108:111]
    v_cvt_pk_bf16_f32 v154, v36, v37
    v_cvt_pk_bf16_f32 v155, v38, v39
    s_waitcnt vmcnt(5)
    s_barrier
    v_exp_f32_e64 v8, v8
    s_add_u32 m0, s57, 24576
    v_exp_f32_e64 v9, v9
    buffer_load_dwordx4 v156, s[36:39], s56 offen offset:0 sc1 lds
    v_exp_f32_e64 v10, v10
    v_mfma_f32_32x32x16_bf16 v[24:39], v[132:135], v[120:123], v[88:103]
    ds_read_b128 v[132:135], v157 offset:8192
    v_exp_f32 v11, v11
    v_exp_f32 v12, v12
    v_exp_f32_e64 v13, v13
    v_mfma_f32_32x32x16_bf16 v[56:71], v[144:147], v[152:155], v[56:71]
    ds_read_b128 v[144:147], v157 offset:7168
    v_exp_f32 v14, v14
    v_exp_f32 v15, v15
    v_cvt_pk_bf16_f32 v148, v8, v9
    v_cvt_pk_bf16_f32 v149, v10, v11
    v_mfma_f32_16x16x32_bf16 v[108:111], v[128:131], v[152:155], v[108:111]
    v_cvt_pk_bf16_f32 v150, v12, v13
    v_cvt_pk_bf16_f32 v151, v14, v15
    v_exp_f32 v16, v16
    v_exp_f32 v17, v17
    buffer_load_dwordx4 v156, s[36:39], s56 offen offset:1024 sc1 lds
    v_exp_f32_e64 v18, v18
    v_mfma_f32_32x32x16_bf16 v[24:39], v[136:139], v[124:127], v[24:39]
    ds_read_b128 v[136:139], v157 offset:9216
    v_exp_f32 v19, v19
    v_exp_f32 v20, v20
    v_exp_f32 v21, v21
    s_waitcnt lgkmcnt(3)
    v_mfma_f32_32x32x16_bf16 v[40:55], v[140:143], v[148:151], v[40:55]
    v_exp_f32 v22, v22
    v_exp_f32 v23, v23
    v_cvt_pk_bf16_f32 v152, v16, v17
    v_cvt_pk_bf16_f32 v153, v18, v19
    v_mfma_f32_16x16x32_bf16 v[104:107], v[128:131], v[148:151], v[104:107]
    v_cvt_pk_bf16_f32 v154, v20, v21
    v_cvt_pk_bf16_f32 v155, v22, v23
    v_exp_f32_e64 v24, v24
    buffer_load_dwordx4 v156, s[36:39], s56 offen offset:2048 sc1 lds
    v_exp_f32 v25, v25
    v_exp_f32_e64 v26, v26
    s_waitcnt lgkmcnt(0)
    v_mfma_f32_32x32x16_bf16 v[8:23], v[132:135], v[112:115], v[72:87]
    v_exp_f32 v27, v27
    v_exp_f32 v28, v28
    v_exp_f32_e64 v29, v29
    v_mfma_f32_32x32x16_bf16 v[40:55], v[144:147], v[152:155], v[40:55]
    v_exp_f32 v30, v30
    v_exp_f32 v31, v31
    v_cvt_pk_bf16_f32 v148, v24, v25
    v_cvt_pk_bf16_f32 v149, v26, v27
    v_mfma_f32_16x16x32_bf16 v[104:107], v[128:131], v[152:155], v[104:107]
    v_cvt_pk_bf16_f32 v150, v28, v29
    v_cvt_pk_bf16_f32 v151, v30, v31
    v_exp_f32_e64 v32, v32
    buffer_load_dwordx4 v156, s[36:39], s56 offen offset:3072 sc1 lds
    v_exp_f32_e64 v33, v33
    s_add_u32 s56, s56, 8192
    s_cmp_eq_u32 s56, s51
    s_cselect_b32 s58, 16384, 0
    s_add_u32 s56, s56, s58
    v_exp_f32_e64 v34, v34
    v_mfma_f32_32x32x16_bf16 v[8:23], v[136:139], v[116:119], v[8:23]
    v_exp_f32 v35, v35
    v_exp_f32 v36, v36
    v_exp_f32_e64 v37, v37
    v_mfma_f32_32x32x16_bf16 v[56:71], v[140:143], v[148:151], v[56:71]
    ds_read_b128 v[140:143], v157 offset:10240
    v_exp_f32 v38, v38
    v_exp_f32 v39, v39
    v_cvt_pk_bf16_f32 v152, v32, v33
    v_cvt_pk_bf16_f32 v153, v34, v35
    v_mfma_f32_16x16x32_bf16 v[108:111], v[128:131], v[148:151], v[108:111]
    v_cvt_pk_bf16_f32 v154, v36, v37
    v_cvt_pk_bf16_f32 v155, v38, v39
    v_exp_f32_e64 v8, v8
    buffer_load_dwordx4 v[168:171], v161, s[64:67], s62 offen
    v_exp_f32 v9, v9
    v_exp_f32 v10, v10
    v_mfma_f32_32x32x16_bf16 v[24:39], v[132:135], v[120:123], v[88:103]
    ds_read_b128 v[132:135], v157 offset:12288
    v_exp_f32 v11, v11
    v_exp_f32 v12, v12
    v_exp_f32_e64 v13, v13
    v_mfma_f32_32x32x16_bf16 v[56:71], v[144:147], v[152:155], v[56:71]
    ds_read_b128 v[144:147], v157 offset:11264
    v_exp_f32 v14, v14
    v_exp_f32 v15, v15
    v_cvt_pk_bf16_f32 v148, v8, v9
    v_cvt_pk_bf16_f32 v149, v10, v11
    v_mfma_f32_16x16x32_bf16 v[108:111], v[128:131], v[152:155], v[108:111]
    v_cvt_pk_bf16_f32 v150, v12, v13
    v_cvt_pk_bf16_f32 v151, v14, v15
    v_exp_f32 v16, v16
    v_exp_f32 v17, v17
    v_exp_f32_e64 v18, v18
    v_mfma_f32_32x32x16_bf16 v[24:39], v[136:139], v[124:127], v[24:39]
    ds_read_b128 v[136:139], v157 offset:13312
    v_exp_f32 v19, v19
    v_exp_f32 v20, v20
    v_exp_f32 v21, v21
    s_waitcnt lgkmcnt(3)
    v_mfma_f32_32x32x16_bf16 v[40:55], v[140:143], v[148:151], v[40:55]
    v_exp_f32 v22, v22
    v_exp_f32 v23, v23
    v_cvt_pk_bf16_f32 v152, v16, v17
    v_cvt_pk_bf16_f32 v153, v18, v19
    v_mfma_f32_16x16x32_bf16 v[104:107], v[128:131], v[148:151], v[104:107]
    v_cvt_pk_bf16_f32 v154, v20, v21
    v_cvt_pk_bf16_f32 v155, v22, v23
    v_exp_f32 v24, v24
    v_exp_f32 v25, v25
    v_exp_f32 v26, v26
    s_waitcnt lgkmcnt(0)
    v_mfma_f32_32x32x16_bf16 v[8:23], v[132:135], v[112:115], v[72:87]
    v_exp_f32 v27, v27
    v_exp_f32 v28, v28
    v_exp_f32_e64 v29, v29
    v_mfma_f32_32x32x16_bf16 v[40:55], v[144:147], v[152:155], v[40:55]
    v_exp_f32 v30, v30
    v_exp_f32 v31, v31
    v_cvt_pk_bf16_f32 v148, v24, v25
    v_cvt_pk_bf16_f32 v149, v26, v27
    v_mfma_f32_16x16x32_bf16 v[104:107], v[128:131], v[152:155], v[104:107]
    v_cvt_pk_bf16_f32 v150, v28, v29
    v_cvt_pk_bf16_f32 v151, v30, v31
    v_exp_f32 v32, v32
    v_exp_f32 v33, v33
    v_exp_f32_e64 v34, v34
    v_mfma_f32_32x32x16_bf16 v[8:23], v[136:139], v[116:119], v[8:23]
    v_exp_f32 v35, v35
    v_exp_f32 v36, v36
    v_exp_f32_e64 v37, v37
    v_mfma_f32_32x32x16_bf16 v[56:71], v[140:143], v[148:151], v[56:71]
    ds_read_b128 v[140:143], v157 offset:14336
    v_exp_f32 v38, v38
    v_exp_f32 v39, v39
    v_cvt_pk_bf16_f32 v152, v32, v33
    v_cvt_pk_bf16_f32 v153, v34, v35
    v_mfma_f32_16x16x32_bf16 v[108:111], v[128:131], v[148:151], v[108:111]
    v_cvt_pk_bf16_f32 v154, v36, v37
    v_cvt_pk_bf16_f32 v155, v38, v39
    s_waitcnt vmcnt(5)
    s_barrier
    v_exp_f32 v8, v8
    s_add_u32 m0, s57, 0
    v_exp_f32_e64 v9, v9
    buffer_load_dwordx4 v156, s[36:39], s56 offen offset:0 sc1 lds
    v_exp_f32_e64 v10, v10
    v_mfma_f32_32x32x16_bf16 v[24:39], v[132:135], v[120:123], v[88:103]
    ds_read_b128 v[132:135], v157 offset:16384
    v_exp_f32 v11, v11
    v_exp_f32 v12, v12
    v_exp_f32_e64 v13, v13
    v_mfma_f32_32x32x16_bf16 v[56:71], v[144:147], v[152:155], v[56:71]
    ds_read_b128 v[144:147], v157 offset:15360
    v_exp_f32 v14, v14
    v_exp_f32 v15, v15
    v_cvt_pk_bf16_f32 v148, v8, v9
    v_cvt_pk_bf16_f32 v149, v10, v11
    v_mfma_f32_16x16x32_bf16 v[108:111], v[128:131], v[152:155], v[108:111]
    v_cvt_pk_bf16_f32 v150, v12, v13
    v_cvt_pk_bf16_f32 v151, v14, v15
    v_exp_f32 v16, v16
    v_exp_f32 v17, v17
    buffer_load_dwordx4 v156, s[36:39], s56 offen offset:1024 sc1 lds
    v_exp_f32_e64 v18, v18
    v_mfma_f32_32x32x16_bf16 v[24:39], v[136:139], v[124:127], v[24:39]
    ds_read_b128 v[136:139], v157 offset:17408
    v_exp_f32 v19, v19
    v_exp_f32 v20, v20
    v_exp_f32 v21, v21
    s_waitcnt lgkmcnt(3)
    v_mfma_f32_32x32x16_bf16 v[40:55], v[140:143], v[148:151], v[40:55]
    v_exp_f32 v22, v22
    v_exp_f32 v23, v23
    v_cvt_pk_bf16_f32 v152, v16, v17
    v_cvt_pk_bf16_f32 v153, v18, v19
    v_mfma_f32_16x16x32_bf16 v[104:107], v[128:131], v[148:151], v[104:107]
    v_cvt_pk_bf16_f32 v154, v20, v21
    v_cvt_pk_bf16_f32 v155, v22, v23
    v_exp_f32_e64 v24, v24
    buffer_load_dwordx4 v156, s[36:39], s56 offen offset:2048 sc1 lds
    v_exp_f32 v25, v25
    v_exp_f32_e64 v26, v26
    s_waitcnt lgkmcnt(0)
    v_mfma_f32_32x32x16_bf16 v[8:23], v[132:135], v[112:115], v[72:87]
    v_exp_f32 v27, v27
    v_exp_f32 v28, v28
    v_exp_f32_e64 v29, v29
    v_mfma_f32_32x32x16_bf16 v[40:55], v[144:147], v[152:155], v[40:55]
    v_exp_f32 v30, v30
    v_exp_f32 v31, v31
    v_cvt_pk_bf16_f32 v148, v24, v25
    v_cvt_pk_bf16_f32 v149, v26, v27
    v_mfma_f32_16x16x32_bf16 v[104:107], v[128:131], v[152:155], v[104:107]
    v_cvt_pk_bf16_f32 v150, v28, v29
    v_cvt_pk_bf16_f32 v151, v30, v31
    v_exp_f32_e64 v32, v32
    buffer_load_dwordx4 v156, s[36:39], s56 offen offset:3072 sc1 lds
    v_exp_f32_e64 v33, v33
    s_add_u32 s56, s56, 8192
    s_cmp_eq_u32 s56, s51
    s_cselect_b32 s58, 16384, 0
    s_add_u32 s56, s56, s58
    v_exp_f32_e64 v34, v34
    v_mfma_f32_32x32x16_bf16 v[8:23], v[136:139], v[116:119], v[8:23]
    v_exp_f32 v35, v35
    v_exp_f32 v36, v36
    v_exp_f32_e64 v37, v37
    v_mfma_f32_32x32x16_bf16 v[56:71], v[140:143], v[148:151], v[56:71]
    ds_read_b128 v[140:143], v157 offset:18432
    v_exp_f32 v38, v38
    v_exp_f32 v39, v39
    v_cvt_pk_bf16_f32 v152, v32, v33
    v_cvt_pk_bf16_f32 v153, v34, v35
    v_mfma_f32_16x16x32_bf16 v[108:111], v[128:131], v[148:151], v[108:111]
    v_cvt_pk_bf16_f32 v154, v36, v37
    v_cvt_pk_bf16_f32 v155, v38, v39
    v_exp_f32 v8, v8
    v_exp_f32 v9, v9
    v_exp_f32_e64 v10, v10
    v_mfma_f32_32x32x16_bf16 v[24:39], v[132:135], v[120:123], v[88:103]
    ds_read_b128 v[132:135], v157 offset:20480
    v_exp_f32 v11, v11
    v_exp_f32 v12, v12
    v_exp_f32_e64 v13, v13
    v_mfma_f32_32x32x16_bf16 v[56:71], v[144:147], v[152:155], v[56:71]
    ds_read_b128 v[144:147], v157 offset:19456
    v_exp_f32 v14, v14
    v_exp_f32 v15, v15
    v_cvt_pk_bf16_f32 v148, v8, v9
    v_cvt_pk_bf16_f32 v149, v10, v11
    v_mfma_f32_16x16x32_bf16 v[108:111], v[128:131], v[152:155], v[108:111]
    v_cvt_pk_bf16_f32 v150, v12, v13
    v_cvt_pk_bf16_f32 v151, v14, v15
    v_exp_f32 v16, v16
    v_exp_f32 v17, v17
    v_exp_f32_e64 v18, v18
    v_mfma_f32_32x32x16_bf16 v[24:39], v[136:139], v[124:127], v[24:39]
    ds_read_b128 v[136:139], v157 offset:21504
    v_exp_f32 v19, v19
    v_exp_f32 v20, v20
    v_exp_f32 v21, v21
    s_waitcnt lgkmcnt(3)
    v_mfma_f32_32x32x16_bf16 v[40:55], v[140:143], v[148:151], v[40:55]
    v_exp_f32 v22, v22
    v_exp_f32 v23, v23
    v_cvt_pk_bf16_f32 v152, v16, v17
    v_cvt_pk_bf16_f32 v153, v18, v19
    v_mfma_f32_16x16x32_bf16 v[104:107], v[128:131], v[148:151], v[104:107]
    v_cvt_pk_bf16_f32 v154, v20, v21
    v_cvt_pk_bf16_f32 v155, v22, v23
    v_exp_f32 v24, v24
    v_exp_f32 v25, v25
    v_exp_f32 v26, v26
    s_waitcnt lgkmcnt(0)
    v_mfma_f32_32x32x16_bf16 v[8:23], v[132:135], v[112:115], v[72:87]
    v_exp_f32 v27, v27
    v_exp_f32 v28, v28
    v_exp_f32_e64 v29, v29
    v_mfma_f32_32x32x16_bf16 v[40:55], v[144:147], v[152:155], v[40:55]
    v_exp_f32 v30, v30
    v_exp_f32 v31, v31
    v_cvt_pk_bf16_f32 v148, v24, v25
    v_cvt_pk_bf16_f32 v149, v26, v27
    v_mfma_f32_16x16x32_bf16 v[104:107], v[128:131], v[152:155], v[104:107]
    v_cvt_pk_bf16_f32 v150, v28, v29
    v_cvt_pk_bf16_f32 v151, v30, v31
    v_exp_f32 v32, v32
    v_exp_f32 v33, v33
    v_exp_f32_e64 v34, v34
    v_mfma_f32_32x32x16_bf16 v[8:23], v[136:139], v[116:119], v[8:23]
    v_exp_f32 v35, v35
    v_exp_f32 v36, v36
    v_exp_f32_e64 v37, v37
    v_mfma_f32_32x32x16_bf16 v[56:71], v[140:143], v[148:151], v[56:71]
    ds_read_b128 v[140:143], v157 offset:22528
    v_exp_f32 v38, v38
    v_exp_f32 v39, v39
    v_cvt_pk_bf16_f32 v152, v32, v33
    v_cvt_pk_bf16_f32 v153, v34, v35
    v_mfma_f32_16x16x32_bf16 v[108:111], v[128:131], v[148:151], v[108:111]
    v_cvt_pk_bf16_f32 v154, v36, v37
    v_cvt_pk_bf16_f32 v155, v38, v39
    s_waitcnt vmcnt(5)
    s_barrier
    v_exp_f32_e64 v8, v8
    s_add_u32 m0, s57, 8192
    v_exp_f32_e64 v9, v9
    buffer_load_dwordx4 v156, s[36:39], s56 offen offset:0 sc1 lds
    v_exp_f32_e64 v10, v10
    v_mfma_f32_32x32x16_bf16 v[24:39], v[132:135], v[120:123], v[88:103]
    ds_read_b128 v[132:135], v157 offset:24576
    v_exp_f32 v11, v11
    v_exp_f32 v12, v12
    v_exp_f32_e64 v13, v13
    v_mfma_f32_32x32x16_bf16 v[56:71], v[144:147], v[152:155], v[56:71]
    ds_read_b128 v[144:147], v157 offset:23552
    v_exp_f32 v14, v14
    v_exp_f32 v15, v15
    v_cvt_pk_bf16_f32 v148, v8, v9
    v_cvt_pk_bf16_f32 v149, v10, v11
    v_mfma_f32_16x16x32_bf16 v[108:111], v[128:131], v[152:155], v[108:111]
    v_cvt_pk_bf16_f32 v150, v12, v13
    v_cvt_pk_bf16_f32 v151, v14, v15
    v_exp_f32 v16, v16
    v_exp_f32 v17, v17
    buffer_load_dwordx4 v156, s[36:39], s56 offen offset:1024 sc1 lds
    v_exp_f32_e64 v18, v18
    v_mfma_f32_32x32x16_bf16 v[24:39], v[136:139], v[124:127], v[24:39]
    ds_read_b128 v[136:139], v157 offset:25600
    v_exp_f32 v19, v19
    v_exp_f32 v20, v20
    v_exp_f32 v21, v21
    s_waitcnt lgkmcnt(3)
    v_mfma_f32_32x32x16_bf16 v[40:55], v[140:143], v[148:151], v[40:55]
    v_exp_f32 v22, v22
    v_exp_f32 v23, v23
    v_cvt_pk_bf16_f32 v152, v16, v17
    v_cvt_pk_bf16_f32 v153, v18, v19
    v_mfma_f32_16x16x32_bf16 v[104:107], v[128:131], v[148:151], v[104:107]
    v_cvt_pk_bf16_f32 v154, v20, v21
    v_cvt_pk_bf16_f32 v155, v22, v23
    v_exp_f32_e64 v24, v24
    buffer_load_dwordx4 v156, s[36:39], s56 offen offset:2048 sc1 lds
    v_exp_f32 v25, v25
    v_exp_f32_e64 v26, v26
    s_waitcnt lgkmcnt(0)
    v_mfma_f32_32x32x16_bf16 v[8:23], v[132:135], v[112:115], v[72:87]
    v_exp_f32 v27, v27
    v_exp_f32 v28, v28
    v_exp_f32_e64 v29, v29
    v_mfma_f32_32x32x16_bf16 v[40:55], v[144:147], v[152:155], v[40:55]
    v_exp_f32 v30, v30
    v_exp_f32 v31, v31
    v_cvt_pk_bf16_f32 v148, v24, v25
    v_cvt_pk_bf16_f32 v149, v26, v27
    v_mfma_f32_16x16x32_bf16 v[104:107], v[128:131], v[152:155], v[104:107]
    v_cvt_pk_bf16_f32 v150, v28, v29
    v_cvt_pk_bf16_f32 v151, v30, v31
    v_exp_f32_e64 v32, v32
    buffer_load_dwordx4 v156, s[36:39], s56 offen offset:3072 sc1 lds
    v_exp_f32_e64 v33, v33
    s_add_u32 s56, s56, 8192
    s_cmp_eq_u32 s56, s51
    s_cselect_b32 s58, 16384, 0
    s_add_u32 s56, s56, s58
    v_exp_f32_e64 v34, v34
    v_mfma_f32_32x32x16_bf16 v[8:23], v[136:139], v[116:119], v[8:23]
    v_exp_f32 v35, v35
    v_exp_f32 v36, v36
    v_exp_f32_e64 v37, v37
    v_mfma_f32_32x32x16_bf16 v[56:71], v[140:143], v[148:151], v[56:71]
    ds_read_b128 v[140:143], v157 offset:26624
    v_exp_f32 v38, v38
    v_exp_f32 v39, v39
    v_cvt_pk_bf16_f32 v152, v32, v33
    v_cvt_pk_bf16_f32 v153, v34, v35
    v_mfma_f32_16x16x32_bf16 v[108:111], v[128:131], v[148:151], v[108:111]
    v_cvt_pk_bf16_f32 v154, v36, v37
    v_cvt_pk_bf16_f32 v155, v38, v39
    v_exp_f32_e64 v8, v8
    buffer_load_dwordx4 v[168:171], v161, s[68:71], s62 offen
    v_exp_f32_e64 v9, v9
    s_add_u32 s62, s62, 2097152
    v_exp_f32_e64 v10, v10
    v_mfma_f32_32x32x16_bf16 v[24:39], v[132:135], v[120:123], v[88:103]
    ds_read_b128 v[132:135], v157 offset:28672
    v_exp_f32 v11, v11
    v_exp_f32 v12, v12
    v_exp_f32_e64 v13, v13
    v_mfma_f32_32x32x16_bf16 v[56:71], v[144:147], v[152:155], v[56:71]
    ds_read_b128 v[144:147], v157 offset:27648
    v_exp_f32 v14, v14
    v_exp_f32 v15, v15
    v_cvt_pk_bf16_f32 v148, v8, v9
    v_cvt_pk_bf16_f32 v149, v10, v11
    v_mfma_f32_16x16x32_bf16 v[108:111], v[128:131], v[152:155], v[108:111]
    v_cvt_pk_bf16_f32 v150, v12, v13
    v_cvt_pk_bf16_f32 v151, v14, v15
    v_exp_f32 v16, v16
    v_exp_f32 v17, v17
    v_exp_f32_e64 v18, v18
    v_mfma_f32_32x32x16_bf16 v[24:39], v[136:139], v[124:127], v[24:39]
    ds_read_b128 v[136:139], v157 offset:29696
    v_exp_f32 v19, v19
    v_exp_f32 v20, v20
    v_exp_f32 v21, v21
    s_waitcnt lgkmcnt(3)
    v_mfma_f32_32x32x16_bf16 v[40:55], v[140:143], v[148:151], v[40:55]
    v_exp_f32 v22, v22
    v_exp_f32 v23, v23
    v_cvt_pk_bf16_f32 v152, v16, v17
    v_cvt_pk_bf16_f32 v153, v18, v19
    v_mfma_f32_16x16x32_bf16 v[104:107], v[128:131], v[148:151], v[104:107]
    v_cvt_pk_bf16_f32 v154, v20, v21
    v_cvt_pk_bf16_f32 v155, v22, v23
    v_exp_f32 v24, v24
    v_exp_f32 v25, v25
    v_exp_f32 v26, v26
    s_waitcnt lgkmcnt(0)
    v_mfma_f32_32x32x16_bf16 v[8:23], v[132:135], v[112:115], v[72:87]
    v_exp_f32 v27, v27
    v_exp_f32 v28, v28
    v_exp_f32_e64 v29, v29
    v_mfma_f32_32x32x16_bf16 v[40:55], v[144:147], v[152:155], v[40:55]
    v_exp_f32 v30, v30
    v_exp_f32 v31, v31
    v_cvt_pk_bf16_f32 v148, v24, v25
    v_cvt_pk_bf16_f32 v149, v26, v27
    v_mfma_f32_16x16x32_bf16 v[104:107], v[128:131], v[152:155], v[104:107]
    v_cvt_pk_bf16_f32 v150, v28, v29
    v_cvt_pk_bf16_f32 v151, v30, v31
    v_exp_f32 v32, v32
    v_exp_f32 v33, v33
    v_exp_f32_e64 v34, v34
    v_mfma_f32_32x32x16_bf16 v[8:23], v[136:139], v[116:119], v[8:23]
    v_exp_f32 v35, v35
    v_exp_f32 v36, v36
    v_exp_f32_e64 v37, v37
    v_mfma_f32_32x32x16_bf16 v[56:71], v[140:143], v[148:151], v[56:71]
    ds_read_b128 v[140:143], v157 offset:30720
    v_exp_f32 v38, v38
    v_exp_f32 v39, v39
    v_cvt_pk_bf16_f32 v152, v32, v33
    v_cvt_pk_bf16_f32 v153, v34, v35
    v_mfma_f32_16x16x32_bf16 v[108:111], v[128:131], v[148:151], v[108:111]
    v_cvt_pk_bf16_f32 v154, v36, v37
    v_cvt_pk_bf16_f32 v155, v38, v39
    s_waitcnt vmcnt(5)
    s_barrier
    v_exp_f32_e64 v8, v8
    s_add_u32 m0, s57, 16384
    v_exp_f32_e64 v9, v9
    buffer_load_dwordx4 v156, s[36:39], s56 offen offset:0 sc1 lds
    v_exp_f32_e64 v10, v10
    v_mfma_f32_32x32x16_bf16 v[24:39], v[132:135], v[120:123], v[88:103]
    ds_read_b128 v[132:135], v157 offset:0
    v_exp_f32 v11, v11
    v_exp_f32 v12, v12
    v_exp_f32_e64 v13, v13
    v_mfma_f32_32x32x16_bf16 v[56:71], v[144:147], v[152:155], v[56:71]
    ds_read_b128 v[144:147], v157 offset:31744
    v_exp_f32 v14, v14
    v_exp_f32 v15, v15
    v_cvt_pk_bf16_f32 v148, v8, v9
    v_cvt_pk_bf16_f32 v149, v10, v11
    v_mfma_f32_16x16x32_bf16 v[108:111], v[128:131], v[152:155], v[108:111]
    v_cvt_pk_bf16_f32 v150, v12, v13
    v_cvt_pk_bf16_f32 v151, v14, v15
    v_exp_f32 v16, v16
    v_exp_f32 v17, v17
    buffer_load_dwordx4 v156, s[36:39], s56 offen offset:1024 sc1 lds
    v_exp_f32_e64 v18, v18
    v_mfma_f32_32x32x16_bf16 v[24:39], v[136:139], v[124:127], v[24:39]
    ds_read_b128 v[136:139], v157 offset:1024
    v_exp_f32 v19, v19
    v_exp_f32 v20, v20
    v_exp_f32 v21, v21
    s_waitcnt lgkmcnt(3)
    v_mfma_f32_32x32x16_bf16 v[40:55], v[140:143], v[148:151], v[40:55]
    v_exp_f32 v22, v22
    v_exp_f32 v23, v23
    v_cvt_pk_bf16_f32 v152, v16, v17
    v_cvt_pk_bf16_f32 v153, v18, v19
    v_mfma_f32_16x16x32_bf16 v[104:107], v[128:131], v[148:151], v[104:107]
    v_cvt_pk_bf16_f32 v154, v20, v21
    v_cvt_pk_bf16_f32 v155, v22, v23
    v_exp_f32_e64 v24, v24
    buffer_load_dwordx4 v156, s[36:39], s56 offen offset:2048 sc1 lds
    v_exp_f32 v25, v25
    v_exp_f32_e64 v26, v26
    s_waitcnt lgkmcnt(0)
    v_mfma_f32_32x32x16_bf16 v[8:23], v[132:135], v[112:115], v[72:87]
    v_exp_f32 v27, v27
    v_exp_f32 v28, v28
    v_exp_f32_e64 v29, v29
    v_mfma_f32_32x32x16_bf16 v[40:55], v[144:147], v[152:155], v[40:55]
    v_exp_f32 v30, v30
    v_exp_f32 v31, v31
    v_cvt_pk_bf16_f32 v148, v24, v25
    v_cvt_pk_bf16_f32 v149, v26, v27
    v_mfma_f32_16x16x32_bf16 v[104:107], v[128:131], v[152:155], v[104:107]
    v_cvt_pk_bf16_f32 v150, v28, v29
    v_cvt_pk_bf16_f32 v151, v30, v31
    v_exp_f32_e64 v32, v32
    buffer_load_dwordx4 v156, s[36:39], s56 offen offset:3072 sc1 lds
    v_exp_f32_e64 v33, v33
    s_add_u32 s56, s56, 8192
    s_cmp_eq_u32 s56, s51
    s_cselect_b32 s58, 16384, 0
    s_add_u32 s56, s56, s58
    v_exp_f32_e64 v34, v34
    v_mfma_f32_32x32x16_bf16 v[8:23], v[136:139], v[116:119], v[8:23]
    v_exp_f32 v35, v35
    v_exp_f32 v36, v36
    v_exp_f32_e64 v37, v37
    v_mfma_f32_32x32x16_bf16 v[56:71], v[140:143], v[148:151], v[56:71]
    ds_read_b128 v[140:143], v157 offset:2048
    v_exp_f32 v38, v38
    v_exp_f32 v39, v39
    s_sub_u32 s59, s59, 1
    s_cmp_lg_u32 s59, 0
    v_cvt_pk_bf16_f32 v152, v32, v33
    v_cvt_pk_bf16_f32 v153, v34, v35
    v_mfma_f32_16x16x32_bf16 v[108:111], v[128:131], v[148:151], v[108:111]
    v_cvt_pk_bf16_f32 v154, v36, v37
    v_cvt_pk_bf16_f32 v155, v38, v39
    s_cbranch_scc1 L_attn_loop
    s_cmp_lg_u32 s3, 0
    s_cbranch_scc1 L_mp0_ct21
    s_mov_b64 s[60:61], s[64:65]
    s_getpc_b64 s[64:65]
L_mp0_pc22:
    s_add_u32 s64, s64, L_attn_epi-L_mp0_pc22
    s_addc_u32 s65, s65, 0
    v_and_b32_e64 v172, 63, v0
    v_lshl_add_u32 v172, v172, 7, 0
    v_min_u32 v172, L_text_end-L_attn_epi-4, v172
    v_mov_b32 v173, s65
    v_add_co_u32 v172, vcc, s64, v172
    s_nop 1
    v_addc_co_u32 v173, vcc, 0, v173, vcc
    global_load_dword v174, v[172:173], off
    s_mov_b64 s[64:65], s[60:61]
L_mp0_ct21:
    v_exp_f32 v8, v8
    v_exp_f32 v9, v9
    v_exp_f32 v10, v10
    v_mfma_f32_32x32x16_bf16 v[24:39], v[132:135], v[120:123], v[88:103]
    ds_read_b128 v[132:135], v157 offset:4096
    v_exp_f32 v11, v11
    v_exp_f32 v12, v12
    v_exp_f32_e64 v13, v13
    v_mfma_f32_32x32x16_bf16 v[56:71], v[144:147], v[152:155], v[56:71]
    ds_read_b128 v[144:147], v157 offset:3072
    v_exp_f32 v14, v14
    v_exp_f32 v15, v15
    v_cvt_pk_bf16_f32 v148, v8, v9
    v_cvt_pk_bf16_f32 v149, v10, v11
    v_mfma_f32_16x16x32_bf16 v[108:111], v[128:131], v[152:155], v[108:111]
    v_cvt_pk_bf16_f32 v150, v12, v13
    v_cvt_pk_bf16_f32 v151, v14, v15
    v_exp_f32 v16, v16
    v_exp_f32 v17, v17
    v_exp_f32_e64 v18, v18
    v_mfma_f32_32x32x16_bf16 v[24:39], v[136:139], v[124:127], v[24:39]
    ds_read_b128 v[136:139], v157 offset:5120
    v_exp_f32 v19, v19
    v_exp_f32 v20, v20
    v_exp_f32 v21, v21
    s_waitcnt lgkmcnt(3)
    v_mfma_f32_32x32x16_bf16 v[40:55], v[140:143], v[148:151], v[40:55]
    v_exp_f32 v22, v22
    v_exp_f32 v23, v23
    v_cvt_pk_bf16_f32 v152, v16, v17
    v_cvt_pk_bf16_f32 v153, v18, v19
    v_mfma_f32_16x16x32_bf16 v[104:107], v[128:131], v[148:151], v[104:107]
    v_cvt_pk_bf16_f32 v154, v20, v21
    v_cvt_pk_bf16_f32 v155, v22, v23
    v_exp_f32 v24, v24
    v_exp_f32 v25, v25
    v_exp_f32 v26, v26
    s_waitcnt lgkmcnt(0)
    v_mfma_f32_32x32x16_bf16 v[8:23], v[132:135], v[112:115], v[72:87]
    v_exp_f32 v27, v27
    v_exp_f32 v28, v28
    v_exp_f32_e64 v29, v29
    v_mfma_f32_32x32x16_bf16 v[40:55], v[144:147], v[152:155], v[40:55]
    v_exp_f32 v30, v30
    v_exp_f32 v31, v31
    v_cvt_pk_bf16_f32 v148, v24, v25
    v_cvt_pk_bf16_f32 v149, v26, v27
    v_mfma_f32_16x16x32_bf16 v[104:107], v[128:131], v[152:155], v[104:107]
    v_cvt_pk_bf16_f32 v150, v28, v29
    v_cvt_pk_bf16_f32 v151, v30, v31
    v_exp_f32 v32, v32
    v_exp_f32 v33, v33
    v_exp_f32_e64 v34, v34
    v_mfma_f32_32x32x16_bf16 v[8:23], v[136:139], v[116:119], v[8:23]
    v_exp_f32 v35, v35
    v_exp_f32 v36, v36
    v_exp_f32_e64 v37, v37
    v_mfma_f32_32x32x16_bf16 v[56:71], v[140:143], v[148:151], v[56:71]
    ds_read_b128 v[140:143], v157 offset:6144
    v_exp_f32 v38, v38
    v_exp_f32 v39, v39
    v_cvt_pk_bf16_f32 v152, v32, v33
    v_cvt_pk_bf16_f32 v153, v34, v35
    v_mfma_f32_16x16x32_bf16 v[108:111], v[128:131], v[148:151], v[108:111]
    v_cvt_pk_bf16_f32 v154, v36, v37
    v_cvt_pk_bf16_f32 v155, v38, v39
    s_waitcnt vmcnt(5)
    s_barrier
    v_exp_f32_e64 v8, v8
    s_add_u32 m0, s57, 24576
    v_exp_f32_e64 v9, v9
    buffer_load_dwordx4 v156, s[36:39], s56 offen offset:0 sc1 lds
    v_exp_f32_e64 v10, v10
    v_mfma_f32_32x32x16_bf16 v[24:39], v[132:135], v[120:123], v[88:103]
    ds_read_b128 v[132:135], v157 offset:8192
    v_exp_f32 v11, v11
    v_exp_f32 v12, v12
    v_exp_f32_e64 v13, v13
    v_mfma_f32_32x32x16_bf16 v[56:71], v[144:147], v[152:155], v[56:71]
    ds_read_b128 v[144:147], v157 offset:7168
    v_exp_f32 v14, v14
    v_exp_f32 v15, v15
    v_cvt_pk_bf16_f32 v148, v8, v9
    v_cvt_pk_bf16_f32 v149, v10, v11
    v_mfma_f32_16x16x32_bf16 v[108:111], v[128:131], v[152:155], v[108:111]
    v_cvt_pk_bf16_f32 v150, v12, v13
    v_cvt_pk_bf16_f32 v151, v14, v15
    v_exp_f32 v16, v16
    v_exp_f32 v17, v17
    buffer_load_dwordx4 v156, s[36:39], s56 offen offset:1024 sc1 lds
    v_exp_f32_e64 v18, v18
    v_mfma_f32_32x32x16_bf16 v[24:39], v[136:139], v[124:127], v[24:39]
    ds_read_b128 v[136:139], v157 offset:9216
    v_exp_f32 v19, v19
    v_exp_f32 v20, v20
    v_exp_f32 v21, v21
    s_waitcnt lgkmcnt(3)
    v_mfma_f32_32x32x16_bf16 v[40:55], v[140:143], v[148:151], v[40:55]
    v_exp_f32 v22, v22
    v_exp_f32 v23, v23
    v_cvt_pk_bf16_f32 v152, v16, v17
    v_cvt_pk_bf16_f32 v153, v18, v19
    v_mfma_f32_16x16x32_bf16 v[104:107], v[128:131], v[148:151], v[104:107]
    v_cvt_pk_bf16_f32 v154, v20, v21
    v_cvt_pk_bf16_f32 v155, v22, v23
    v_exp_f32_e64 v24, v24
    buffer_load_dwordx4 v156, s[36:39], s56 offen offset:2048 sc1 lds
    v_exp_f32 v25, v25
    v_exp_f32_e64 v26, v26
    s_waitcnt lgkmcnt(0)
    v_mfma_f32_32x32x16_bf16 v[8:23], v[132:135], v[112:115], v[72:87]
    v_exp_f32 v27, v27
    v_exp_f32 v28, v28
    v_exp_f32_e64 v29, v29
    v_mfma_f32_32x32x16_bf16 v[40:55], v[144:147], v[152:155], v[40:55]
    v_exp_f32 v30, v30
    v_exp_f32 v31, v31
    v_cvt_pk_bf16_f32 v148, v24, v25
    v_cvt_pk_bf16_f32 v149, v26, v27
    v_mfma_f32_16x16x32_bf16 v[104:107], v[128:131], v[152:155], v[104:107]
    v_cvt_pk_bf16_f32 v150, v28, v29
    v_cvt_pk_bf16_f32 v151, v30, v31
    v_exp_f32_e64 v32, v32
    buffer_load_dwordx4 v156, s[36:39], s56 offen offset:3072 sc1 lds
    v_exp_f32_e64 v33, v33
    s_add_u32 s56, s56, 8192
    s_cmp_eq_u32 s56, s51
    s_cselect_b32 s58, 16384, 0
    s_add_u32 s56, s56, s58
    v_exp_f32_e64 v34, v34
    v_mfma_f32_32x32x16_bf16 v[8:23], v[136:139], v[116:119], v[8:23]
    v_exp_f32 v35, v35
    v_exp_f32 v36, v36
    v_exp_f32_e64 v37, v37
    v_mfma_f32_32x32x16_bf16 v[56:71], v[140:143], v[148:151], v[56:71]
    ds_read_b128 v[140:143], v157 offset:10240
    v_exp_f32 v38, v38
    v_exp_f32 v39, v39
    v_cvt_pk_bf16_f32 v152, v32, v33
    v_cvt_pk_bf16_f32 v153, v34, v35
    v_mfma_f32_16x16x32_bf16 v[108:111], v[128:131], v[148:151], v[108:111]
    v_cvt_pk_bf16_f32 v154, v36, v37
    v_cvt_pk_bf16_f32 v155, v38, v39
    v_exp_f32_e64 v8, v8
    buffer_load_dwordx4 v[168:171], v161, s[64:67], s62 offen
    v_exp_f32 v9, v9
    v_exp_f32 v10, v10
    v_mfma_f32_32x32x16_bf16 v[24:39], v[132:135], v[120:123], v[88:103]
    ds_read_b128 v[132:135], v157 offset:12288
    v_exp_f32 v11, v11
    v_exp_f32 v12, v12
    v_exp_f32_e64 v13, v13
    v_mfma_f32_32x32x16_bf16 v[56:71], v[144:147], v[152:155], v[56:71]
    ds_read_b128 v[144:147], v157 offset:11264
    v_exp_f32 v14, v14
    v_exp_f32 v15, v15
    v_cvt_pk_bf16_f32 v148, v8, v9
    v_cvt_pk_bf16_f32 v149, v10, v11
    v_mfma_f32_16x16x32_bf16 v[108:111], v[128:131], v[152:155], v[108:111]
    v_cvt_pk_bf16_f32 v150, v12, v13
    v_cvt_pk_bf16_f32 v151, v14, v15
    v_exp_f32 v16, v16
    v_exp_f32 v17, v17
    v_exp_f32_e64 v18, v18
    v_mfma_f32_32x32x16_bf16 v[24:39], v[136:139], v[124:127], v[24:39]
    ds_read_b128 v[136:139], v157 offset:13312
    v_exp_f32 v19, v19
    v_exp_f32 v20, v20
    v_exp_f32 v21, v21
    s_waitcnt lgkmcnt(3)
    v_mfma_f32_32x32x16_bf16 v[40:55], v[140:143], v[148:151], v[40:55]
    v_exp_f32 v22, v22
    v_exp_f32 v23, v23
    v_cvt_pk_bf16_f32 v152, v16, v17
    v_cvt_pk_bf16_f32 v153, v18, v19
    v_mfma_f32_16x16x32_bf16 v[104:107], v[128:131], v[148:151], v[104:107]
    v_cvt_pk_bf16_f32 v154, v20, v21
    v_cvt_pk_bf16_f32 v155, v22, v23
    v_exp_f32 v24, v24
    v_exp_f32 v25, v25
    v_exp_f32 v26, v26
    s_waitcnt lgkmcnt(0)
    v_mfma_f32_32x32x16_bf16 v[8:23], v[132:135], v[112:115], v[72:87]
    v_exp_f32 v27, v27
    v_exp_f32 v28, v28
    v_exp_f32_e64 v29, v29
    v_mfma_f32_32x32x16_bf16 v[40:55], v[144:147], v[152:155], v[40:55]
    v_exp_f32 v30, v30
    v_exp_f32 v31, v31
    v_cvt_pk_bf16_f32 v148, v24, v25
    v_cvt_pk_bf16_f32 v149, v26, v27
    v_mfma_f32_16x16x32_bf16 v[104:107], v[128:131], v[152:155], v[104:107]
    v_cvt_pk_bf16_f32 v150, v28, v29
    v_cvt_pk_bf16_f32 v151, v30, v31
    v_exp_f32 v32, v32
    v_exp_f32 v33, v33
    v_exp_f32_e64 v34, v34
    v_mfma_f32_32x32x16_bf16 v[8:23], v[136:139], v[116:119], v[8:23]
    v_exp_f32 v35, v35
    v_exp_f32 v36, v36
    v_exp_f32_e64 v37, v37
    v_mfma_f32_32x32x16_bf16 v[56:71], v[140:143], v[148:151], v[56:71]
    ds_read_b128 v[140:143], v157 offset:14336
    v_exp_f32 v38, v38
    v_exp_f32 v39, v39
    v_cvt_pk_bf16_f32 v152, v32, v33
    v_cvt_pk_bf16_f32 v153, v34, v35
    v_mfma_f32_16x16x32_bf16 v[108:111], v[128:131], v[148:151], v[108:111]
    v_cvt_pk_bf16_f32 v154, v36, v37
    v_cvt_pk_bf16_f32 v155, v38, v39
    s_waitcnt vmcnt(5)
    s_barrier
    v_exp_f32 v8, v8
    v_exp_f32 v9, v9
    v_exp_f32_e64 v10, v10
    v_mfma_f32_32x32x16_bf16 v[24:39], v[132:135], v[120:123], v[88:103]
    ds_read_b128 v[132:135], v157 offset:16384
    v_exp_f32 v11, v11
    v_exp_f32 v12, v12
    v_exp_f32_e64 v13, v13
    v_mfma_f32_32x32x16_bf16 v[56:71], v[144:147], v[152:155], v[56:71]
    ds_read_b128 v[144:147], v157 offset:15360
    v_exp_f32 v14, v14
    v_exp_f32 v15, v15
    v_cvt_pk_bf16_f32 v148, v8, v9
    v_cvt_pk_bf16_f32 v149, v10, v11
    v_mfma_f32_16x16x32_bf16 v[108:111], v[128:131], v[152:155], v[108:111]
    v_cvt_pk_bf16_f32 v150, v12, v13
    v_cvt_pk_bf16_f32 v151, v14, v15
    v_exp_f32 v16, v16
    v_exp_f32 v17, v17
    v_exp_f32_e64 v18, v18
    v_mfma_f32_32x32x16_bf16 v[24:39], v[136:139], v[124:127], v[24:39]
    ds_read_b128 v[136:139], v157 offset:17408
    v_exp_f32 v19, v19
    v_exp_f32 v20, v20
    v_exp_f32 v21, v21
    s_waitcnt lgkmcnt(3)
    v_mfma_f32_32x32x16_bf16 v[40:55], v[140:143], v[148:151], v[40:55]
    v_exp_f32 v22, v22
    v_exp_f32 v23, v23
    v_cvt_pk_bf16_f32 v152, v16, v17
    v_cvt_pk_bf16_f32 v153, v18, v19
    v_mfma_f32_16x16x32_bf16 v[104:107], v[128:131], v[148:151], v[104:107]
    v_cvt_pk_bf16_f32 v154, v20, v21
    v_cvt_pk_bf16_f32 v155, v22, v23
    v_exp_f32 v24, v24
    v_exp_f32 v25, v25
    v_exp_f32 v26, v26
    s_waitcnt lgkmcnt(0)
    v_mfma_f32_32x32x16_bf16 v[8:23], v[132:135], v[112:115], v[72:87]
    v_exp_f32 v27, v27
    v_exp_f32 v28, v28
    v_exp_f32_e64 v29, v29
    v_mfma_f32_32x32x16_bf16 v[40:55], v[144:147], v[152:155], v[40:55]
    v_exp_f32 v30, v30
    v_exp_f32 v31, v31
    v_cvt_pk_bf16_f32 v148, v24, v25
    v_cvt_pk_bf16_f32 v149, v26, v27
    v_mfma_f32_16x16x32_bf16 v[104:107], v[128:131], v[152:155], v[104:107]
    v_cvt_pk_bf16_f32 v150, v28, v29
    v_cvt_pk_bf16_f32 v151, v30, v31
    v_exp_f32 v32, v32
    v_exp_f32 v33, v33
    v_exp_f32_e64 v34, v34
    v_mfma_f32_32x32x16_bf16 v[8:23], v[136:139], v[116:119], v[8:23]
    v_exp_f32 v35, v35
    v_exp_f32 v36, v36
    v_exp_f32_e64 v37, v37
    v_mfma_f32_32x32x16_bf16 v[56:71], v[140:143], v[148:151], v[56:71]
    ds_read_b128 v[140:143], v157 offset:18432
    v_exp_f32 v38, v38
    v_exp_f32 v39, v39
    v_cvt_pk_bf16_f32 v152, v32, v33
    v_cvt_pk_bf16_f32 v153, v34, v35
    v_mfma_f32_16x16x32_bf16 v[108:111], v[128:131], v[148:151], v[108:111]
    v_cvt_pk_bf16_f32 v154, v36, v37
    v_cvt_pk_bf16_f32 v155, v38, v39
    v_exp_f32 v8, v8
    v_exp_f32 v9, v9
    v_exp_f32_e64 v10, v10
    v_mfma_f32_32x32x16_bf16 v[24:39], v[132:135], v[120:123], v[88:103]
    ds_read_b128 v[132:135], v157 offset:20480
    v_exp_f32 v11, v11
    v_exp_f32 v12, v12
    v_exp_f32_e64 v13, v13
    v_mfma_f32_32x32x16_bf16 v[56:71], v[144:147], v[152:155], v[56:71]
    ds_read_b128 v[144:147], v157 offset:19456
    v_exp_f32 v14, v14
    v_exp_f32 v15, v15
    v_cvt_pk_bf16_f32 v148, v8, v9
    v_cvt_pk_bf16_f32 v149, v10, v11
    v_mfma_f32_16x16x32_bf16 v[108:111], v[128:131], v[152:155], v[108:111]
    v_cvt_pk_bf16_f32 v150, v12, v13
    v_cvt_pk_bf16_f32 v151, v14, v15
    v_exp_f32 v16, v16
    v_exp_f32 v17, v17
    v_exp_f32_e64 v18, v18
    v_mfma_f32_32x32x16_bf16 v[24:39], v[136:139], v[124:127], v[24:39]
    ds_read_b128 v[136:139], v157 offset:21504
    v_exp_f32 v19, v19
    v_exp_f32 v20, v20
    v_exp_f32 v21, v21
    s_waitcnt lgkmcnt(3)
    v_mfma_f32_32x32x16_bf16 v[40:55], v[140:143], v[148:151], v[40:55]
    v_exp_f32 v22, v22
    v_exp_f32 v23, v23
    v_cvt_pk_bf16_f32 v152, v16, v17
    v_cvt_pk_bf16_f32 v153, v18, v19
    v_mfma_f32_16x16x32_bf16 v[104:107], v[128:131], v[148:151], v[104:107]
    v_cvt_pk_bf16_f32 v154, v20, v21
    v_cvt_pk_bf16_f32 v155, v22, v23
    v_exp_f32 v24, v24
    v_exp_f32 v25, v25
    v_exp_f32 v26, v26
    s_waitcnt lgkmcnt(0)
    v_mfma_f32_32x32x16_bf16 v[8:23], v[132:135], v[112:115], v[72:87]
    v_exp_f32 v27, v27
    v_exp_f32 v28, v28
    v_exp_f32_e64 v29, v29
    v_mfma_f32_32x32x16_bf16 v[40:55], v[144:147], v[152:155], v[40:55]
    v_exp_f32 v30, v30
    v_exp_f32 v31, v31
    v_cvt_pk_bf16_f32 v148, v24, v25
    v_cvt_pk_bf16_f32 v149, v26, v27
    v_mfma_f32_16x16x32_bf16 v[104:107], v[128:131], v[152:155], v[104:107]
    v_cvt_pk_bf16_f32 v150, v28, v29
    v_cvt_pk_bf16_f32 v151, v30, v31
    v_exp_f32 v32, v32
    v_exp_f32 v33, v33
    v_exp_f32_e64 v34, v34
    v_mfma_f32_32x32x16_bf16 v[8:23], v[136:139], v[116:119], v[8:23]
    v_exp_f32 v35, v35
    v_exp_f32 v36, v36
    v_exp_f32_e64 v37, v37
    v_mfma_f32_32x32x16_bf16 v[56:71], v[140:143], v[148:151], v[56:71]
    ds_read_b128 v[140:143], v157 offset:22528
    v_exp_f32 v38, v38
    v_exp_f32 v39, v39
    v_cvt_pk_bf16_f32 v152, v32, v33
    v_cvt_pk_bf16_f32 v153, v34, v35
    v_mfma_f32_16x16x32_bf16 v[108:111], v[128:131], v[148:151], v[108:111]
    v_cvt_pk_bf16_f32 v154, v36, v37
    v_cvt_pk_bf16_f32 v155, v38, v39
    s_waitcnt vmcnt(1)
    s_barrier
    v_exp_f32 v8, v8
    v_exp_f32 v9, v9
    v_exp_f32_e64 v10, v10
    v_mfma_f32_32x32x16_bf16 v[24:39], v[132:135], v[120:123], v[88:103]
    ds_read_b128 v[132:135], v157 offset:24576
    v_exp_f32 v11, v11
    v_exp_f32 v12, v12
    v_exp_f32_e64 v13, v13
    v_mfma_f32_32x32x16_bf16 v[56:71], v[144:147], v[152:155], v[56:71]
    ds_read_b128 v[144:147], v157 offset:23552
    v_exp_f32 v14, v14
    v_exp_f32 v15, v15
    v_cvt_pk_bf16_f32 v148, v8, v9
    v_cvt_pk_bf16_f32 v149, v10, v11
    v_mfma_f32_16x16x32_bf16 v[108:111], v[128:131], v[152:155], v[108:111]
    v_cvt_pk_bf16_f32 v150, v12, v13
    v_cvt_pk_bf16_f32 v151, v14, v15
    v_exp_f32 v16, v16
    v_exp_f32 v17, v17
    v_exp_f32_e64 v18, v18
    v_mfma_f32_32x32x16_bf16 v[24:39], v[136:139], v[124:127], v[24:39]
    ds_read_b128 v[136:139], v157 offset:25600
    v_exp_f32 v19, v19
    v_exp_f32 v20, v20
    v_exp_f32 v21, v21
    s_waitcnt lgkmcnt(3)
    v_mfma_f32_32x32x16_bf16 v[40:55], v[140:143], v[148:151], v[40:55]
    v_exp_f32 v22, v22
    v_exp_f32 v23, v23
    v_cvt_pk_bf16_f32 v152, v16, v17
    v_cvt_pk_bf16_f32 v153, v18, v19
    v_mfma_f32_16x16x32_bf16 v[104:107], v[128:131], v[148:151], v[104:107]
    v_cvt_pk_bf16_f32 v154, v20, v21
    v_cvt_pk_bf16_f32 v155, v22, v23
    v_exp_f32 v24, v24
    v_exp_f32 v25, v25
    v_exp_f32 v26, v26
    s_waitcnt lgkmcnt(0)
    v_mfma_f32_32x32x16_bf16 v[8:23], v[132:135], v[112:115], v[72:87]
    v_exp_f32 v27, v27
    v_exp_f32 v28, v28
    v_exp_f32_e64 v29, v29
    v_mfma_f32_32x32x16_bf16 v[40:55], v[144:147], v[152:155], v[40:55]
    v_exp_f32 v30, v30
    v_exp_f32 v31, v31
    v_cvt_pk_bf16_f32 v148, v24, v25
    v_cvt_pk_bf16_f32 v149, v26, v27
    v_mfma_f32_16x16x32_bf16 v[104:107], v[128:131], v[152:155], v[104:107]
    v_cvt_pk_bf16_f32 v150, v28, v29
    v_cvt_pk_bf16_f32 v151, v30, v31
    v_exp_f32 v32, v32
    v_exp_f32 v33, v33
    v_exp_f32_e64 v34, v34
    v_mfma_f32_32x32x16_bf16 v[8:23], v[136:139], v[116:119], v[8:23]
    v_exp_f32 v35, v35
    v_exp_f32 v36, v36
    v_exp_f32_e64 v37, v37
    v_mfma_f32_32x32x16_bf16 v[56:71], v[140:143], v[148:151], v[56:71]
    ds_read_b128 v[140:143], v157 offset:26624
    v_exp_f32 v38, v38
    v_exp_f32 v39, v39
    v_cvt_pk_bf16_f32 v152, v32, v33
    v_cvt_pk_bf16_f32 v153, v34, v35
    v_mfma_f32_16x16x32_bf16 v[108:111], v[128:131], v[148:151], v[108:111]
    v_cvt_pk_bf16_f32 v154, v36, v37
    v_cvt_pk_bf16_f32 v155, v38, v39
    v_exp_f32_e64 v8, v8
    buffer_load_dwordx4 v[168:171], v161, s[68:71], s62 offen
    v_exp_f32_e64 v9, v9
    s_add_u32 s62, s62, 2097152
    v_exp_f32_e64 v10, v10
    v_mfma_f32_32x32x16_bf16 v[24:39], v[132:135], v[120:123], v[88:103]
    ds_read_b128 v[132:135], v157 offset:28672
    v_exp_f32 v11, v11
    v_exp_f32 v12, v12
    v_exp_f32_e64 v13, v13
    v_mfma_f32_32x32x16_bf16 v[56:71], v[144:147], v[152:155], v[56:71]
    ds_read_b128 v[144:147], v157 offset:27648
    v_exp_f32 v14, v14
    v_exp_f32 v15, v15
    v_cvt_pk_bf16_f32 v148, v8, v9
    v_cvt_pk_bf16_f32 v149, v10, v11
    v_mfma_f32_16x16x32_bf16 v[108:111], v[128:131], v[152:155], v[108:111]
    v_cvt_pk_bf16_f32 v150, v12, v13
    v_cvt_pk_bf16_f32 v151, v14, v15
    v_exp_f32 v16, v16
    v_exp_f32 v17, v17
    v_exp_f32_e64 v18, v18
    v_mfma_f32_32x32x16_bf16 v[24:39], v[136:139], v[124:127], v[24:39]
    ds_read_b128 v[136:139], v157 offset:29696
    v_exp_f32 v19, v19
    v_exp_f32 v20, v20
    v_exp_f32 v21, v21
    s_waitcnt lgkmcnt(3)
    v_mfma_f32_32x32x16_bf16 v[40:55], v[140:143], v[148:151], v[40:55]
    v_exp_f32 v22, v22
    v_exp_f32 v23, v23
    v_cvt_pk_bf16_f32 v152, v16, v17
    v_cvt_pk_bf16_f32 v153, v18, v19
    v_mfma_f32_16x16x32_bf16 v[104:107], v[128:131], v[148:151], v[104:107]
    v_cvt_pk_bf16_f32 v154, v20, v21
    v_cvt_pk_bf16_f32 v155, v22, v23
    v_exp_f32 v24, v24
    v_exp_f32 v25, v25
    v_exp_f32 v26, v26
    s_waitcnt lgkmcnt(0)
    v_mfma_f32_32x32x16_bf16 v[8:23], v[132:135], v[112:115], v[72:87]
    v_exp_f32 v27, v27
    v_exp_f32 v28, v28
    v_exp_f32_e64 v29, v29
    v_mfma_f32_32x32x16_bf16 v[40:55], v[144:147], v[152:155], v[40:55]
    v_exp_f32 v30, v30
    v_exp_f32 v31, v31
    v_cvt_pk_bf16_f32 v148, v24, v25
    v_cvt_pk_bf16_f32 v149, v26, v27
    v_mfma_f32_16x16x32_bf16 v[104:107], v[128:131], v[152:155], v[104:107]
    v_cvt_pk_bf16_f32 v150, v28, v29
    v_cvt_pk_bf16_f32 v151, v30, v31
    v_exp_f32 v32, v32
    v_exp_f32 v33, v33
    v_exp_f32_e64 v34, v34
    v_mfma_f32_32x32x16_bf16 v[8:23], v[136:139], v[116:119], v[8:23]
    v_exp_f32 v35, v35
    v_exp_f32 v36, v36
    v_exp_f32_e64 v37, v37
    v_mfma_f32_32x32x16_bf16 v[56:71], v[140:143], v[148:151], v[56:71]
    ds_read_b128 v[140:143], v157 offset:30720
    v_exp_f32 v38, v38
    v_exp_f32 v39, v39
    v_cvt_pk_bf16_f32 v152, v32, v33
    v_cvt_pk_bf16_f32 v153, v34, v35
    v_mfma_f32_16x16x32_bf16 v[108:111], v[128:131], v[148:151], v[108:111]
    v_cvt_pk_bf16_f32 v154, v36, v37
    v_cvt_pk_bf16_f32 v155, v38, v39
    s_barrier
    v_exp_f32 v8, v8
    v_exp_f32 v9, v9
    v_exp_f32 v10, v10
    v_mfma_f32_32x32x16_bf16 v[24:39], v[132:135], v[120:123], v[88:103]
    ds_read_b128 v[132:135], v157 offset:0
    v_exp_f32 v11, v11
    v_exp_f32 v12, v12
    v_exp_f32_e64 v13, v13
    v_mfma_f32_32x32x16_bf16 v[56:71], v[144:147], v[152:155], v[56:71]
    ds_read_b128 v[144:147], v157 offset:31744
    v_exp_f32 v14, v14
    v_exp_f32 v15, v15
    v_cvt_pk_bf16_f32 v148, v8, v9
    v_cvt_pk_bf16_f32 v149, v10, v11
    v_mfma_f32_16x16x32_bf16 v[108:111], v[128:131], v[152:155], v[108:111]
    v_cvt_pk_bf16_f32 v150, v12, v13
    v_cvt_pk_bf16_f32 v151, v14, v15
    v_exp_f32 v16, v16
    v_exp_f32 v17, v17
    v_exp_f32_e64 v18, v18
    v_mfma_f32_32x32x16_bf16 v[24:39], v[136:139], v[124:127], v[24:39]
    ds_read_b128 v[136:139], v157 offset:1024
    v_exp_f32 v19, v19
    v_exp_f32 v20, v20
    v_exp_f32 v21, v21
    s_waitcnt lgkmcnt(3)
    v_mfma_f32_32x32x16_bf16 v[40:55], v[140:143], v[148:151], v[40:55]
    v_exp_f32 v22, v22
    v_exp_f32 v23, v23
    v_cvt_pk_bf16_f32 v152, v16, v17
    v_cvt_pk_bf16_f32 v153, v18, v19
    v_mfma_f32_16x16x32_bf16 v[104:107], v[128:131], v[148:151], v[104:107]
    v_cvt_pk_bf16_f32 v154, v20, v21
    v_cvt_pk_bf16_f32 v155, v22, v23
    v_exp_f32 v24, v24
    v_exp_f32 v25, v25
    v_exp_f32 v26, v26
    s_waitcnt lgkmcnt(0)
    v_mfma_f32_32x32x16_bf16 v[8:23], v[132:135], v[112:115], v[72:87]
    v_exp_f32 v27, v27
    v_exp_f32 v28, v28
    v_exp_f32_e64 v29, v29
    v_mfma_f32_32x32x16_bf16 v[40:55], v[144:147], v[152:155], v[40:55]
    v_exp_f32 v30, v30
    v_exp_f32 v31, v31
    v_cvt_pk_bf16_f32 v148, v24, v25
    v_cvt_pk_bf16_f32 v149, v26, v27
    v_mfma_f32_16x16x32_bf16 v[104:107], v[128:131], v[152:155], v[104:107]
    v_cvt_pk_bf16_f32 v150, v28, v29
    v_cvt_pk_bf16_f32 v151, v30, v31
    v_exp_f32 v32, v32
    v_exp_f32 v33, v33
    v_exp_f32_e64 v34, v34
    v_mfma_f32_32x32x16_bf16 v[8:23], v[136:139], v[116:119], v[8:23]
    v_exp_f32 v35, v35
    v_exp_f32 v36, v36
    v_exp_f32_e64 v37, v37
    v_mfma_f32_32x32x16_bf16 v[56:71], v[140:143], v[148:151], v[56:71]
    ds_read_b128 v[140:143], v157 offset:2048
    v_exp_f32 v38, v38
    v_exp_f32 v39, v39
    v_cvt_pk_bf16_f32 v152, v32, v33
    v_cvt_pk_bf16_f32 v153, v34, v35
    v_mfma_f32_16x16x32_bf16 v[108:111], v[128:131], v[148:151], v[108:111]
    v_cvt_pk_bf16_f32 v154, v36, v37
    v_cvt_pk_bf16_f32 v155, v38, v39
    s_nop 0
L_attn_epi:
    s_nop 0
    v_mfma_f32_32x32x16_bf16 v[56:71], v[144:147], v[152:155], v[56:71]
    v_mfma_f32_16x16x32_bf16 v[108:111], v[128:131], v[152:155], v[108:111]
    s_lshl_b32 s58, s48, 13
    s_add_u32 s58, s58, s55
    s_add_u32 s58, s58, 8192
    v_add_u32_e64 v2, s58, v156
    v_lshl_add_u32 v4, v1, 2, s58
    s_xor_b32 s58, s58, 0x10000
    v_add_u32_e64 v3, s58, v156
    v_lshl_add_u32 v5, v1, 2, s58
    s_nop 3
    ds_write_b128 v2, v[56:59] offset:0
    ds_write_b128 v2, v[60:63] offset:1024
    ds_write_b128 v2, v[64:67] offset:2048
    ds_write_b128 v2, v[68:71] offset:3072
    ds_write_b32 v4, v108 offset:4096
    s_add_u32 s40, s28, 0x1100000
    s_addc_u32 s41, s29, 0
    s_and_b32 s41, s41, 0xffff
    s_mov_b32 s42, 0x400000
    s_mov_b32 s43, 0x20000
    s_waitcnt lgkmcnt(0)
    s_barrier
    ds_read_b128 v[8:11], v3 offset:0
    ds_read_b128 v[12:15], v3 offset:1024
    ds_read_b128 v[16:19], v3 offset:2048
    ds_read_b128 v[20:23], v3 offset:3072
    ds_read_b32 v159, v5 offset:4096
    s_waitcnt lgkmcnt(0)
    s_nop 0
    v_pk_add_f32 v[40:41], v[40:41], v[8:9]
    v_pk_add_f32 v[42:43], v[42:43], v[10:11]
    v_pk_add_f32 v[44:45], v[44:45], v[12:13]
    v_pk_add_f32 v[46:47], v[46:47], v[14:15]
    v_pk_add_f32 v[48:49], v[48:49], v[16:17]
    v_pk_add_f32 v[50:51], v[50:51], v[18:19]
    v_pk_add_f32 v[52:53], v[52:53], v[20:21]
    v_pk_add_f32 v[54:55], v[54:55], v[22:23]
    v_add_f32_e64 v104, v104, v159
    v_max3_f32 v159, |v40|, |v41|, |v104|
    v_max3_f32 v159, |v42|, |v43|, v159
    v_max3_f32 v159, |v44|, |v45|, v159
    v_max3_f32 v159, |v46|, |v47|, v159
    v_max3_f32 v159, |v48|, |v49|, v159
    v_max3_f32 v159, |v50|, |v51|, v159
    v_max3_f32 v159, |v52|, |v53|, v159
    v_max3_f32 v159, |v54|, |v55|, v159
    v_mul_f32_e64 v160, 0, v104
    v_fma_f32 v160, 0, v40, v160
    v_fma_f32 v160, 0, v41, v160
    v_fma_f32 v160, 0, v42, v160
    v_fma_f32 v160, 0, v43, v160
    v_fma_f32 v160, 0, v44, v160
    v_fma_f32 v160, 0, v45, v160
    v_fma_f32 v160, 0, v46, v160
    v_fma_f32 v160, 0, v47, v160
    v_fma_f32 v160, 0, v48, v160
    v_fma_f32 v160, 0, v49, v160
    v_fma_f32 v160, 0, v50, v160
    v_fma_f32 v160, 0, v51, v160
    v_fma_f32 v160, 0, v52, v160
    v_fma_f32 v160, 0, v53, v160
    v_fma_f32 v160, 0, v54, v160
    v_fma_f32 v160, 0, v55, v160
    v_add_f32_e64 v159, v159, v160
    v_mov_b32 v3, 0x7b800000
    v_cmp_nlt_f32 vcc, v159, v3
    s_nop 4
    s_cbranch_vccnz L_attn_safe
L_attn_store:
    v_rcp_f32_e64 v160, v104
    s_nop 0
    v_pk_mul_f32 v[40:41], v[40:41], v[160:161] op_sel_hi:[1,0]
    v_pk_mul_f32 v[42:43], v[42:43], v[160:161] op_sel_hi:[1,0]
    v_pk_mul_f32 v[44:45], v[44:45], v[160:161] op_sel_hi:[1,0]
    v_pk_mul_f32 v[46:47], v[46:47], v[160:161] op_sel_hi:[1,0]
    v_pk_mul_f32 v[48:49], v[48:49], v[160:161] op_sel_hi:[1,0]
    v_pk_mul_f32 v[50:51], v[50:51], v[160:161] op_sel_hi:[1,0]
    v_pk_mul_f32 v[52:53], v[52:53], v[160:161] op_sel_hi:[1,0]
    v_pk_mul_f32 v[54:55], v[54:55], v[160:161] op_sel_hi:[1,0]
    v_cvt_pk_bf16_f32 v148, v40, v41
    v_cvt_pk_bf16_f32 v149, v42, v43
    v_cvt_pk_bf16_f32 v150, v44, v45
    v_cvt_pk_bf16_f32 v151, v46, v47
    v_cvt_pk_bf16_f32 v152, v48, v49
    v_cvt_pk_bf16_f32 v153, v50, v51
    v_cvt_pk_bf16_f32 v154, v52, v53
    v_cvt_pk_bf16_f32 v155, v54, v55
    buffer_store_dwordx4 v[148:151], v156, s[40:43], s54 offen sc1
    buffer_store_dwordx4 v[152:155], v156, s[40:43], s54 offen offset:1024 sc1
    s_add_u32 s96, s28, 0x3a00000
    s_addc_u32 s97, s29, 0
    s_and_b32 s97, s97, 0xffff
    s_mov_b32 s98, 0x200000
    s_mov_b32 s99, 0x20000
    v_mov_b32 v252, s84
    v_mov_b32 v253, s85
    v_mov_b32_e64 v254, 0
    s_waitcnt vmcnt(0)
    s_barrier
    s_cmp_lg_u32 s3, 7
    s_cbranch_scc1 L_mp0_sg23
    s_mov_b64 exec, 1
    buffer_store_dwordx2 v[252:253], v254, s[96:99], s87 offen sc1
    s_mov_b64 exec, -1
L_mp0_sg23:
    s_mov_b64 exec, -1
    s_setprio 0
    s_branch L_wo_entry
L_attn_safe:
    s_add_u32 s36, s28, 0x900000
    s_addc_u32 s37, s29, 0
    s_add_u32 s36, s36, s52
    s_addc_u32 s37, s37, 0
    s_and_b32 s37, s37, 0xffff
    s_mov_b32 s38, 0x40000
    s_mov_b32 s39, 0x20000
    s_mov_b32 s56, 0
    v_mov_b32 v158, 0xff800000
L_attn_safe1:
    buffer_load_dwordx4 v[132:135], v156, s[36:39], s56 offen offset:0 sc1
    buffer_load_dwordx4 v[136:139], v156, s[36:39], s56 offen offset:1024 sc1
    s_waitcnt vmcnt(0)
    v_mfma_f32_32x32x16_bf16 v[8:23], v[132:135], v[112:115], 0
    v_mfma_f32_32x32x16_bf16 v[8:23], v[136:139], v[116:119], v[8:23]
    s_nop 15
    v_max3_f32 v158, v158, v8, v9
    v_max3_f32 v158, v158, v10, v11
    v_max3_f32 v158, v158, v12, v13
    v_max3_f32 v158, v158, v14, v15
    v_max3_f32 v158, v158, v16, v17
    v_max3_f32 v158, v158, v18, v19
    v_max3_f32 v158, v158, v20, v21
    v_max3_f32 v158, v158, v22, v23
    s_add_u32 s56, s56, 4096
    s_cmp_lt_u32 s56, 262144
    s_cbranch_scc1 L_attn_safe1
    v_mov_b32 v159, v158
    s_nop 1
    v_permlane32_swap_b32 v158, v159
    s_nop 1
    v_max_f32 v158, v158, v159
    v_sub_f32 v72, 0, v158
    v_mov_b32 v73, v72
    v_mov_b32 v74, v72
    v_mov_b32 v75, v72
    v_mov_b32 v76, v72
    v_mov_b32 v77, v72
    v_mov_b32 v78, v72
    v_mov_b32 v79, v72
    v_mov_b32 v80, v72
    v_mov_b32 v81, v72
    v_mov_b32 v82, v72
    v_mov_b32 v83, v72
    v_mov_b32 v84, v72
    v_mov_b32 v85, v72
    v_mov_b32 v86, v72
    v_mov_b32 v87, v72
    v_mov_b32 v40, 0
    v_mov_b32 v41, 0
    v_mov_b32 v42, 0
    v_mov_b32 v43, 0
    v_mov_b32 v44, 0
    v_mov_b32 v45, 0
    v_mov_b32 v46, 0
    v_mov_b32 v47, 0
    v_mov_b32 v48, 0
    v_mov_b32 v49, 0
    v_mov_b32 v50, 0
    v_mov_b32 v51, 0
    v_mov_b32 v52, 0
    v_mov_b32 v53, 0
    v_mov_b32 v54, 0
    v_mov_b32 v55, 0
    v_mov_b32 v104, 0
    v_mov_b32 v105, 0
    v_mov_b32 v106, 0
    v_mov_b32_e64 v107, 0
    s_mov_b32 s56, 0
L_attn_safe2:
    buffer_load_dwordx4 v[132:135], v156, s[36:39], s56 offen offset:0 sc1
    buffer_load_dwordx4 v[136:139], v156, s[36:39], s56 offen offset:1024 sc1
    buffer_load_dwordx4 v[140:143], v156, s[36:39], s56 offen offset:2048 sc1
    buffer_load_dwordx4 v[144:147], v156, s[36:39], s56 offen offset:3072 sc1
    s_waitcnt vmcnt(0)
    v_mfma_f32_32x32x16_bf16 v[8:23], v[132:135], v[112:115], v[72:87]
    v_mfma_f32_32x32x16_bf16 v[8:23], v[136:139], v[116:119], v[8:23]
    s_nop 15
    v_exp_f32 v8, v8
    v_exp_f32 v9, v9
    v_exp_f32 v10, v10
    v_exp_f32 v11, v11
    v_exp_f32 v12, v12
    v_exp_f32 v13, v13
    v_exp_f32 v14, v14
    v_exp_f32 v15, v15
    v_exp_f32 v16, v16
    v_exp_f32 v17, v17
    v_exp_f32 v18, v18
    v_exp_f32 v19, v19
    v_exp_f32 v20, v20
    v_exp_f32 v21, v21
    v_exp_f32 v22, v22
    v_exp_f32_e64 v23, v23
    s_nop 0
    v_cvt_pk_bf16_f32 v148, v8, v9
    v_cvt_pk_bf16_f32 v149, v10, v11
    v_cvt_pk_bf16_f32 v150, v12, v13
    v_cvt_pk_bf16_f32 v151, v14, v15
    v_cvt_pk_bf16_f32 v152, v16, v17
    v_cvt_pk_bf16_f32 v153, v18, v19
    v_cvt_pk_bf16_f32 v154, v20, v21
    v_cvt_pk_bf16_f32 v155, v22, v23
    s_nop 1
    v_mfma_f32_32x32x16_bf16 v[40:55], v[140:143], v[148:151], v[40:55]
    v_mfma_f32_16x16x32_bf16 v[104:107], v[128:131], v[148:151], v[104:107]
    v_mfma_f32_32x32x16_bf16 v[40:55], v[144:147], v[152:155], v[40:55]
    v_mfma_f32_16x16x32_bf16 v[104:107], v[128:131], v[152:155], v[104:107]
    s_add_u32 s56, s56, 4096
    s_nop 7
    s_cmp_lt_u32 s56, 262144
    s_cbranch_scc1 L_attn_safe2
    s_nop 15
    s_branch L_attn_store
L_wo_entry:
    v_and_b32 v1, 63, v0
    s_mov_b32 s46, s3
    s_and_b32 s47, s2, 7
    s_lshr_b32 s48, s2, 3
    s_and_b32 s30, s47, 3
    s_lshl_b32 s30, s30, 3
    s_and_b32 s49, s48, 7
    s_add_u32 s30, s30, s49
    s_lshr_b32 s31, s47, 2
    s_mul_i32 s31, s31, 4
    s_lshr_b32 s49, s48, 3
    s_add_u32 s31, s31, s49
    s_and_b32 s30, s47, 3
    s_lshl_b32 s30, s30, 3
    s_and_b32 s49, s48, 3
    s_lshl_b32 s49, s49, 1
    s_add_u32 s30, s30, s49
    s_bfe_u32 s49, s48, 0x10002
    s_add_u32 s30, s30, s49
    s_lshr_b32 s100, s30, 1
    s_lshl_b32 s100, s100, 8
    s_and_b32 s101, s30, 1
    s_lshl_b32 s101, s101, 7
    s_add_u32 s100, s100, s101
    s_lshl_b32 s101, s31, 4
    s_add_u32 s100, s100, s101
    s_add_u32 s100, s100, 24576
    s_lshl_b32 s87, s100, 5
    s_cmp_ge_u32 s46, 4
    s_cbranch_scc1 L_wo_comp
    s_mul_i32 s50, s30, 131072
    s_mul_i32 s51, s46, 2
    s_lshr_b32 s52, s51, 2
    s_and_b32 s51, s51, 3
    s_mul_i32 s52, s52, 65536
    s_lshl_b32 s51, s51, 10
    s_add_u32 s50, s50, s52
    s_add_u32 s50, s50, s51
    v_lshl_add_u32 v8, v1, 4, s50
    v_add_u32 v9, 1024, v8
    v_lshrrev_b32 v2, 4, v1
    v_bfe_u32 v3, v1, 2, 2
    v_and_b32 v4, 3, v1
    v_and_b32 v5, 2, v2
    v_xor_b32 v4, v4, v5
    v_lshrrev_b32 v5, 1, v2
    v_lshl_add_u32 v5, v5, 2, v3
    v_mul_u32_u24 v5, 2048, v5
    v_and_b32_e64 v6, 1, v2
    v_lshl_add_u32 v5, v6, 6, v5
    v_lshl_add_u32 v5, v4, 4, v5
    s_mul_i32 s50, s46, 32768
    s_mul_i32 s51, s31, 256
    s_add_u32 s50, s50, s51
    v_add_u32 v5, s50, v5
    v_add_u32_e64 v10, 0, v5
    v_add_u32 v11, 128, v5
    v_add_u32 v12, 16384, v5
    v_add_u32 v13, 16512, v5
    s_mul_i32 s55, s46, 2048
    s_mul_i32 s56, s46, 4096
    s_add_u32 s56, s56, 8192
    s_waitcnt lgkmcnt(0)
    s_mov_b32 s36, s8
    s_and_b32 s37, s9, 0xffff
    s_mov_b32 s38, 0x200000
    s_mov_b32 s39, 0x20000
    s_add_u32 s32, s28, 0x1100000
    s_addc_u32 s33, s29, 0
    s_and_b32 s33, s33, 0xffff
    s_mov_b32 s34, 0x400000
    s_mov_b32 s35, 0x20000
    s_mul_i32 s54, s31, 1
    s_add_u32 s54, s54, s30
    s_add_u32 s57, s54, 0
    s_and_b32 s57, s57, 3
    s_mul_i32 s57, s57, 131072
    s_add_u32 m0, s56, 0
    s_nop 0
    buffer_load_dwordx4 v10, s[36:39], s57 offen lds
    s_add_u32 m0, s56, 1024
    s_nop 0
    buffer_load_dwordx4 v11, s[36:39], s57 offen lds
    s_add_u32 m0, s56, 2048
    s_nop 0
    buffer_load_dwordx4 v12, s[36:39], s57 offen lds
    s_add_u32 m0, s56, 3072
    s_nop 0
    buffer_load_dwordx4 v13, s[36:39], s57 offen lds
    s_add_u32 s57, s54, 1
    s_and_b32 s57, s57, 3
    s_mul_i32 s57, s57, 131072
    s_add_u32 m0, s56, 24576
    s_nop 0
    buffer_load_dwordx4 v10, s[36:39], s57 offen lds
    s_add_u32 m0, s56, 25600
    s_nop 0
    buffer_load_dwordx4 v11, s[36:39], s57 offen lds
    s_add_u32 m0, s56, 26624
    s_nop 0
    buffer_load_dwordx4 v12, s[36:39], s57 offen lds
    s_add_u32 m0, s56, 27648
    s_nop 0
    buffer_load_dwordx4 v13, s[36:39], s57 offen lds
    s_add_u32 s57, s54, 2
    s_and_b32 s57, s57, 3
    s_mul_i32 s57, s57, 131072
    s_add_u32 m0, s56, 49152
    s_nop 0
    buffer_load_dwordx4 v10, s[36:39], s57 offen lds
    s_add_u32 m0, s56, 50176
    s_nop 0
    buffer_load_dwordx4 v11, s[36:39], s57 offen lds
    s_add_u32 m0, s56, 51200
    s_nop 0
    buffer_load_dwordx4 v12, s[36:39], s57 offen lds
    s_add_u32 m0, s56, 52224
    s_nop 0
    buffer_load_dwordx4 v13, s[36:39], s57 offen lds
    s_add_u32 s57, s54, 3
    s_and_b32 s57, s57, 3
    s_mul_i32 s57, s57, 131072
    s_add_u32 m0, s56, 73728
    s_nop 0
    buffer_load_dwordx4 v10, s[36:39], s57 offen lds
    s_add_u32 m0, s56, 74752
    s_nop 0
    buffer_load_dwordx4 v11, s[36:39], s57 offen lds
    s_add_u32 m0, s56, 75776
    s_nop 0
    buffer_load_dwordx4 v12, s[36:39], s57 offen lds
    s_add_u32 m0, s56, 76800
    s_nop 0
    buffer_load_dwordx4 v13, s[36:39], s57 offen lds
    s_add_u32 s57, s54, 4
    s_and_b32 s57, s57, 3
    s_mul_i32 s57, s57, 131072
    s_add_u32 s57, s57, 524288
    s_add_u32 m0, s56, 98304
    s_nop 0
    buffer_load_dwordx4 v10, s[36:39], s57 offen lds
    s_add_u32 m0, s56, 99328
    s_nop 0
    buffer_load_dwordx4 v11, s[36:39], s57 offen lds
    s_add_u32 m0, s56, 100352
    s_nop 0
    buffer_load_dwordx4 v12, s[36:39], s57 offen lds
    s_add_u32 m0, s56, 101376
    s_nop 0
    buffer_load_dwordx4 v13, s[36:39], s57 offen lds
    s_mov_b32 s40, s4
    s_and_b32 s41, s5, 0xffff
    s_mov_b32 s42, 0x400000
    s_mov_b32 s43, 0x20000
    v_lshrrev_b32 v2, 4, v1
    v_and_b32_e64 v3, 15, v1
    s_lshl_b32 s62, s30, 17
    s_lshl_b32 s63, s31, 8
    s_add_u32 s62, s62, s63
    s_lshl_b32 s63, s46, 15
    s_add_u32 s62, s62, s63
    s_lshl_b32 s63, s46, 12
    s_add_u32 s63, s63, 131072
    v_add_u32 v4, 0, v2
    v_xor_b32 v5, v4, v3
    v_lshlrev_b32_e64 v5, 4, v5
    v_lshl_add_u32 v5, v4, 11, v5
    s_add_u32 m0, s63, 0
    s_nop 0
    buffer_load_dwordx4 v5, s[40:43], s62 offen lds
    v_add_u32 v4, 4, v2
    v_xor_b32 v5, v4, v3
    v_lshlrev_b32_e64 v5, 4, v5
    v_lshl_add_u32 v5, v4, 11, v5
    s_add_u32 m0, s63, 1024
    s_nop 0
    buffer_load_dwordx4 v5, s[40:43], s62 offen lds
    v_add_u32 v4, 8, v2
    v_xor_b32 v5, v4, v3
    v_lshlrev_b32 v5, 4, v5
    v_lshl_add_u32 v5, v4, 11, v5
    s_add_u32 m0, s63, 2048
    s_nop 0
    buffer_load_dwordx4 v5, s[40:43], s62 offen lds
    v_add_u32 v4, 12, v2
    v_xor_b32 v5, v4, v3
    v_lshlrev_b32 v5, 4, v5
    v_lshl_add_u32 v5, v4, 11, v5
    s_add_u32 m0, s63, 3072
    s_nop 0
    buffer_load_dwordx4 v5, s[40:43], s62 offen lds
    s_barrier
    s_add_u32 s57, s54, 0
    s_and_b32 s57, s57, 3
    s_mul_i32 s57, s57, 4096
    s_add_u32 m0, s55, 0
    s_nop 0
    buffer_load_dwordx4 v8, s[32:35], s57 offen sc1 lds
    s_add_u32 m0, s55, 1024
    s_nop 0
    buffer_load_dwordx4 v9, s[32:35], s57 offen sc1 lds
    s_add_u32 s57, s54, 1
    s_and_b32 s57, s57, 3
    s_mul_i32 s57, s57, 4096
    s_add_u32 m0, s55, 24576
    s_nop 0
    buffer_load_dwordx4 v8, s[32:35], s57 offen sc1 lds
    s_add_u32 m0, s55, 25600
    s_nop 0
    buffer_load_dwordx4 v9, s[32:35], s57 offen sc1 lds
    s_waitcnt vmcnt(2)
    s_barrier
    s_add_u32 s57, s54, 2
    s_and_b32 s57, s57, 3
    s_mul_i32 s57, s57, 4096
    s_add_u32 m0, s55, 49152
    s_nop 0
    buffer_load_dwordx4 v8, s[32:35], s57 offen sc1 lds
    s_add_u32 m0, s55, 50176
    s_nop 0
    buffer_load_dwordx4 v9, s[32:35], s57 offen sc1 lds
    s_add_u32 s57, s54, 3
    s_and_b32 s57, s57, 3
    s_mul_i32 s57, s57, 4096
    s_add_u32 m0, s55, 73728
    s_nop 0
    buffer_load_dwordx4 v8, s[32:35], s57 offen sc1 lds
    s_add_u32 m0, s55, 74752
    s_nop 0
    buffer_load_dwordx4 v9, s[32:35], s57 offen sc1 lds
    s_add_u32 s57, s54, 4
    s_and_b32 s57, s57, 3
    s_mul_i32 s57, s57, 4096
    s_add_u32 s57, s57, 16384
    s_add_u32 m0, s55, 98304
    s_nop 0
    buffer_load_dwordx4 v8, s[32:35], s57 offen sc1 lds
    s_add_u32 m0, s55, 99328
    s_nop 0
    buffer_load_dwordx4 v9, s[32:35], s57 offen sc1 lds
    s_waitcnt vmcnt(6)
    s_barrier
    s_waitcnt vmcnt(4)
    s_barrier
    s_add_u32 s57, s54, 5
    s_and_b32 s57, s57, 3
    s_mul_i32 s57, s57, 131072
    s_add_u32 s57, s57, 524288
    s_add_u32 m0, s56, 0
    s_nop 0
    buffer_load_dwordx4 v10, s[36:39], s57 offen lds
    s_add_u32 m0, s56, 1024
    s_nop 0
    buffer_load_dwordx4 v11, s[36:39], s57 offen lds
    s_add_u32 m0, s56, 2048
    s_nop 0
    buffer_load_dwordx4 v12, s[36:39], s57 offen lds
    s_add_u32 m0, s56, 3072
    s_nop 0
    buffer_load_dwordx4 v13, s[36:39], s57 offen lds
    s_add_u32 s57, s54, 5
    s_and_b32 s57, s57, 3
    s_mul_i32 s57, s57, 4096
    s_add_u32 s57, s57, 16384
    s_add_u32 m0, s55, 0
    s_nop 0
    buffer_load_dwordx4 v8, s[32:35], s57 offen sc1 lds
    s_add_u32 m0, s55, 1024
    s_nop 0
    buffer_load_dwordx4 v9, s[32:35], s57 offen sc1 lds
    s_waitcnt vmcnt(8)
    s_barrier
    s_add_u32 s57, s54, 6
    s_and_b32 s57, s57, 3
    s_mul_i32 s57, s57, 131072
    s_add_u32 s57, s57, 524288
    s_add_u32 m0, s56, 24576
    s_nop 0
    buffer_load_dwordx4 v10, s[36:39], s57 offen lds
    s_add_u32 m0, s56, 25600
    s_nop 0
    buffer_load_dwordx4 v11, s[36:39], s57 offen lds
    s_add_u32 m0, s56, 26624
    s_nop 0
    buffer_load_dwordx4 v12, s[36:39], s57 offen lds
    s_add_u32 m0, s56, 27648
    s_nop 0
    buffer_load_dwordx4 v13, s[36:39], s57 offen lds
    s_add_u32 s57, s54, 6
    s_and_b32 s57, s57, 3
    s_mul_i32 s57, s57, 4096
    s_add_u32 s57, s57, 16384
    s_add_u32 m0, s55, 24576
    s_nop 0
    buffer_load_dwordx4 v8, s[32:35], s57 offen sc1 lds
    s_add_u32 m0, s55, 25600
    s_nop 0
    buffer_load_dwordx4 v9, s[32:35], s57 offen sc1 lds
    s_waitcnt vmcnt(12)
    s_barrier
    s_add_u32 s57, s54, 7
    s_and_b32 s57, s57, 3
    s_mul_i32 s57, s57, 131072
    s_add_u32 s57, s57, 524288
    s_add_u32 m0, s56, 49152
    s_nop 0
    buffer_load_dwordx4 v10, s[36:39], s57 offen lds
    s_add_u32 m0, s56, 50176
    s_nop 0
    buffer_load_dwordx4 v11, s[36:39], s57 offen lds
    s_add_u32 m0, s56, 51200
    s_nop 0
    buffer_load_dwordx4 v12, s[36:39], s57 offen lds
    s_add_u32 m0, s56, 52224
    s_nop 0
    buffer_load_dwordx4 v13, s[36:39], s57 offen lds
    s_add_u32 s57, s54, 7
    s_and_b32 s57, s57, 3
    s_mul_i32 s57, s57, 4096
    s_add_u32 s57, s57, 16384
    s_add_u32 m0, s55, 49152
    s_nop 0
    buffer_load_dwordx4 v8, s[32:35], s57 offen sc1 lds
    s_add_u32 m0, s55, 50176
    s_nop 0
    buffer_load_dwordx4 v9, s[32:35], s57 offen sc1 lds
    s_add_u32 s60, s55, 122880
    s_add_u32 s55, s55, 73728
    s_add_u32 s56, s56, 73728
    s_mov_b32 s57, 32768
    s_mov_b32 s58, 1048576
    s_mov_b32 s59, 8
L_wo_lloop:
    s_add_u32 s57, s54, s59
    s_and_b32 s57, s57, 3
    s_andn2_b32 s58, s59, 3
    s_or_b32 s57, s57, s58
    s_mul_i32 s58, s57, 131072
    s_mul_i32 s57, s57, 4096
    s_waitcnt vmcnt(12)
    s_barrier
    s_add_u32 m0, s56, 0
    s_nop 0
    buffer_load_dwordx4 v10, s[36:39], s58 offen lds
    s_add_u32 m0, s56, 1024
    s_nop 0
    buffer_load_dwordx4 v11, s[36:39], s58 offen lds
    s_add_u32 m0, s56, 2048
    s_nop 0
    buffer_load_dwordx4 v12, s[36:39], s58 offen lds
    s_add_u32 m0, s56, 3072
    s_nop 0
    buffer_load_dwordx4 v13, s[36:39], s58 offen lds
    s_add_u32 m0, s55, 0
    s_nop 0
    buffer_load_dwordx4 v8, s[32:35], s57 offen sc1 lds
    s_add_u32 m0, s55, 1024
    s_nop 0
    buffer_load_dwordx4 v9, s[32:35], s57 offen sc1 lds
    s_add_u32 s57, s57, 4096
    s_add_u32 s58, s58, 131072
    s_add_u32 s55, s55, 24576
    s_add_u32 s56, s56, 24576
    s_cmp_eq_u32 s55, s60
    s_cselect_b32 s61, 122880, 0
    s_sub_u32 s55, s55, s61
    s_sub_u32 s56, s56, s61
    s_add_u32 s59, s59, 1
    s_cmp_lt_u32 s59, 16
    s_cbranch_scc1 L_wo_lloop
    s_and_b32 s44, s46, 1
    s_lshl_b32 s44, s44, 13
    s_cmp_ge_u32 s2, 32
    s_cbranch_scc1 L_mp0_ct24
    s_getpc_b64 s[64:65]
L_mp0_pc25:
    s_add_u32 s64, s64, L_wo_epi-L_mp0_pc25
    s_addc_u32 s65, s65, 0
    v_and_b32_e64 v60, 63, v0
    v_lshl_add_u32 v60, v60, 7, s44
    v_min_u32 v60, L_text_end-L_wo_epi-4, v60
    v_mov_b32 v61, s65
    v_add_co_u32 v60, vcc, s64, v60
    s_nop 1
    v_addc_co_u32 v61, vcc, 0, v61, vcc
    global_load_dword v62, v[60:61], off
L_mp0_ct24:
    s_waitcnt vmcnt(12)
    s_barrier
    s_waitcnt vmcnt(6)
    s_barrier
    s_waitcnt vmcnt(0)
    s_barrier
    s_barrier
    s_waitcnt vmcnt(0)
    s_mov_b64 exec, -1
    s_setprio 0
    s_branch L_win_entry
L_wo_comp:
    s_setprio 1
    s_sub_u32 s46, s46, 4
    s_lshr_b32 s50, s46, 1
    s_and_b32 s51, s46, 1
    v_and_b32 v3, 31, v1
    v_lshrrev_b32 v4, 5, v1
    v_and_b32 v5, 15, v1
    v_lshrrev_b32_e64 v6, 4, v1
    s_mul_i32 s52, s50, 4096
    v_lshl_add_u32 v7, v5, 4, s52
    v_lshl_add_u32 v88, v6, 9, v7
    v_mul_u32_u24 v5, 4096, v4
    v_and_b32_e64 v6, 1, v6
    v_lshl_add_u32 v5, v6, 9, v5
    v_lshl_add_u32 v5, v6, 5, v5
    v_bfe_u32 v6, v1, 2, 2
    v_lshl_add_u32 v5, v6, 6, v5
    v_bfe_u32 v6, v1, 1, 1
    v_lshl_add_u32 v5, v6, 3, v5
    v_and_b32_e64 v6, 1, v1
    v_lshl_add_u32 v5, v6, 4, v5
    s_mul_i32 s52, s51, 1024
    s_add_u32 s52, s52, 8192
    v_add_u32 v90, s52, v5
    v_xor_b32_e64 v91, 32, v90
    s_waitcnt lgkmcnt(0)
    s_add_u32 s36, s28, 0x1500000
    s_addc_u32 s37, s29, 0
    s_and_b32 s37, s37, 0xffff
    s_mov_b32 s38, 0x800000
    s_mov_b32 s39, 0x20000
    s_add_u32 s32, s28, 0x40000
    s_addc_u32 s33, s29, 0
    s_and_b32 s33, s33, 0xffff
    s_mov_b32 s34, 0x40000
    s_mov_b32 s35, 0x20000
    v_lshlrev_b32_e64 v94, 4, v1
    s_lshl_b32 s60, s31, 7
    s_lshl_b32 s61, s51, 6
    s_add_u32 s60, s60, s61
    s_lshl_b32 s61, s30, 1
    s_add_u32 s61, s61, s50
    s_lshl_b32 s62, s61, 16
    s_lshl_b32 s63, s60, 1
    s_add_u32 s63, s63, s62
    s_lshl_b32 s64, s60, 6
    s_add_u32 s64, s64, s62
    s_add_u32 s65, s64, 4194304
    s_lshl_b32 s66, s50, 13
    s_add_u32 s66, s66, 131072
    v_and_b32 v5, 15, v3
    s_lshl_b32 s67, s51, 3
    v_xor_b32 v5, s67, v5
    v_lshlrev_b32_e64 v5, 4, v5
    v_lshl_add_u32 v5, v3, 8, v5
    v_lshl_add_u32 v5, v4, 3, v5
    v_add_u32 v95, s66, v5
    s_lshl_b32 s67, s51, 8
    s_add_u32 s67, s67, 147456
    v_lshl_add_u32 v96, v4, 4, s67
    s_mov_b32 s53, 0
    v_add_u32 v89, s53, v88
    v_add_u32 v92, s53, v90
    v_add_u32 v93, s53, v91
    s_cmp_lg_u32 s3, 4
    s_cbranch_scc1 L_mp0_wd26
    s_add_u32 s96, s28, 0x3a00000
    s_addc_u32 s97, s29, 0
    s_and_b32 s97, s97, 0xffff
    s_mov_b32 s98, 0x200000
    s_mov_b32 s99, 0x20000
    s_lshr_b32 s100, s30, 1
    s_lshl_b32 s100, s100, 8
    s_add_u32 s100, s100, 16384
    s_lshl_b32 s100, s100, 5
    v_lshlrev_b32_e64 v254, 7, v1
    s_mov_b32 s101, 0x100000
    s_bfm_b64 exec, 16, 0
L_mp0_wf27:
    buffer_load_dwordx2 v[252:253], v254, s[96:99], s100 offen sc1
    s_waitcnt vmcnt(0)
    v_cmp_ne_u64 vcc, s[84:85], v[252:253]
    s_sub_u32 s101, s101, 1
    s_nop 3
    s_cbranch_vccz L_mp0_we28
    s_mov_b64 exec, vcc
    s_sleep 1
    s_cmp_lg_u32 s101, 0
    s_cbranch_scc1 L_mp0_wf27
L_mp0_we28:
    s_mov_b64 exec, -1
L_mp0_wd26:
    s_barrier
    s_cmp_lg_u32 s46, 1
    s_cbranch_scc1 L_mp0_ev29
    s_mov_b32 s80, s28
    s_and_b32 s81, s29, 0xffff
    s_mov_b32 s82, 0x40000
    s_mov_b32 s83, 0x20000
    v_lshlrev_b32 v100, 4, v3
    v_lshl_add_u32 v100, v4, 13, v100
    s_lshl_b32 s68, s31, 9
    s_add_u32 s68, s68, 163840
    s_add_u32 s69, s68, 16384
    buffer_load_dwordx4 v[116:119], v100, s[80:83], s68 offen sc1
    buffer_load_dwordx4 v[120:123], v100, s[80:83], s69 offen sc1
    v_and_b32 v101, 15, v1
    v_lshlrev_b32 v101, 2, v101
    s_lshl_b32 s70, s2, 6
    s_add_u32 s68, s70, 163840
    s_add_u32 s69, s68, 16384
    buffer_load_dword v124, v101, s[80:83], s68 offen sc1
    buffer_load_dword v125, v101, s[80:83], s69 offen sc1
    v_cvt_f32_u32 v102, v4
    v_add_u32 v103, 147456, v94
    s_waitcnt vmcnt(0)
    v_pk_add_f32 v[116:117], v[116:117], v[120:121]
    v_pk_add_f32 v[118:119], v[118:119], v[122:123]
    v_cvt_pk_bf16_f32 v120, v116, v117
    v_lshlrev_b32_e64 v116, 16, v120
    v_and_b32 v117, 0xffff0000, v120
    v_cvt_pk_bf16_f32 v120, v118, v119
    v_lshlrev_b32_e64 v118, 16, v120
    v_and_b32 v119, 0xffff0000, v120
    v_add_f32 v116, v102, v116
    v_add_f32 v117, v102, v117
    v_add_f32 v118, v102, v118
    v_add_f32 v119, v102, v119
    v_cvt_pk_bf16_f32 v120, v116, v117
    v_lshlrev_b32_e64 v116, 16, v120
    v_and_b32 v117, 0xffff0000, v120
    v_cvt_pk_bf16_f32 v120, v118, v119
    v_lshlrev_b32_e64 v118, 16, v120
    v_and_b32 v119, 0xffff0000, v120
    ds_write_b128 v103, v[116:119]
    s_lshr_b32 s68, s2, 6
    s_cmp_eq_u32 s68, 2
    s_cselect_b32 s68, 1.0, 0
    v_add_f32 v124, v124, v125
    v_cvt_pk_bf16_f32 v124, v124, v124
    v_lshlrev_b32 v124, 16, v124
    v_add_f32 v124, s68, v124
    v_cvt_pk_bf16_f32 v124, v124, v124
    v_lshlrev_b32_e64 v124, 16, v124
    s_add_u32 s70, s70, 8192
    s_mov_b64 exec, 0xffff
    buffer_store_dword v124, v101, s[80:83], s70 offen sc1
    s_mov_b64 exec, -1
    s_waitcnt lgkmcnt(0)
L_mp0_ev29:
    s_barrier
    s_nop 0
    ds_read_b128 v[40:43], v89 offset:0
    ds_read_b64_tr_b16 v[56:57], v92 offset:0
    ds_read_b64_tr_b16 v[58:59], v92 offset:2048
    ds_read_b128 v[44:47], v89 offset:256
    ds_read_b64_tr_b16 v[60:61], v93 offset:0
    ds_read_b64_tr_b16 v[62:63], v93 offset:2048
    ds_read_b64_tr_b16 v[64:65], v92 offset:256
    ds_read_b64_tr_b16 v[66:67], v92 offset:2304
    ds_read_b64_tr_b16 v[68:69], v93 offset:256
    ds_read_b64_tr_b16 v[70:71], v93 offset:2304
    s_waitcnt lgkmcnt(7)
    v_mfma_f32_16x16x32_bf16 v[8:11], v[56:59], v[40:43], 0
    ds_read_b128 v[48:51], v89 offset:2048
    ds_read_b64_tr_b16 v[72:73], v92 offset:8192
    s_waitcnt lgkmcnt(8)
    v_mfma_f32_16x16x32_bf16 v[12:15], v[56:59], v[44:47], 0
    ds_read_b64_tr_b16 v[74:75], v92 offset:10240
    ds_read_b128 v[52:55], v89 offset:2304
    s_waitcnt lgkmcnt(8)
    v_mfma_f32_16x16x32_bf16 v[16:19], v[60:63], v[40:43], 0
    ds_read_b64_tr_b16 v[76:77], v93 offset:8192
    v_mfma_f32_16x16x32_bf16 v[20:23], v[60:63], v[44:47], 0
    ds_read_b64_tr_b16 v[78:79], v93 offset:10240
    ds_read_b64_tr_b16 v[80:81], v92 offset:8448
    s_waitcnt lgkmcnt(9)
    v_mfma_f32_16x16x32_bf16 v[24:27], v[64:67], v[40:43], 0
    ds_read_b64_tr_b16 v[82:83], v92 offset:10496
    ds_read_b64_tr_b16 v[84:85], v93 offset:8448
    v_mfma_f32_16x16x32_bf16 v[28:31], v[64:67], v[44:47], 0
    ds_read_b64_tr_b16 v[86:87], v93 offset:10496
    s_waitcnt lgkmcnt(9)
    v_mfma_f32_16x16x32_bf16 v[32:35], v[68:71], v[40:43], 0
    s_add_u32 s53, s53, 24576
    s_cmp_eq_u32 s53, 122880
    v_mfma_f32_16x16x32_bf16 v[36:39], v[68:71], v[44:47], 0
    s_cselect_b32 s53, 0, s53
    v_add_u32 v89, s53, v88
    v_add_u32 v92, s53, v90
    v_add_u32_e64 v93, s53, v91
    s_barrier
    s_waitcnt lgkmcnt(7)
    v_mfma_f32_16x16x32_bf16 v[8:11], v[72:75], v[48:51], v[8:11]
    ds_read_b128 v[40:43], v89 offset:0
    ds_read_b64_tr_b16 v[56:57], v92 offset:0
    s_waitcnt lgkmcnt(8)
    v_mfma_f32_16x16x32_bf16 v[12:15], v[72:75], v[52:55], v[12:15]
    ds_read_b64_tr_b16 v[58:59], v92 offset:2048
    s_waitcnt lgkmcnt(7)
    v_mfma_f32_16x16x32_bf16 v[16:19], v[76:79], v[48:51], v[16:19]
    ds_read_b128 v[44:47], v89 offset:256
    v_mfma_f32_16x16x32_bf16 v[20:23], v[76:79], v[52:55], v[20:23]
    ds_read_b64_tr_b16 v[60:61], v93 offset:0
    s_waitcnt lgkmcnt(7)
    v_mfma_f32_16x16x32_bf16 v[24:27], v[80:83], v[48:51], v[24:27]
    ds_read_b64_tr_b16 v[62:63], v93 offset:2048
    ds_read_b64_tr_b16 v[64:65], v92 offset:256
    v_mfma_f32_16x16x32_bf16 v[28:31], v[80:83], v[52:55], v[28:31]
    ds_read_b64_tr_b16 v[66:67], v92 offset:2304
    s_waitcnt lgkmcnt(8)
    v_mfma_f32_16x16x32_bf16 v[32:35], v[84:87], v[48:51], v[32:35]
    ds_read_b64_tr_b16 v[68:69], v93 offset:256
    v_mfma_f32_16x16x32_bf16 v[36:39], v[84:87], v[52:55], v[36:39]
    ds_read_b64_tr_b16 v[70:71], v93 offset:2304
    s_mov_b32 s54, 7
L_wo_loop:
    s_waitcnt lgkmcnt(7)
    v_mfma_f32_16x16x32_bf16 v[8:11], v[56:59], v[40:43], v[8:11]
    ds_read_b128 v[48:51], v89 offset:2048
    ds_read_b64_tr_b16 v[72:73], v92 offset:8192
    s_waitcnt lgkmcnt(8)
    v_mfma_f32_16x16x32_bf16 v[12:15], v[56:59], v[44:47], v[12:15]
    ds_read_b64_tr_b16 v[74:75], v92 offset:10240
    ds_read_b128 v[52:55], v89 offset:2304
    s_waitcnt lgkmcnt(8)
    v_mfma_f32_16x16x32_bf16 v[16:19], v[60:63], v[40:43], v[16:19]
    ds_read_b64_tr_b16 v[76:77], v93 offset:8192
    v_mfma_f32_16x16x32_bf16 v[20:23], v[60:63], v[44:47], v[20:23]
    ds_read_b64_tr_b16 v[78:79], v93 offset:10240
    ds_read_b64_tr_b16 v[80:81], v92 offset:8448
    s_waitcnt lgkmcnt(9)
    v_mfma_f32_16x16x32_bf16 v[24:27], v[64:67], v[40:43], v[24:27]
    ds_read_b64_tr_b16 v[82:83], v92 offset:10496
    ds_read_b64_tr_b16 v[84:85], v93 offset:8448
    v_mfma_f32_16x16x32_bf16 v[28:31], v[64:67], v[44:47], v[28:31]
    ds_read_b64_tr_b16 v[86:87], v93 offset:10496
    s_waitcnt lgkmcnt(9)
    v_mfma_f32_16x16x32_bf16 v[32:35], v[68:71], v[40:43], v[32:35]
    s_add_u32 s53, s53, 24576
    s_cmp_eq_u32 s53, 122880
    v_mfma_f32_16x16x32_bf16 v[36:39], v[68:71], v[44:47], v[36:39]
    s_cselect_b32 s53, 0, s53
    v_add_u32 v89, s53, v88
    v_add_u32 v92, s53, v90
    v_add_u32 v93, s53, v91
    s_barrier
    s_waitcnt lgkmcnt(7)
    v_mfma_f32_16x16x32_bf16 v[8:11], v[72:75], v[48:51], v[8:11]
    ds_read_b128 v[40:43], v89 offset:0
    ds_read_b64_tr_b16 v[56:57], v92 offset:0
    s_waitcnt lgkmcnt(8)
    v_mfma_f32_16x16x32_bf16 v[12:15], v[72:75], v[52:55], v[12:15]
    ds_read_b64_tr_b16 v[58:59], v92 offset:2048
    s_waitcnt lgkmcnt(7)
    v_mfma_f32_16x16x32_bf16 v[16:19], v[76:79], v[48:51], v[16:19]
    ds_read_b128 v[44:47], v89 offset:256
    v_mfma_f32_16x16x32_bf16 v[20:23], v[76:79], v[52:55], v[20:23]
    ds_read_b64_tr_b16 v[60:61], v93 offset:0
    s_waitcnt lgkmcnt(7)
    v_mfma_f32_16x16x32_bf16 v[24:27], v[80:83], v[48:51], v[24:27]
    ds_read_b64_tr_b16 v[62:63], v93 offset:2048
    ds_read_b64_tr_b16 v[64:65], v92 offset:256
    v_mfma_f32_16x16x32_bf16 v[28:31], v[80:83], v[52:55], v[28:31]
    ds_read_b64_tr_b16 v[66:67], v92 offset:2304
    s_waitcnt lgkmcnt(8)
    v_mfma_f32_16x16x32_bf16 v[32:35], v[84:87], v[48:51], v[32:35]
    ds_read_b64_tr_b16 v[68:69], v93 offset:256
    v_mfma_f32_16x16x32_bf16 v[36:39], v[84:87], v[52:55], v[36:39]
    ds_read_b64_tr_b16 v[70:71], v93 offset:2304
    s_waitcnt lgkmcnt(7)
    v_mfma_f32_16x16x32_bf16 v[8:11], v[56:59], v[40:43], v[8:11]
    ds_read_b128 v[48:51], v89 offset:2048
    ds_read_b64_tr_b16 v[72:73], v92 offset:8192
    s_waitcnt lgkmcnt(8)
    v_mfma_f32_16x16x32_bf16 v[12:15], v[56:59], v[44:47], v[12:15]
    ds_read_b64_tr_b16 v[74:75], v92 offset:10240
    ds_read_b128 v[52:55], v89 offset:2304
    s_waitcnt lgkmcnt(8)
    v_mfma_f32_16x16x32_bf16 v[16:19], v[60:63], v[40:43], v[16:19]
    ds_read_b64_tr_b16 v[76:77], v93 offset:8192
    v_mfma_f32_16x16x32_bf16 v[20:23], v[60:63], v[44:47], v[20:23]
    ds_read_b64_tr_b16 v[78:79], v93 offset:10240
    ds_read_b64_tr_b16 v[80:81], v92 offset:8448
    s_waitcnt lgkmcnt(9)
    v_mfma_f32_16x16x32_bf16 v[24:27], v[64:67], v[40:43], v[24:27]
    ds_read_b64_tr_b16 v[82:83], v92 offset:10496
    ds_read_b64_tr_b16 v[84:85], v93 offset:8448
    v_mfma_f32_16x16x32_bf16 v[28:31], v[64:67], v[44:47], v[28:31]
    ds_read_b64_tr_b16 v[86:87], v93 offset:10496
    s_waitcnt lgkmcnt(9)
    v_mfma_f32_16x16x32_bf16 v[32:35], v[68:71], v[40:43], v[32:35]
    s_add_u32 s53, s53, 24576
    s_cmp_eq_u32 s53, 122880
    v_mfma_f32_16x16x32_bf16 v[36:39], v[68:71], v[44:47], v[36:39]
    s_cselect_b32 s53, 0, s53
    v_add_u32 v89, s53, v88
    v_add_u32 v92, s53, v90
    v_add_u32_e64 v93, s53, v91
    s_barrier
    s_waitcnt lgkmcnt(7)
    v_mfma_f32_16x16x32_bf16 v[8:11], v[72:75], v[48:51], v[8:11]
    ds_read_b128 v[40:43], v89 offset:0
    ds_read_b64_tr_b16 v[56:57], v92 offset:0
    s_waitcnt lgkmcnt(8)
    v_mfma_f32_16x16x32_bf16 v[12:15], v[72:75], v[52:55], v[12:15]
    ds_read_b64_tr_b16 v[58:59], v92 offset:2048
    ds_read_b128 v[44:47], v89 offset:256
    s_waitcnt lgkmcnt(8)
    v_mfma_f32_16x16x32_bf16 v[16:19], v[76:79], v[48:51], v[16:19]
    ds_read_b64_tr_b16 v[60:61], v93 offset:0
    v_mfma_f32_16x16x32_bf16 v[20:23], v[76:79], v[52:55], v[20:23]
    ds_read_b64_tr_b16 v[62:63], v93 offset:2048
    ds_read_b64_tr_b16 v[64:65], v92 offset:256
    s_waitcnt lgkmcnt(9)
    v_mfma_f32_16x16x32_bf16 v[24:27], v[80:83], v[48:51], v[24:27]
    ds_read_b64_tr_b16 v[66:67], v92 offset:2304
    ds_read_b64_tr_b16 v[68:69], v93 offset:256
    v_mfma_f32_16x16x32_bf16 v[28:31], v[80:83], v[52:55], v[28:31]
    ds_read_b64_tr_b16 v[70:71], v93 offset:2304
    s_waitcnt lgkmcnt(9)
    v_mfma_f32_16x16x32_bf16 v[32:35], v[84:87], v[48:51], v[32:35]
    s_sub_u32 s54, s54, 1
    s_cmp_lg_u32 s54, 0
    v_mfma_f32_16x16x32_bf16 v[36:39], v[84:87], v[52:55], v[36:39]
    s_cbranch_scc1 L_wo_loop
L_wo_epi:
    s_nop 0
    ds_read_b128 v[116:119], v96 offset:0
    ds_read_b128 v[120:123], v96 offset:32
    ds_read_b128 v[124:127], v96 offset:64
    ds_read_b128 v[128:131], v96 offset:96
    ds_read_b128 v[132:135], v96 offset:128
    ds_read_b128 v[136:139], v96 offset:160
    ds_read_b128 v[140:143], v96 offset:192
    ds_read_b128 v[144:147], v96 offset:224
    v_xor_b32_e64 v97, 0, v95
    ds_read_b64 v[100:101], v97
    v_xor_b32_e64 v97, 16, v95
    ds_read_b64 v[102:103], v97
    v_xor_b32_e64 v97, 32, v95
    ds_read_b64 v[104:105], v97
    v_xor_b32_e64 v97, 48, v95
    ds_read_b64 v[106:107], v97
    v_xor_b32_e64 v97, 64, v95
    ds_read_b64 v[108:109], v97
    v_xor_b32 v97, 80, v95
    ds_read_b64 v[110:111], v97
    v_xor_b32 v97, 96, v95
    ds_read_b64 v[112:113], v97
    v_xor_b32 v97, 112, v95
    ds_read_b64 v[114:115], v97
    ds_read_b128 v[148:151], v96 offset:512
    ds_read_b128 v[152:155], v96 offset:544
    ds_read_b128 v[156:159], v96 offset:576
    ds_read_b128 v[160:163], v96 offset:608
    ds_read_b128 v[164:167], v96 offset:640
    ds_read_b128 v[168:171], v96 offset:672
    ds_read_b128 v[172:175], v96 offset:704
    ds_read_b128 v[176:179], v96 offset:736
    s_waitcnt lgkmcnt(7)
    v_mfma_f32_16x16x32_bf16 v[8:11], v[56:59], v[40:43], v[8:11]
    ds_read_b128 v[48:51], v89 offset:2048
    ds_read_b64_tr_b16 v[72:73], v92 offset:8192
    s_waitcnt lgkmcnt(8)
    v_mfma_f32_16x16x32_bf16 v[12:15], v[56:59], v[44:47], v[12:15]
    ds_read_b64_tr_b16 v[74:75], v92 offset:10240
    s_waitcnt lgkmcnt(7)
    v_mfma_f32_16x16x32_bf16 v[16:19], v[60:63], v[40:43], v[16:19]
    ds_read_b128 v[52:55], v89 offset:2304
    v_mfma_f32_16x16x32_bf16 v[20:23], v[60:63], v[44:47], v[20:23]
    ds_read_b64_tr_b16 v[76:77], v93 offset:8192
    s_waitcnt lgkmcnt(7)
    v_mfma_f32_16x16x32_bf16 v[24:27], v[64:67], v[40:43], v[24:27]
    ds_read_b64_tr_b16 v[78:79], v93 offset:10240
    ds_read_b64_tr_b16 v[80:81], v92 offset:8448
    v_mfma_f32_16x16x32_bf16 v[28:31], v[64:67], v[44:47], v[28:31]
    ds_read_b64_tr_b16 v[82:83], v92 offset:10496
    s_waitcnt lgkmcnt(8)
    v_mfma_f32_16x16x32_bf16 v[32:35], v[68:71], v[40:43], v[32:35]
    ds_read_b64_tr_b16 v[84:85], v93 offset:8448
    v_mfma_f32_16x16x32_bf16 v[36:39], v[68:71], v[44:47], v[36:39]
    ds_read_b64_tr_b16 v[86:87], v93 offset:10496
    s_waitcnt lgkmcnt(7)
    v_mfma_f32_16x16x32_bf16 v[8:11], v[72:75], v[48:51], v[8:11]
    s_waitcnt lgkmcnt(6)
    v_mfma_f32_16x16x32_bf16 v[12:15], v[72:75], v[52:55], v[12:15]
    s_waitcnt lgkmcnt(4)
    v_mfma_f32_16x16x32_bf16 v[16:19], v[76:79], v[48:51], v[16:19]
    v_mfma_f32_16x16x32_bf16 v[20:23], v[76:79], v[52:55], v[20:23]
    s_waitcnt lgkmcnt(2)
    v_mfma_f32_16x16x32_bf16 v[24:27], v[80:83], v[48:51], v[24:27]
    v_mfma_f32_16x16x32_bf16 v[28:31], v[80:83], v[52:55], v[28:31]
    s_waitcnt lgkmcnt(0)
    v_mfma_f32_16x16x32_bf16 v[32:35], v[84:87], v[48:51], v[32:35]
    v_mfma_f32_16x16x32_bf16 v[36:39], v[84:87], v[52:55], v[36:39]
    s_nop 7
    v_permlane16_swap_b32 v8, v12
    v_permlane16_swap_b32 v9, v13
    v_permlane16_swap_b32 v10, v14
    v_permlane16_swap_b32 v11, v15
    v_permlane16_swap_b32 v16, v20
    v_permlane16_swap_b32 v17, v21
    v_permlane16_swap_b32 v18, v22
    v_permlane16_swap_b32 v19, v23
    v_permlane16_swap_b32 v24, v28
    v_permlane16_swap_b32 v25, v29
    v_permlane16_swap_b32 v26, v30
    v_permlane16_swap_b32 v27, v31
    v_permlane16_swap_b32 v32, v36
    v_permlane16_swap_b32 v33, v37
    v_permlane16_swap_b32 v34, v38
    v_permlane16_swap_b32 v35, v39
    s_nop 1
    s_waitcnt lgkmcnt(0)
    v_lshlrev_b32 v40, 16, v100
    v_and_b32 v41, 0xffff0000, v100
    v_pk_fma_f32 v[8:9], v[8:9], v[116:117], v[40:41]
    v_lshlrev_b32_e64 v42, 16, v101
    v_and_b32 v43, 0xffff0000, v101
    v_pk_fma_f32 v[10:11], v[10:11], v[118:119], v[42:43]
    v_lshlrev_b32_e64 v44, 16, v102
    v_and_b32 v45, 0xffff0000, v102
    v_pk_fma_f32 v[12:13], v[12:13], v[120:121], v[44:45]
    v_lshlrev_b32_e64 v46, 16, v103
    v_and_b32 v47, 0xffff0000, v103
    v_pk_fma_f32 v[14:15], v[14:15], v[122:123], v[46:47]
    v_lshlrev_b32_e64 v40, 16, v104
    v_and_b32 v41, 0xffff0000, v104
    v_pk_fma_f32 v[16:17], v[16:17], v[124:125], v[40:41]
    v_lshlrev_b32_e64 v42, 16, v105
    v_and_b32 v43, 0xffff0000, v105
    v_pk_fma_f32 v[18:19], v[18:19], v[126:127], v[42:43]
    v_lshlrev_b32_e64 v44, 16, v106
    v_and_b32 v45, 0xffff0000, v106
    v_pk_fma_f32 v[20:21], v[20:21], v[128:129], v[44:45]
    v_lshlrev_b32_e64 v46, 16, v107
    v_and_b32 v47, 0xffff0000, v107
    v_pk_fma_f32 v[22:23], v[22:23], v[130:131], v[46:47]
    s_waitcnt lgkmcnt(0)
    s_nop 0
    v_pk_mul_f32 v[148:149], v[8:9], v[148:149]
    v_pk_mul_f32 v[150:151], v[10:11], v[150:151]
    v_pk_mul_f32 v[152:153], v[12:13], v[152:153]
    v_pk_mul_f32 v[154:155], v[14:15], v[154:155]
    v_pk_mul_f32 v[156:157], v[16:17], v[156:157]
    v_pk_mul_f32 v[158:159], v[18:19], v[158:159]
    v_pk_mul_f32 v[160:161], v[20:21], v[160:161]
    v_pk_mul_f32 v[162:163], v[22:23], v[162:163]
    v_cvt_pk_bf16_f32 v116, v148, v149
    v_cvt_pk_bf16_f32 v117, v150, v151
    v_cvt_pk_bf16_f32 v118, v152, v153
    v_cvt_pk_bf16_f32 v119, v154, v155
    v_cvt_pk_bf16_f32 v120, v156, v157
    v_cvt_pk_bf16_f32 v121, v158, v159
    v_cvt_pk_bf16_f32 v122, v160, v161
    v_cvt_pk_bf16_f32 v123, v162, v163
    buffer_store_dwordx4 v[116:119], v94, s[36:39], s65 offen offset:0 sc1
    buffer_store_dwordx4 v[120:123], v94, s[36:39], s65 offen offset:1024 sc1
    v_lshlrev_b32_e64 v40, 16, v108
    v_and_b32 v41, 0xffff0000, v108
    v_pk_fma_f32 v[24:25], v[24:25], v[132:133], v[40:41]
    v_lshlrev_b32_e64 v42, 16, v109
    v_and_b32 v43, 0xffff0000, v109
    v_pk_fma_f32 v[26:27], v[26:27], v[134:135], v[42:43]
    v_lshlrev_b32_e64 v44, 16, v110
    v_and_b32 v45, 0xffff0000, v110
    v_pk_fma_f32 v[28:29], v[28:29], v[136:137], v[44:45]
    v_lshlrev_b32_e64 v46, 16, v111
    v_and_b32 v47, 0xffff0000, v111
    v_pk_fma_f32 v[30:31], v[30:31], v[138:139], v[46:47]
    v_lshlrev_b32_e64 v40, 16, v112
    v_and_b32 v41, 0xffff0000, v112
    v_pk_fma_f32 v[32:33], v[32:33], v[140:141], v[40:41]
    v_lshlrev_b32_e64 v42, 16, v113
    v_and_b32 v43, 0xffff0000, v113
    v_pk_fma_f32 v[34:35], v[34:35], v[142:143], v[42:43]
    v_lshlrev_b32_e64 v44, 16, v114
    v_and_b32 v45, 0xffff0000, v114
    v_pk_fma_f32 v[36:37], v[36:37], v[144:145], v[44:45]
    v_lshlrev_b32_e64 v46, 16, v115
    v_and_b32 v47, 0xffff0000, v115
    v_pk_fma_f32 v[38:39], v[38:39], v[146:147], v[46:47]
    v_pk_mul_f32 v[164:165], v[24:25], v[164:165]
    v_pk_mul_f32 v[166:167], v[26:27], v[166:167]
    v_pk_mul_f32 v[168:169], v[28:29], v[168:169]
    v_pk_mul_f32 v[170:171], v[30:31], v[170:171]
    v_pk_mul_f32 v[172:173], v[32:33], v[172:173]
    v_pk_mul_f32 v[174:175], v[34:35], v[174:175]
    v_pk_mul_f32 v[176:177], v[36:37], v[176:177]
    v_pk_mul_f32 v[178:179], v[38:39], v[178:179]
    v_cvt_pk_bf16_f32 v132, v164, v165
    v_cvt_pk_bf16_f32 v133, v166, v167
    v_cvt_pk_bf16_f32 v134, v168, v169
    v_cvt_pk_bf16_f32 v135, v170, v171
    v_cvt_pk_bf16_f32 v136, v172, v173
    v_cvt_pk_bf16_f32 v137, v174, v175
    v_cvt_pk_bf16_f32 v138, v176, v177
    v_cvt_pk_bf16_f32 v139, v178, v179
    buffer_store_dwordx4 v[132:135], v94, s[36:39], s65 offen offset:2048 sc1
    buffer_store_dwordx4 v[136:139], v94, s[36:39], s65 offen offset:3072 sc1
    v_pk_add_f32 v[48:49], v[8:9], v[10:11]
    v_pk_mul_f32 v[50:51], v[8:9], v[8:9]
    v_pk_fma_f32 v[50:51], v[10:11], v[10:11], v[50:51]
    v_pk_add_f32 v[48:49], v[48:49], v[12:13]
    v_pk_fma_f32 v[50:51], v[12:13], v[12:13], v[50:51]
    v_pk_add_f32 v[48:49], v[48:49], v[14:15]
    v_pk_fma_f32 v[50:51], v[14:15], v[14:15], v[50:51]
    v_pk_add_f32 v[48:49], v[48:49], v[16:17]
    v_pk_fma_f32 v[50:51], v[16:17], v[16:17], v[50:51]
    v_pk_add_f32 v[48:49], v[48:49], v[18:19]
    v_pk_fma_f32 v[50:51], v[18:19], v[18:19], v[50:51]
    v_pk_add_f32 v[48:49], v[48:49], v[20:21]
    v_pk_fma_f32 v[50:51], v[20:21], v[20:21], v[50:51]
    v_pk_add_f32 v[48:49], v[48:49], v[22:23]
    v_pk_fma_f32 v[50:51], v[22:23], v[22:23], v[50:51]
    v_pk_add_f32 v[48:49], v[48:49], v[24:25]
    v_pk_fma_f32 v[50:51], v[24:25], v[24:25], v[50:51]
    v_pk_add_f32 v[48:49], v[48:49], v[26:27]
    v_pk_fma_f32 v[50:51], v[26:27], v[26:27], v[50:51]
    v_pk_add_f32 v[48:49], v[48:49], v[28:29]
    v_pk_fma_f32 v[50:51], v[28:29], v[28:29], v[50:51]
    v_pk_add_f32 v[48:49], v[48:49], v[30:31]
    v_pk_fma_f32 v[50:51], v[30:31], v[30:31], v[50:51]
    v_pk_add_f32 v[48:49], v[48:49], v[32:33]
    v_pk_fma_f32 v[50:51], v[32:33], v[32:33], v[50:51]
    v_pk_add_f32 v[48:49], v[48:49], v[34:35]
    v_pk_fma_f32 v[50:51], v[34:35], v[34:35], v[50:51]
    v_pk_add_f32 v[48:49], v[48:49], v[36:37]
    v_pk_fma_f32 v[50:51], v[36:37], v[36:37], v[50:51]
    v_pk_add_f32 v[48:49], v[48:49], v[38:39]
    v_pk_fma_f32 v[50:51], v[38:39], v[38:39], v[50:51]
    v_add_f32 v48, v48, v49
    v_add_f32 v49, v50, v51
    v_mov_b32 v50, v48
    v_mov_b32 v51, v49
    s_lshl_b32 s66, s30, 4
    s_lshl_b32 s67, s31, 1
    s_add_u32 s66, s66, s67
    s_add_u32 s66, s66, s51
    s_lshl_b32 s66, s66, 9
    s_lshl_b32 s67, s50, 8
    s_add_u32 s66, s66, s67
    v_lshlrev_b32_e64 v5, 3, v3
    v_permlane32_swap_b32 v48, v50
    v_permlane32_swap_b32 v49, v51
    s_nop 1
    v_pk_add_f32 v[48:49], v[48:49], v[50:51]
    s_mov_b32 exec_hi, 0
    buffer_store_dwordx2 v[48:49], v5, s[32:35], s66 offen sc1
    s_mov_b32 exec_hi, -1
    v_cvt_pk_bf16_f32 v100, v8, v9
    v_cvt_pk_bf16_f32 v101, v10, v11
    v_cvt_pk_bf16_f32 v102, v12, v13
    v_cvt_pk_bf16_f32 v103, v14, v15
    v_cvt_pk_bf16_f32 v104, v16, v17
    v_cvt_pk_bf16_f32 v105, v18, v19
    v_cvt_pk_bf16_f32 v106, v20, v21
    v_cvt_pk_bf16_f32 v107, v22, v23
    v_xor_b32_e64 v97, 0, v95
    ds_write_b64 v97, v[100:101]
    v_xor_b32_e64 v97, 16, v95
    ds_write_b64 v97, v[102:103]
    v_xor_b32_e64 v97, 32, v95
    ds_write_b64 v97, v[104:105]
    v_xor_b32_e64 v97, 48, v95
    ds_write_b64 v97, v[106:107]
    v_cvt_pk_bf16_f32 v108, v24, v25
    v_cvt_pk_bf16_f32 v109, v26, v27
    v_cvt_pk_bf16_f32 v110, v28, v29
    v_cvt_pk_bf16_f32 v111, v30, v31
    v_cvt_pk_bf16_f32 v112, v32, v33
    v_cvt_pk_bf16_f32 v113, v34, v35
    v_cvt_pk_bf16_f32 v114, v36, v37
    v_cvt_pk_bf16_f32 v115, v38, v39
    v_xor_b32_e64 v97, 64, v95
    ds_write_b64 v97, v[108:109]
    v_xor_b32 v97, 80, v95
    ds_write_b64 v97, v[110:111]
    v_xor_b32 v97, 96, v95
    ds_write_b64 v97, v[112:113]
    v_xor_b32 v97, 112, v95
    ds_write_b64 v97, v[114:115]
    s_waitcnt lgkmcnt(0)
    s_add_u32 s96, s28, 0x3a00000
    s_addc_u32 s97, s29, 0
    s_and_b32 s97, s97, 0xffff
    s_mov_b32 s98, 0x200000
    s_mov_b32 s99, 0x20000
    v_mov_b32 v252, s84
    v_mov_b32 v253, s85
    v_mov_b32 v254, 0
    s_and_b32 s100, s3, 3
    s_lshl_b32 s100, s100, 7
    s_add_u32 s100, s100, s87
    s_waitcnt vmcnt(0)
    s_mov_b64 exec, 1
    buffer_store_dwordx2 v[252:253], v254, s[96:99], s100 offen sc1
    s_mov_b64 exec, -1
    s_barrier
    s_mov_b64 exec, -1
    s_setprio 0
    s_branch L_win_entry
L_win_entry:
    v_and_b32 v1, 63, v0
    s_mov_b32 s46, s3
    s_and_b32 s47, s2, 7
    s_lshr_b32 s48, s2, 3
    s_and_b32 s30, s47, 3
    s_lshl_b32 s30, s30, 2
    s_and_b32 s49, s48, 3
    s_add_u32 s30, s30, s49
    s_lshr_b32 s31, s47, 2
    s_mul_i32 s31, s31, 7
    s_lshr_b32 s49, s48, 2
    s_add_u32 s31, s31, s49
    s_lshl_b32 s100, s31, 8
    s_lshl_b32 s101, s30, 4
    s_add_u32 s100, s100, s101
    s_add_u32 s100, s100, 32768
    s_lshl_b32 s87, s100, 5
    s_cmp_ge_u32 s2, 224
    s_cbranch_scc1 L_win_pf
    s_cmp_ge_u32 s46, 4
    s_cbranch_scc1 L_win_comp
    s_mul_i32 s50, s30, 262144
    s_mul_i32 s51, s46, 2
    s_lshr_b32 s52, s51, 1
    s_and_b32 s51, s51, 1
    s_mul_i32 s52, s52, 65536
    s_lshl_b32 s51, s51, 10
    s_add_u32 s50, s50, s52
    s_add_u32 s50, s50, s51
    v_lshl_add_u32 v8, v1, 4, s50
    v_add_u32 v9, 1024, v8
    v_lshrrev_b32_e64 v2, 4, v1
    v_bfe_u32 v3, v1, 2, 2
    v_and_b32 v4, 3, v1
    v_and_b32 v5, 2, v2
    v_xor_b32 v4, v4, v5
    v_lshrrev_b32 v5, 1, v2
    v_lshl_add_u32 v5, v5, 2, v3
    v_mul_u32_u24 v5, 7168, v5
    v_and_b32_e64 v6, 1, v2
    v_lshl_add_u32 v5, v6, 6, v5
    v_lshl_add_u32 v5, v4, 4, v5
    s_mul_i32 s50, s46, 57344
    s_mul_i32 s51, s31, 256
    s_add_u32 s50, s50, s51
    v_add_u32 v5, s50, v5
    v_add_u32 v10, 3584, v5
    v_add_u32_e64 v11, 0, v5
    v_add_u32 v12, 3712, v5
    v_add_u32 v13, 128, v5
    s_mul_i32 s55, s46, 2048
    s_mul_i32 s56, s46, 4096
    s_add_u32 s56, s56, 8192
    s_waitcnt lgkmcnt(0)
    s_mov_b32 s36, s12
    s_and_b32 s37, s13, 0xffff
    s_mov_b32 s38, 0x700000
    s_mov_b32 s39, 0x20000
    s_add_u32 s32, s28, 0x1900000
    s_addc_u32 s33, s29, 0
    s_and_b32 s33, s33, 0xffff
    s_mov_b32 s34, 0x400000
    s_mov_b32 s35, 0x20000
    s_mov_b32 s57, 0
    s_add_u32 m0, s56, 0
    s_nop 0
    buffer_load_dwordx4 v10, s[36:39], s57 offen lds
    s_add_u32 m0, s56, 1024
    s_nop 0
    buffer_load_dwordx4 v11, s[36:39], s57 offen lds
    s_add_u32 m0, s56, 2048
    s_nop 0
    buffer_load_dwordx4 v12, s[36:39], s57 offen lds
    s_add_u32 m0, s56, 3072
    s_nop 0
    buffer_load_dwordx4 v13, s[36:39], s57 offen lds
    s_mov_b32 s57, 229376
    s_add_u32 m0, s56, 24576
    s_nop 0
    buffer_load_dwordx4 v10, s[36:39], s57 offen lds
    s_add_u32 m0, s56, 25600
    s_nop 0
    buffer_load_dwordx4 v11, s[36:39], s57 offen lds
    s_add_u32 m0, s56, 26624
    s_nop 0
    buffer_load_dwordx4 v12, s[36:39], s57 offen lds
    s_add_u32 m0, s56, 27648
    s_nop 0
    buffer_load_dwordx4 v13, s[36:39], s57 offen lds
    s_barrier
    s_mov_b32 s57, 0
    s_add_u32 m0, s55, 0
    s_nop 0
    buffer_load_dwordx4 v8, s[32:35], s57 offen sc1 lds
    s_add_u32 m0, s55, 1024
    s_nop 0
    buffer_load_dwordx4 v9, s[32:35], s57 offen sc1 lds
    s_mov_b32 s57, 2048
    s_add_u32 m0, s55, 24576
    s_nop 0
    buffer_load_dwordx4 v8, s[32:35], s57 offen sc1 lds
    s_add_u32 m0, s55, 25600
    s_nop 0
    buffer_load_dwordx4 v9, s[32:35], s57 offen sc1 lds
    s_waitcnt vmcnt(2)
    s_barrier
    s_mov_b32 s57, 458752
    s_add_u32 m0, s56, 49152
    s_nop 0
    buffer_load_dwordx4 v10, s[36:39], s57 offen lds
    s_add_u32 m0, s56, 50176
    s_nop 0
    buffer_load_dwordx4 v11, s[36:39], s57 offen lds
    s_add_u32 m0, s56, 51200
    s_nop 0
    buffer_load_dwordx4 v12, s[36:39], s57 offen lds
    s_add_u32 m0, s56, 52224
    s_nop 0
    buffer_load_dwordx4 v13, s[36:39], s57 offen lds
    s_mov_b32 s57, 4096
    s_add_u32 m0, s55, 49152
    s_nop 0
    buffer_load_dwordx4 v8, s[32:35], s57 offen sc1 lds
    s_add_u32 m0, s55, 50176
    s_nop 0
    buffer_load_dwordx4 v9, s[32:35], s57 offen sc1 lds
    s_mov_b32 s57, 688128
    s_add_u32 m0, s56, 73728
    s_nop 0
    buffer_load_dwordx4 v10, s[36:39], s57 offen lds
    s_add_u32 m0, s56, 74752
    s_nop 0
    buffer_load_dwordx4 v11, s[36:39], s57 offen lds
    s_add_u32 m0, s56, 75776
    s_nop 0
    buffer_load_dwordx4 v12, s[36:39], s57 offen lds
    s_add_u32 m0, s56, 76800
    s_nop 0
    buffer_load_dwordx4 v13, s[36:39], s57 offen lds
    s_mov_b32 s57, 6144
    s_add_u32 m0, s55, 73728
    s_nop 0
    buffer_load_dwordx4 v8, s[32:35], s57 offen sc1 lds
    s_add_u32 m0, s55, 74752
    s_nop 0
    buffer_load_dwordx4 v9, s[32:35], s57 offen sc1 lds
    s_mov_b32 s57, 917504
    s_add_u32 m0, s56, 98304
    s_nop 0
    buffer_load_dwordx4 v10, s[36:39], s57 offen lds
    s_add_u32 m0, s56, 99328
    s_nop 0
    buffer_load_dwordx4 v11, s[36:39], s57 offen lds
    s_add_u32 m0, s56, 100352
    s_nop 0
    buffer_load_dwordx4 v12, s[36:39], s57 offen lds
    s_add_u32 m0, s56, 101376
    s_nop 0
    buffer_load_dwordx4 v13, s[36:39], s57 offen lds
    s_mov_b32 s57, 8192
    s_add_u32 m0, s55, 98304
    s_nop 0
    buffer_load_dwordx4 v8, s[32:35], s57 offen sc1 lds
    s_add_u32 m0, s55, 99328
    s_nop 0
    buffer_load_dwordx4 v9, s[32:35], s57 offen sc1 lds
    s_waitcnt vmcnt(18)
    s_barrier
    s_waitcnt vmcnt(12)
    s_barrier
    s_mov_b32 s57, 1146880
    s_add_u32 m0, s56, 0
    s_nop 0
    buffer_load_dwordx4 v10, s[36:39], s57 offen lds
    s_add_u32 m0, s56, 1024
    s_nop 0
    buffer_load_dwordx4 v11, s[36:39], s57 offen lds
    s_add_u32 m0, s56, 2048
    s_nop 0
    buffer_load_dwordx4 v12, s[36:39], s57 offen lds
    s_add_u32 m0, s56, 3072
    s_nop 0
    buffer_load_dwordx4 v13, s[36:39], s57 offen lds
    s_mov_b32 s57, 10240
    s_add_u32 m0, s55, 0
    s_nop 0
    buffer_load_dwordx4 v8, s[32:35], s57 offen sc1 lds
    s_add_u32 m0, s55, 1024
    s_nop 0
    buffer_load_dwordx4 v9, s[32:35], s57 offen sc1 lds
    s_waitcnt vmcnt(12)
    s_barrier
    s_mov_b32 s57, 1376256
    s_add_u32 m0, s56, 24576
    s_nop 0
    buffer_load_dwordx4 v10, s[36:39], s57 offen lds
    s_add_u32 m0, s56, 25600
    s_nop 0
    buffer_load_dwordx4 v11, s[36:39], s57 offen lds
    s_add_u32 m0, s56, 26624
    s_nop 0
    buffer_load_dwordx4 v12, s[36:39], s57 offen lds
    s_add_u32 m0, s56, 27648
    s_nop 0
    buffer_load_dwordx4 v13, s[36:39], s57 offen lds
    s_mov_b32 s57, 12288
    s_add_u32 m0, s55, 24576
    s_nop 0
    buffer_load_dwordx4 v8, s[32:35], s57 offen sc1 lds
    s_add_u32 m0, s55, 25600
    s_nop 0
    buffer_load_dwordx4 v9, s[32:35], s57 offen sc1 lds
    s_waitcnt vmcnt(12)
    s_barrier
    s_mov_b32 s57, 1605632
    s_add_u32 m0, s56, 49152
    s_nop 0
    buffer_load_dwordx4 v10, s[36:39], s57 offen lds
    s_add_u32 m0, s56, 50176
    s_nop 0
    buffer_load_dwordx4 v11, s[36:39], s57 offen lds
    s_add_u32 m0, s56, 51200
    s_nop 0
    buffer_load_dwordx4 v12, s[36:39], s57 offen lds
    s_add_u32 m0, s56, 52224
    s_nop 0
    buffer_load_dwordx4 v13, s[36:39], s57 offen lds
    s_mov_b32 s57, 14336
    s_add_u32 m0, s55, 49152
    s_nop 0
    buffer_load_dwordx4 v8, s[32:35], s57 offen sc1 lds
    s_add_u32 m0, s55, 50176
    s_nop 0
    buffer_load_dwordx4 v9, s[32:35], s57 offen sc1 lds
    s_add_u32 s60, s55, 122880
    s_add_u32 s55, s55, 73728
    s_add_u32 s56, s56, 73728
    s_mov_b32 s57, 16384
    s_mov_b32 s58, 1835008
    s_mov_b32 s59, 8
L_win_lloop:
    s_waitcnt vmcnt(12)
    s_barrier
    s_add_u32 m0, s56, 0
    s_nop 0
    buffer_load_dwordx4 v10, s[36:39], s58 offen lds
    s_add_u32 m0, s56, 1024
    s_nop 0
    buffer_load_dwordx4 v11, s[36:39], s58 offen lds
    s_add_u32 m0, s56, 2048
    s_nop 0
    buffer_load_dwordx4 v12, s[36:39], s58 offen lds
    s_add_u32 m0, s56, 3072
    s_nop 0
    buffer_load_dwordx4 v13, s[36:39], s58 offen lds
    s_add_u32 m0, s55, 0
    s_nop 0
    buffer_load_dwordx4 v8, s[32:35], s57 offen sc1 lds
    s_add_u32 m0, s55, 1024
    s_nop 0
    buffer_load_dwordx4 v9, s[32:35], s57 offen sc1 lds
    s_add_u32 s57, s57, 2048
    s_add_u32 s58, s58, 229376
    s_add_u32 s55, s55, 24576
    s_add_u32 s56, s56, 24576
    s_cmp_eq_u32 s55, s60
    s_cselect_b32 s61, 122880, 0
    s_sub_u32 s55, s55, s61
    s_sub_u32 s56, s56, s61
    s_add_u32 s59, s59, 1
    s_cmp_lt_u32 s59, 32
    s_cbranch_scc1 L_win_lloop
    s_add_u32 s40, s28, 0x8000
    s_addc_u32 s41, s29, 0
    s_and_b32 s41, s41, 0xffff
    s_mov_b32 s42, 0x8000
    s_mov_b32 s43, 0x20000
    v_and_b32 v2, 31, v1
    v_lshlrev_b32 v2, 4, v2
    v_add_u32 v3, 7168, v2
    v_cmp_gt_u32 vcc, 32, v1
    s_lshl_b32 s62, s31, 9
    s_add_u32 s63, s62, 16384
    v_cndmask_b32 v2, v2, v3, vcc
    v_lshlrev_b32 v3, 4, v1
    v_add_u32 v3, 151552, v3
    buffer_load_dwordx4 v[24:27], v2, s[40:43], s62 offen sc1
    buffer_load_dwordx4 v[28:31], v2, s[40:43], s63 offen sc1
    s_and_b32 s44, s46, 1
    s_lshl_b32 s44, s44, 13
    s_cmp_ge_u32 s2, 32
    s_cbranch_scc1 L_mp0_ct30
    s_getpc_b64 s[64:65]
L_mp0_pc31:
    s_add_u32 s64, s64, L_win_epi-L_mp0_pc31
    s_addc_u32 s65, s65, 0
    v_and_b32_e64 v60, 63, v0
    v_lshl_add_u32 v60, v60, 7, s44
    v_min_u32 v60, L_text_end-L_win_epi-4, v60
    v_mov_b32 v61, s65
    v_add_co_u32 v60, vcc, s64, v60
    s_nop 1
    v_addc_co_u32 v61, vcc, 0, v61, vcc
    global_load_dword v62, v[60:61], off
L_mp0_ct30:
    s_waitcnt vmcnt(14)
    s_barrier
    s_waitcnt vmcnt(8)
    s_barrier
    s_waitcnt vmcnt(0)
    s_mov_b32 s101, 0x100000
    s_branch L_mp0_uwc33
L_mp0_uwp32:
    buffer_load_dwordx4 v[24:27], v2, s[40:43], s62 offen sc1
    buffer_load_dwordx4 v[28:31], v2, s[40:43], s63 offen sc1
    s_waitcnt vmcnt(0)
L_mp0_uwc33:
    v_max3_u32 v4, v24, v25, v26
    v_max3_u32 v4, v4, v27, v28
    v_max3_u32 v4, v4, v29, v30
    v_max_u32 v4, v4, v31
    v_cmp_eq_u32 vcc, -1, v4
    s_sub_u32 s101, s101, 1
    s_nop 3
    s_cbranch_vccz L_mp0_pd34
    s_cmp_lg_u32 s101, 0
    s_cbranch_scc1 L_mp0_uwp32
L_mp0_pd34:
    ds_write_b128 v3, v[24:27]
    ds_write_b128 v3, v[28:31] offset:1024
    s_waitcnt lgkmcnt(0)
    s_barrier
    s_barrier
    s_add_u32 s36, s28, 0x3900000
    s_addc_u32 s37, s29, 0
    s_and_b32 s37, s37, 0xffff
    s_mov_b32 s38, 0x80000
    s_mov_b32 s39, 0x20000
    s_lshl_b32 s65, s30, 1
    s_lshr_b32 s66, s46, 1
    s_add_u32 s65, s65, s66
    s_lshl_b32 s65, s65, 14
    s_and_b32 s66, s46, 1
    s_lshl_b32 s66, s66, 8
    s_add_u32 s65, s65, s66
    s_add_u32 s66, s65, 3584
    v_and_b32 v2, 31, v1
    v_lshrrev_b32_e64 v3, 5, v1
    v_mul_u32_u24 v3, 7168, v3
    v_lshl_add_u32 v2, v2, 3, v3
    s_lshl_b32 s67, s46, 9
    s_add_u32 s67, s67, 153600
    v_lshl_add_u32 v3, v1, 3, s67
    s_setprio 2
    s_barrier
    s_nop 0
    s_mov_b32 s101, 0x100000
L_mp0_lpoll35:
    buffer_load_dwordx2 v[24:25], v2, s[36:39], s65 offen offset:0 sc1
    buffer_load_dwordx2 v[26:27], v2, s[36:39], s65 offen offset:512 sc1
    buffer_load_dwordx2 v[28:29], v2, s[36:39], s65 offen offset:1024 sc1
    buffer_load_dwordx2 v[30:31], v2, s[36:39], s65 offen offset:1536 sc1
    buffer_load_dwordx2 v[32:33], v2, s[36:39], s65 offen offset:2048 sc1
    buffer_load_dwordx2 v[34:35], v2, s[36:39], s65 offen offset:2560 sc1
    buffer_load_dwordx2 v[36:37], v2, s[36:39], s65 offen offset:3072 sc1
    buffer_load_dwordx2 v[38:39], v2, s[36:39], s66 offen offset:0 sc1
    buffer_load_dwordx2 v[40:41], v2, s[36:39], s66 offen offset:512 sc1
    buffer_load_dwordx2 v[42:43], v2, s[36:39], s66 offen offset:1024 sc1
    buffer_load_dwordx2 v[44:45], v2, s[36:39], s66 offen offset:1536 sc1
    buffer_load_dwordx2 v[46:47], v2, s[36:39], s66 offen offset:2048 sc1
    buffer_load_dwordx2 v[48:49], v2, s[36:39], s66 offen offset:2560 sc1
    buffer_load_dwordx2 v[50:51], v2, s[36:39], s66 offen offset:3072 sc1
    s_waitcnt vmcnt(0)
    v_max_u32 v5, v24, v25
    v_max3_u32 v5, v5, v26, v27
    v_max3_u32 v5, v5, v28, v29
    v_max3_u32 v5, v5, v30, v31
    v_max3_u32 v5, v5, v32, v33
    v_max3_u32 v5, v5, v34, v35
    v_max3_u32 v5, v5, v36, v37
    v_max3_u32 v5, v5, v38, v39
    v_max3_u32 v5, v5, v40, v41
    v_max3_u32 v5, v5, v42, v43
    v_max3_u32 v5, v5, v44, v45
    v_max3_u32 v5, v5, v46, v47
    v_max3_u32 v5, v5, v48, v49
    v_max3_u32 v5, v5, v50, v51
    v_cmp_eq_u32 vcc, -1, v5
    s_sub_u32 s101, s101, 1
    s_nop 3
    s_cbranch_vccz L_mp0_pd36
    s_cmp_lg_u32 s101, 0
    s_cbranch_scc1 L_mp0_lpoll35
L_mp0_pd36:
    v_pk_add_f32 v[24:25], v[24:25], v[26:27]
    v_pk_add_f32 v[24:25], v[24:25], v[28:29]
    v_pk_add_f32 v[24:25], v[24:25], v[30:31]
    v_pk_add_f32 v[24:25], v[24:25], v[32:33]
    v_pk_add_f32 v[24:25], v[24:25], v[34:35]
    v_pk_add_f32 v[24:25], v[24:25], v[36:37]
    v_pk_add_f32 v[24:25], v[24:25], v[38:39]
    v_pk_add_f32 v[24:25], v[24:25], v[40:41]
    v_pk_add_f32 v[24:25], v[24:25], v[42:43]
    v_pk_add_f32 v[24:25], v[24:25], v[44:45]
    v_pk_add_f32 v[24:25], v[24:25], v[46:47]
    v_pk_add_f32 v[24:25], v[24:25], v[48:49]
    v_pk_add_f32 v[24:25], v[24:25], v[50:51]
    v_mov_b32 v26, v24
    v_mov_b32 v27, v25
    s_nop 1
    v_permlane32_swap_b32 v24, v26
    v_permlane32_swap_b32 v25, v27
    s_nop 1
    v_pk_add_f32 v[24:25], v[24:25], v[26:27]
    v_mul_f32 v24, 0x3a124925, v24
    v_mul_f32_e64 v26, v24, v24
    v_mov_b32 v27, 0x3a124925
    v_fma_f32 v25, v25, v27, -v26
    v_max_f32_e64 v25, 0, v25
    v_add_f32 v25, 0x3727c5ac, v25
    v_rsq_f32 v56, v25
    s_nop 0
    v_mul_f32_e64 v57, -v24, v56
    ds_write_b64 v3, v[56:57]
    s_waitcnt lgkmcnt(0)
    s_barrier
    s_barrier
    s_waitcnt vmcnt(0)
    s_mov_b64 exec, -1
    s_setprio 0
    s_branch L_wsp_entry
L_win_comp:
    s_setprio 1
    s_sub_u32 s46, s46, 4
    s_lshr_b32 s50, s46, 1
    s_and_b32 s51, s46, 1
    v_and_b32 v3, 31, v1
    v_lshrrev_b32 v4, 5, v1
    v_and_b32 v5, 15, v1
    v_lshrrev_b32_e64 v6, 4, v1
    s_mul_i32 s52, s50, 4096
    v_lshl_add_u32 v7, v5, 4, s52
    v_lshl_add_u32 v208, v6, 9, v7
    v_mul_u32_u24 v5, 8192, v4
    v_and_b32_e64 v6, 1, v6
    v_lshl_add_u32 v5, v6, 9, v5
    v_lshl_add_u32 v5, v6, 5, v5
    v_bfe_u32 v6, v1, 2, 2
    v_lshl_add_u32 v5, v6, 6, v5
    v_bfe_u32 v6, v1, 1, 1
    v_lshl_add_u32 v5, v6, 3, v5
    v_and_b32_e64 v6, 1, v1
    v_lshl_add_u32 v5, v6, 4, v5
    s_mul_i32 s52, s51, 2048
    s_add_u32 s52, s52, 8192
    v_add_u32 v210, s52, v5
    v_xor_b32_e64 v211, 32, v210
    s_waitcnt lgkmcnt(0)
    s_add_u32 s32, s28, 0x2400000
    s_addc_u32 s33, s29, 0
    s_and_b32 s33, s33, 0xffff
    s_mov_b32 s34, 0x700000
    s_mov_b32 s35, 0x20000
    s_add_u32 s36, s28, 0x40000
    s_addc_u32 s37, s29, 0
    s_and_b32 s37, s37, 0xffff
    s_mov_b32 s38, 0x40000
    s_mov_b32 s39, 0x20000
    s_add_u32 s40, s28, 0x3900000
    s_addc_u32 s41, s29, 0
    s_and_b32 s41, s41, 0xffff
    s_mov_b32 s42, 0x80000
    s_mov_b32 s43, 0x20000
    v_lshlrev_b32 v214, 4, v1
    v_lshlrev_b32 v215, 3, v1
    s_lshl_b32 s61, s30, 1
    s_add_u32 s61, s61, s50
    s_lshl_b32 s64, s61, 13
    s_add_u32 s65, s64, 4096
    s_lshl_b32 s66, s31, 1
    s_add_u32 s66, s66, s51
    s_lshl_b32 s66, s66, 9
    s_lshl_b32 s67, s61, 14
    s_add_u32 s66, s66, s67
    s_mul_i32 s60, s61, 229376
    s_lshl_b32 s61, s31, 13
    s_add_u32 s60, s60, s61
    s_lshl_b32 s61, s51, 12
    s_add_u32 s60, s60, s61
    s_add_u32 s61, s60, 114688
    s_lshl_b32 s67, s51, 8
    s_add_u32 s67, s67, 151552
    v_lshl_add_u32 v216, v4, 4, s67
    s_mov_b32 s53, 0
    v_add_u32 v209, s53, v208
    v_add_u32 v212, s53, v210
    v_add_u32 v213, s53, v211
    s_cmp_lg_u32 s3, 4
    s_cbranch_scc1 L_mp0_wd37
    s_add_u32 s96, s28, 0x3a00000
    s_addc_u32 s97, s29, 0
    s_and_b32 s97, s97, 0xffff
    s_mov_b32 s98, 0x200000
    s_mov_b32 s99, 0x20000
    s_lshl_b32 s100, s30, 8
    s_add_u32 s100, s100, 24576
    s_lshl_b32 s100, s100, 5
    v_lshlrev_b32 v254, 7, v1
    s_mov_b32 s101, 0x100000
L_mp0_wf38:
    buffer_load_dwordx2 v[252:253], v254, s[96:99], s100 offen sc1
    s_waitcnt vmcnt(0)
    v_cmp_ne_u64 vcc, s[84:85], v[252:253]
    s_sub_u32 s101, s101, 1
    s_nop 3
    s_cbranch_vccz L_mp0_we39
    s_mov_b64 exec, vcc
    s_sleep 1
    s_cmp_lg_u32 s101, 0
    s_cbranch_scc1 L_mp0_wf38
L_mp0_we39:
    s_mov_b64 exec, -1
L_mp0_wd37:
    s_barrier
    s_mov_b32 s80, s16
    s_and_b32 s81, s17, 0xffff
    s_mov_b32 s82, 0x1000
    s_mov_b32 s83, 0x20000
    s_lshr_b32 s67, s64, 6
    v_and_b32 v5, 15, v1
    v_lshlrev_b32_e64 v5, 1, v5
    buffer_load_ushort v244, v5, s[80:83], s67 offen offset:0
    buffer_load_ushort v245, v5, s[80:83], s67 offen offset:32
    buffer_load_ushort v246, v5, s[80:83], s67 offen offset:64
    buffer_load_ushort v247, v5, s[80:83], s67 offen offset:96
    buffer_load_dwordx2 v[136:137], v215, s[36:39], s64 offen offset:0 sc1
    buffer_load_dwordx2 v[138:139], v215, s[36:39], s64 offen offset:512 sc1
    buffer_load_dwordx2 v[140:141], v215, s[36:39], s64 offen offset:1024 sc1
    buffer_load_dwordx2 v[142:143], v215, s[36:39], s64 offen offset:1536 sc1
    buffer_load_dwordx2 v[144:145], v215, s[36:39], s64 offen offset:2048 sc1
    buffer_load_dwordx2 v[146:147], v215, s[36:39], s64 offen offset:2560 sc1
    buffer_load_dwordx2 v[148:149], v215, s[36:39], s64 offen offset:3072 sc1
    buffer_load_dwordx2 v[150:151], v215, s[36:39], s64 offen offset:3584 sc1
    buffer_load_dwordx2 v[152:153], v215, s[36:39], s65 offen offset:0 sc1
    buffer_load_dwordx2 v[154:155], v215, s[36:39], s65 offen offset:512 sc1
    buffer_load_dwordx2 v[156:157], v215, s[36:39], s65 offen offset:1024 sc1
    buffer_load_dwordx2 v[158:159], v215, s[36:39], s65 offen offset:1536 sc1
    buffer_load_dwordx2 v[160:161], v215, s[36:39], s65 offen offset:2048 sc1
    buffer_load_dwordx2 v[162:163], v215, s[36:39], s65 offen offset:2560 sc1
    buffer_load_dwordx2 v[164:165], v215, s[36:39], s65 offen offset:3072 sc1
    buffer_load_dwordx2 v[166:167], v215, s[36:39], s65 offen offset:3584 sc1
    s_waitcnt vmcnt(0)
    s_nop 0
    v_pk_add_f32 v[136:137], v[136:137], v[138:139]
    v_pk_add_f32 v[136:137], v[136:137], v[140:141]
    v_pk_add_f32 v[136:137], v[136:137], v[142:143]
    v_pk_add_f32 v[136:137], v[136:137], v[144:145]
    v_pk_add_f32 v[136:137], v[136:137], v[146:147]
    v_pk_add_f32 v[136:137], v[136:137], v[148:149]
    v_pk_add_f32 v[136:137], v[136:137], v[150:151]
    v_pk_add_f32 v[136:137], v[136:137], v[152:153]
    v_pk_add_f32 v[136:137], v[136:137], v[154:155]
    v_pk_add_f32 v[136:137], v[136:137], v[156:157]
    v_pk_add_f32 v[136:137], v[136:137], v[158:159]
    v_pk_add_f32 v[136:137], v[136:137], v[160:161]
    v_pk_add_f32 v[136:137], v[136:137], v[162:163]
    v_pk_add_f32 v[136:137], v[136:137], v[164:165]
    v_pk_add_f32 v[136:137], v[136:137], v[166:167]
    v_mul_f32 v136, 0x3a800000, v136
    v_mul_f32_e64 v138, v136, v136
    v_mov_b32 v139, 0x3a800000
    v_fma_f32 v137, v137, v139, -v138
    v_max_f32_e64 v137, 0, v137
    v_add_f32 v137, 0x3727c5ac, v137
    v_rsq_f32 v220, v137
    s_nop 0
    v_mul_f32_e64 v224, -v136, v220
    v_mov_b32 v222, v220
    v_mov_b32 v226, v224
    s_nop 1
    v_permlane32_swap_b32 v220, v222
    v_permlane32_swap_b32 v224, v226
    s_barrier
    ds_read_b128 v[136:139], v209 offset:0
    ds_read_b64_tr_b16 v[168:169], v212 offset:0
    ds_read_b64_tr_b16 v[170:171], v212 offset:4096
    ds_read_b128 v[140:143], v209 offset:256
    ds_read_b128 v[144:147], v209 offset:2048
    ds_read_b128 v[148:151], v209 offset:2304
    ds_read_b64_tr_b16 v[172:173], v213 offset:0
    ds_read_b64_tr_b16 v[174:175], v213 offset:4096
    ds_read_b64_tr_b16 v[176:177], v212 offset:256
    ds_read_b64_tr_b16 v[178:179], v212 offset:4352
    ds_read_b64_tr_b16 v[180:181], v213 offset:256
    ds_read_b64_tr_b16 v[182:183], v213 offset:4352
    s_waitcnt lgkmcnt(9)
    v_mfma_f32_16x16x32_bf16 v[8:11], v[168:171], v[136:139], 0
    ds_read_b64_tr_b16 v[184:185], v212 offset:1024
    s_waitcnt lgkmcnt(9)
    v_mfma_f32_16x16x32_bf16 v[12:15], v[168:171], v[140:143], 0
    ds_read_b64_tr_b16 v[186:187], v212 offset:5120
    s_waitcnt lgkmcnt(9)
    v_mfma_f32_16x16x32_bf16 v[40:43], v[168:171], v[144:147], 0
    s_waitcnt lgkmcnt(8)
    v_mfma_f32_16x16x32_bf16 v[44:47], v[168:171], v[148:151], 0
    ds_read_b64_tr_b16 v[188:189], v213 offset:1024
    s_waitcnt lgkmcnt(7)
    v_mfma_f32_16x16x32_bf16 v[16:19], v[172:175], v[136:139], 0
    ds_read_b64_tr_b16 v[190:191], v213 offset:5120
    v_mfma_f32_16x16x32_bf16 v[20:23], v[172:175], v[140:143], 0
    v_mfma_f32_16x16x32_bf16 v[48:51], v[172:175], v[144:147], 0
    ds_read_b64_tr_b16 v[192:193], v212 offset:1280
    v_mfma_f32_16x16x32_bf16 v[52:55], v[172:175], v[148:151], 0
    ds_read_b64_tr_b16 v[194:195], v212 offset:5376
    s_waitcnt lgkmcnt(8)
    v_mfma_f32_16x16x32_bf16 v[24:27], v[176:179], v[136:139], 0
    v_mfma_f32_16x16x32_bf16 v[28:31], v[176:179], v[140:143], 0
    ds_read_b64_tr_b16 v[196:197], v213 offset:1280
    v_mfma_f32_16x16x32_bf16 v[56:59], v[176:179], v[144:147], 0
    ds_read_b64_tr_b16 v[198:199], v213 offset:5376
    v_mfma_f32_16x16x32_bf16 v[60:63], v[176:179], v[148:151], 0
    s_add_u32 s53, s53, 24576
    s_cmp_eq_u32 s53, 122880
    s_waitcnt lgkmcnt(8)
    v_mfma_f32_16x16x32_bf16 v[32:35], v[180:183], v[136:139], 0
    s_cselect_b32 s53, 0, s53
    v_add_u32_e64 v209, s53, v208
    v_mfma_f32_16x16x32_bf16 v[36:39], v[180:183], v[140:143], 0
    v_add_u32 v212, s53, v210
    v_add_u32 v213, s53, v211
    v_mfma_f32_16x16x32_bf16 v[64:67], v[180:183], v[144:147], 0
    v_mfma_f32_16x16x32_bf16 v[68:71], v[180:183], v[148:151], 0
    s_barrier
    s_waitcnt lgkmcnt(6)
    v_mfma_f32_16x16x32_bf16 v[72:75], v[184:187], v[136:139], 0
    ds_read_b128 v[152:155], v209 offset:0
    v_mfma_f32_16x16x32_bf16 v[76:79], v[184:187], v[140:143], 0
    ds_read_b64_tr_b16 v[168:169], v212 offset:0
    v_mfma_f32_16x16x32_bf16 v[104:107], v[184:187], v[144:147], 0
    ds_read_b64_tr_b16 v[170:171], v212 offset:4096
    v_mfma_f32_16x16x32_bf16 v[108:111], v[184:187], v[148:151], 0
    s_waitcnt lgkmcnt(7)
    v_mfma_f32_16x16x32_bf16 v[80:83], v[188:191], v[136:139], 0
    ds_read_b128 v[156:159], v209 offset:256
    v_mfma_f32_16x16x32_bf16 v[84:87], v[188:191], v[140:143], 0
    ds_read_b128 v[160:163], v209 offset:2048
    v_mfma_f32_16x16x32_bf16 v[112:115], v[188:191], v[144:147], 0
    ds_read_b128 v[164:167], v209 offset:2304
    v_mfma_f32_16x16x32_bf16 v[116:119], v[188:191], v[148:151], 0
    s_waitcnt lgkmcnt(8)
    v_mfma_f32_16x16x32_bf16 v[88:91], v[192:195], v[136:139], 0
    ds_read_b64_tr_b16 v[172:173], v213 offset:0
    v_mfma_f32_16x16x32_bf16 v[92:95], v[192:195], v[140:143], 0
    ds_read_b64_tr_b16 v[174:175], v213 offset:4096
    v_mfma_f32_16x16x32_bf16 v[120:123], v[192:195], v[144:147], 0
    ds_read_b64_tr_b16 v[176:177], v212 offset:256
    v_mfma_f32_16x16x32_bf16 v[124:127], v[192:195], v[148:151], 0
    s_waitcnt lgkmcnt(9)
    v_mfma_f32_16x16x32_bf16 v[96:99], v[196:199], v[136:139], 0
    ds_read_b64_tr_b16 v[178:179], v212 offset:4352
    v_mfma_f32_16x16x32_bf16 v[100:103], v[196:199], v[140:143], 0
    ds_read_b64_tr_b16 v[180:181], v213 offset:256
    v_mfma_f32_16x16x32_bf16 v[128:131], v[196:199], v[144:147], 0
    ds_read_b64_tr_b16 v[182:183], v213 offset:4352
    v_mfma_f32_16x16x32_bf16 v[132:135], v[196:199], v[148:151], 0
    s_mov_b32 s54, 14
L_win_loop:
    s_waitcnt lgkmcnt(9)
    v_mfma_f32_16x16x32_bf16 v[8:11], v[168:171], v[152:155], v[8:11]
    ds_read_b64_tr_b16 v[184:185], v212 offset:1024
    s_waitcnt lgkmcnt(9)
    v_mfma_f32_16x16x32_bf16 v[12:15], v[168:171], v[156:159], v[12:15]
    ds_read_b64_tr_b16 v[186:187], v212 offset:5120
    s_waitcnt lgkmcnt(9)
    v_mfma_f32_16x16x32_bf16 v[40:43], v[168:171], v[160:163], v[40:43]
    s_waitcnt lgkmcnt(8)
    v_mfma_f32_16x16x32_bf16 v[44:47], v[168:171], v[164:167], v[44:47]
    ds_read_b64_tr_b16 v[188:189], v213 offset:1024
    s_waitcnt lgkmcnt(7)
    v_mfma_f32_16x16x32_bf16 v[16:19], v[172:175], v[152:155], v[16:19]
    ds_read_b64_tr_b16 v[190:191], v213 offset:5120
    v_mfma_f32_16x16x32_bf16 v[20:23], v[172:175], v[156:159], v[20:23]
    v_mfma_f32_16x16x32_bf16 v[48:51], v[172:175], v[160:163], v[48:51]
    ds_read_b64_tr_b16 v[192:193], v212 offset:1280
    v_mfma_f32_16x16x32_bf16 v[52:55], v[172:175], v[164:167], v[52:55]
    ds_read_b64_tr_b16 v[194:195], v212 offset:5376
    s_waitcnt lgkmcnt(8)
    v_mfma_f32_16x16x32_bf16 v[24:27], v[176:179], v[152:155], v[24:27]
    v_mfma_f32_16x16x32_bf16 v[28:31], v[176:179], v[156:159], v[28:31]
    ds_read_b64_tr_b16 v[196:197], v213 offset:1280
    v_mfma_f32_16x16x32_bf16 v[56:59], v[176:179], v[160:163], v[56:59]
    ds_read_b64_tr_b16 v[198:199], v213 offset:5376
    v_mfma_f32_16x16x32_bf16 v[60:63], v[176:179], v[164:167], v[60:63]
    s_add_u32 s53, s53, 24576
    s_cmp_eq_u32 s53, 122880
    s_waitcnt lgkmcnt(8)
    v_mfma_f32_16x16x32_bf16 v[32:35], v[180:183], v[152:155], v[32:35]
    s_cselect_b32 s53, 0, s53
    v_add_u32_e64 v209, s53, v208
    v_mfma_f32_16x16x32_bf16 v[36:39], v[180:183], v[156:159], v[36:39]
    v_add_u32 v212, s53, v210
    v_add_u32 v213, s53, v211
    v_mfma_f32_16x16x32_bf16 v[64:67], v[180:183], v[160:163], v[64:67]
    v_mfma_f32_16x16x32_bf16 v[68:71], v[180:183], v[164:167], v[68:71]
    s_barrier
    s_waitcnt lgkmcnt(6)
    v_mfma_f32_16x16x32_bf16 v[72:75], v[184:187], v[152:155], v[72:75]
    ds_read_b128 v[136:139], v209 offset:0
    v_mfma_f32_16x16x32_bf16 v[76:79], v[184:187], v[156:159], v[76:79]
    ds_read_b64_tr_b16 v[168:169], v212 offset:0
    v_mfma_f32_16x16x32_bf16 v[104:107], v[184:187], v[160:163], v[104:107]
    ds_read_b64_tr_b16 v[170:171], v212 offset:4096
    v_mfma_f32_16x16x32_bf16 v[108:111], v[184:187], v[164:167], v[108:111]
    s_waitcnt lgkmcnt(7)
    v_mfma_f32_16x16x32_bf16 v[80:83], v[188:191], v[152:155], v[80:83]
    ds_read_b128 v[140:143], v209 offset:256
    v_mfma_f32_16x16x32_bf16 v[84:87], v[188:191], v[156:159], v[84:87]
    ds_read_b128 v[144:147], v209 offset:2048
    v_mfma_f32_16x16x32_bf16 v[112:115], v[188:191], v[160:163], v[112:115]
    ds_read_b128 v[148:151], v209 offset:2304
    v_mfma_f32_16x16x32_bf16 v[116:119], v[188:191], v[164:167], v[116:119]
    s_waitcnt lgkmcnt(8)
    v_mfma_f32_16x16x32_bf16 v[88:91], v[192:195], v[152:155], v[88:91]
    ds_read_b64_tr_b16 v[172:173], v213 offset:0
    v_mfma_f32_16x16x32_bf16 v[92:95], v[192:195], v[156:159], v[92:95]
    ds_read_b64_tr_b16 v[174:175], v213 offset:4096
    v_mfma_f32_16x16x32_bf16 v[120:123], v[192:195], v[160:163], v[120:123]
    ds_read_b64_tr_b16 v[176:177], v212 offset:256
    v_mfma_f32_16x16x32_bf16 v[124:127], v[192:195], v[164:167], v[124:127]
    s_waitcnt lgkmcnt(9)
    v_mfma_f32_16x16x32_bf16 v[96:99], v[196:199], v[152:155], v[96:99]
    ds_read_b64_tr_b16 v[178:179], v212 offset:4352
    v_mfma_f32_16x16x32_bf16 v[100:103], v[196:199], v[156:159], v[100:103]
    ds_read_b64_tr_b16 v[180:181], v213 offset:256
    v_mfma_f32_16x16x32_bf16 v[128:131], v[196:199], v[160:163], v[128:131]
    ds_read_b64_tr_b16 v[182:183], v213 offset:4352
    v_mfma_f32_16x16x32_bf16 v[132:135], v[196:199], v[164:167], v[132:135]
    s_waitcnt lgkmcnt(9)
    v_mfma_f32_16x16x32_bf16 v[8:11], v[168:171], v[136:139], v[8:11]
    ds_read_b64_tr_b16 v[184:185], v212 offset:1024
    s_waitcnt lgkmcnt(9)
    v_mfma_f32_16x16x32_bf16 v[12:15], v[168:171], v[140:143], v[12:15]
    ds_read_b64_tr_b16 v[186:187], v212 offset:5120
    s_waitcnt lgkmcnt(9)
    v_mfma_f32_16x16x32_bf16 v[40:43], v[168:171], v[144:147], v[40:43]
    s_waitcnt lgkmcnt(8)
    v_mfma_f32_16x16x32_bf16 v[44:47], v[168:171], v[148:151], v[44:47]
    ds_read_b64_tr_b16 v[188:189], v213 offset:1024
    s_waitcnt lgkmcnt(7)
    v_mfma_f32_16x16x32_bf16 v[16:19], v[172:175], v[136:139], v[16:19]
    ds_read_b64_tr_b16 v[190:191], v213 offset:5120
    v_mfma_f32_16x16x32_bf16 v[20:23], v[172:175], v[140:143], v[20:23]
    v_mfma_f32_16x16x32_bf16 v[48:51], v[172:175], v[144:147], v[48:51]
    ds_read_b64_tr_b16 v[192:193], v212 offset:1280
    v_mfma_f32_16x16x32_bf16 v[52:55], v[172:175], v[148:151], v[52:55]
    ds_read_b64_tr_b16 v[194:195], v212 offset:5376
    s_waitcnt lgkmcnt(8)
    s_nop 0
    v_mfma_f32_16x16x32_bf16 v[24:27], v[176:179], v[136:139], v[24:27]
    v_mfma_f32_16x16x32_bf16 v[28:31], v[176:179], v[140:143], v[28:31]
    ds_read_b64_tr_b16 v[196:197], v213 offset:1280
    v_mfma_f32_16x16x32_bf16 v[56:59], v[176:179], v[144:147], v[56:59]
    ds_read_b64_tr_b16 v[198:199], v213 offset:5376
    v_mfma_f32_16x16x32_bf16 v[60:63], v[176:179], v[148:151], v[60:63]
    s_add_u32 s53, s53, 24576
    s_cmp_eq_u32 s53, 122880
    s_waitcnt lgkmcnt(8)
    v_mfma_f32_16x16x32_bf16 v[32:35], v[180:183], v[136:139], v[32:35]
    s_cselect_b32 s53, 0, s53
    v_add_u32_e64 v209, s53, v208
    v_mfma_f32_16x16x32_bf16 v[36:39], v[180:183], v[140:143], v[36:39]
    v_add_u32 v212, s53, v210
    v_add_u32 v213, s53, v211
    v_mfma_f32_16x16x32_bf16 v[64:67], v[180:183], v[144:147], v[64:67]
    v_mfma_f32_16x16x32_bf16 v[68:71], v[180:183], v[148:151], v[68:71]
    s_barrier
    s_waitcnt lgkmcnt(6)
    v_mfma_f32_16x16x32_bf16 v[72:75], v[184:187], v[136:139], v[72:75]
    ds_read_b128 v[152:155], v209 offset:0
    v_mfma_f32_16x16x32_bf16 v[76:79], v[184:187], v[140:143], v[76:79]
    ds_read_b64_tr_b16 v[168:169], v212 offset:0
    v_mfma_f32_16x16x32_bf16 v[104:107], v[184:187], v[144:147], v[104:107]
    ds_read_b64_tr_b16 v[170:171], v212 offset:4096
    v_mfma_f32_16x16x32_bf16 v[108:111], v[184:187], v[148:151], v[108:111]
    ds_read_b128 v[156:159], v209 offset:256
    s_waitcnt lgkmcnt(8)
    v_mfma_f32_16x16x32_bf16 v[80:83], v[188:191], v[136:139], v[80:83]
    ds_read_b128 v[160:163], v209 offset:2048
    v_mfma_f32_16x16x32_bf16 v[84:87], v[188:191], v[140:143], v[84:87]
    ds_read_b128 v[164:167], v209 offset:2304
    v_mfma_f32_16x16x32_bf16 v[112:115], v[188:191], v[144:147], v[112:115]
    v_mfma_f32_16x16x32_bf16 v[116:119], v[188:191], v[148:151], v[116:119]
    ds_read_b64_tr_b16 v[172:173], v213 offset:0
    s_waitcnt lgkmcnt(9)
    v_mfma_f32_16x16x32_bf16 v[88:91], v[192:195], v[136:139], v[88:91]
    ds_read_b64_tr_b16 v[174:175], v213 offset:4096
    v_mfma_f32_16x16x32_bf16 v[92:95], v[192:195], v[140:143], v[92:95]
    ds_read_b64_tr_b16 v[176:177], v212 offset:256
    v_mfma_f32_16x16x32_bf16 v[120:123], v[192:195], v[144:147], v[120:123]
    ds_read_b64_tr_b16 v[178:179], v212 offset:4352
    v_mfma_f32_16x16x32_bf16 v[124:127], v[192:195], v[148:151], v[124:127]
    ds_read_b64_tr_b16 v[180:181], v213 offset:256
    s_waitcnt lgkmcnt(9)
    v_mfma_f32_16x16x32_bf16 v[96:99], v[196:199], v[136:139], v[96:99]
    ds_read_b64_tr_b16 v[182:183], v213 offset:4352
    v_mfma_f32_16x16x32_bf16 v[100:103], v[196:199], v[140:143], v[100:103]
    s_sub_u32 s54, s54, 1
    s_cmp_lg_u32 s54, 0
    v_mfma_f32_16x16x32_bf16 v[128:131], v[196:199], v[144:147], v[128:131]
    v_mfma_f32_16x16x32_bf16 v[132:135], v[196:199], v[148:151], v[132:135]
    s_cbranch_scc1 L_win_loop
L_win_epi:
    v_add_u32 v209, 0, v208
    v_add_u32 v212, 0, v210
    v_add_u32_e64 v213, 0, v211
    s_barrier
    s_waitcnt lgkmcnt(9)
    v_mfma_f32_16x16x32_bf16 v[8:11], v[168:171], v[152:155], v[8:11]
    ds_read_b128 v[136:139], v209 offset:0
    s_waitcnt lgkmcnt(9)
    v_mfma_f32_16x16x32_bf16 v[12:15], v[168:171], v[156:159], v[12:15]
    ds_read_b64_tr_b16 v[184:185], v212 offset:0
    s_waitcnt lgkmcnt(9)
    v_mfma_f32_16x16x32_bf16 v[40:43], v[168:171], v[160:163], v[40:43]
    ds_read_b64_tr_b16 v[186:187], v212 offset:4096
    s_waitcnt lgkmcnt(9)
    v_mfma_f32_16x16x32_bf16 v[44:47], v[168:171], v[164:167], v[44:47]
    s_waitcnt lgkmcnt(7)
    v_mfma_f32_16x16x32_bf16 v[16:19], v[172:175], v[152:155], v[16:19]
    ds_read_b128 v[140:143], v209 offset:256
    v_mfma_f32_16x16x32_bf16 v[20:23], v[172:175], v[156:159], v[20:23]
    ds_read_b128 v[144:147], v209 offset:2048
    v_mfma_f32_16x16x32_bf16 v[48:51], v[172:175], v[160:163], v[48:51]
    ds_read_b128 v[148:151], v209 offset:2304
    v_mfma_f32_16x16x32_bf16 v[52:55], v[172:175], v[164:167], v[52:55]
    s_waitcnt lgkmcnt(8)
    v_mfma_f32_16x16x32_bf16 v[24:27], v[176:179], v[152:155], v[24:27]
    ds_read_b64_tr_b16 v[188:189], v213 offset:0
    v_mfma_f32_16x16x32_bf16 v[28:31], v[176:179], v[156:159], v[28:31]
    ds_read_b64_tr_b16 v[190:191], v213 offset:4096
    v_mfma_f32_16x16x32_bf16 v[56:59], v[176:179], v[160:163], v[56:59]
    ds_read_b64_tr_b16 v[192:193], v212 offset:256
    v_mfma_f32_16x16x32_bf16 v[60:63], v[176:179], v[164:167], v[60:63]
    s_waitcnt lgkmcnt(9)
    v_mfma_f32_16x16x32_bf16 v[32:35], v[180:183], v[152:155], v[32:35]
    ds_read_b64_tr_b16 v[194:195], v212 offset:4352
    v_mfma_f32_16x16x32_bf16 v[36:39], v[180:183], v[156:159], v[36:39]
    ds_read_b64_tr_b16 v[196:197], v213 offset:256
    v_mfma_f32_16x16x32_bf16 v[64:67], v[180:183], v[160:163], v[64:67]
    ds_read_b64_tr_b16 v[198:199], v213 offset:4352
    v_mfma_f32_16x16x32_bf16 v[68:71], v[180:183], v[164:167], v[68:71]
    v_add_u32 v209, 24576, v208
    v_add_u32 v212, 24576, v210
    v_add_u32 v213, 24576, v211
    s_barrier
    s_waitcnt lgkmcnt(9)
    v_mfma_f32_16x16x32_bf16 v[8:11], v[184:187], v[136:139], v[8:11]
    ds_read_b128 v[152:155], v209 offset:0
    s_waitcnt lgkmcnt(9)
    v_mfma_f32_16x16x32_bf16 v[12:15], v[184:187], v[140:143], v[12:15]
    ds_read_b64_tr_b16 v[168:169], v212 offset:0
    s_waitcnt lgkmcnt(9)
    v_mfma_f32_16x16x32_bf16 v[40:43], v[184:187], v[144:147], v[40:43]
    ds_read_b64_tr_b16 v[170:171], v212 offset:4096
    s_waitcnt lgkmcnt(9)
    v_mfma_f32_16x16x32_bf16 v[44:47], v[184:187], v[148:151], v[44:47]
    s_waitcnt lgkmcnt(7)
    v_mfma_f32_16x16x32_bf16 v[16:19], v[188:191], v[136:139], v[16:19]
    ds_read_b128 v[156:159], v209 offset:256
    v_mfma_f32_16x16x32_bf16 v[20:23], v[188:191], v[140:143], v[20:23]
    ds_read_b128 v[160:163], v209 offset:2048
    v_mfma_f32_16x16x32_bf16 v[48:51], v[188:191], v[144:147], v[48:51]
    ds_read_b128 v[164:167], v209 offset:2304
    v_mfma_f32_16x16x32_bf16 v[52:55], v[188:191], v[148:151], v[52:55]
    s_waitcnt lgkmcnt(8)
    v_mfma_f32_16x16x32_bf16 v[24:27], v[192:195], v[136:139], v[24:27]
    ds_read_b64_tr_b16 v[172:173], v213 offset:0
    v_mfma_f32_16x16x32_bf16 v[28:31], v[192:195], v[140:143], v[28:31]
    ds_read_b64_tr_b16 v[174:175], v213 offset:4096
    v_mfma_f32_16x16x32_bf16 v[56:59], v[192:195], v[144:147], v[56:59]
    ds_read_b64_tr_b16 v[176:177], v212 offset:256
    v_mfma_f32_16x16x32_bf16 v[60:63], v[192:195], v[148:151], v[60:63]
    s_waitcnt lgkmcnt(9)
    v_mfma_f32_16x16x32_bf16 v[32:35], v[196:199], v[136:139], v[32:35]
    ds_read_b64_tr_b16 v[178:179], v212 offset:4352
    v_mfma_f32_16x16x32_bf16 v[36:39], v[196:199], v[140:143], v[36:39]
    ds_read_b64_tr_b16 v[180:181], v213 offset:256
    v_mfma_f32_16x16x32_bf16 v[64:67], v[196:199], v[144:147], v[64:67]
    ds_read_b64_tr_b16 v[182:183], v213 offset:4352
    v_mfma_f32_16x16x32_bf16 v[68:71], v[196:199], v[148:151], v[68:71]
    s_waitcnt lgkmcnt(9)
    v_mfma_f32_16x16x32_bf16 v[8:11], v[168:171], v[152:155], v[8:11]
    s_waitcnt lgkmcnt(8)
    v_mfma_f32_16x16x32_bf16 v[12:15], v[168:171], v[156:159], v[12:15]
    s_waitcnt lgkmcnt(7)
    v_mfma_f32_16x16x32_bf16 v[40:43], v[168:171], v[160:163], v[40:43]
    s_waitcnt lgkmcnt(6)
    v_mfma_f32_16x16x32_bf16 v[44:47], v[168:171], v[164:167], v[44:47]
    s_waitcnt lgkmcnt(4)
    v_mfma_f32_16x16x32_bf16 v[16:19], v[172:175], v[152:155], v[16:19]
    v_mfma_f32_16x16x32_bf16 v[20:23], v[172:175], v[156:159], v[20:23]
    v_mfma_f32_16x16x32_bf16 v[48:51], v[172:175], v[160:163], v[48:51]
    v_mfma_f32_16x16x32_bf16 v[52:55], v[172:175], v[164:167], v[52:55]
    s_waitcnt lgkmcnt(2)
    v_mfma_f32_16x16x32_bf16 v[24:27], v[176:179], v[152:155], v[24:27]
    v_mfma_f32_16x16x32_bf16 v[28:31], v[176:179], v[156:159], v[28:31]
    v_mfma_f32_16x16x32_bf16 v[56:59], v[176:179], v[160:163], v[56:59]
    v_mfma_f32_16x16x32_bf16 v[60:63], v[176:179], v[164:167], v[60:63]
    s_waitcnt lgkmcnt(0)
    v_mfma_f32_16x16x32_bf16 v[32:35], v[180:183], v[152:155], v[32:35]
    v_mfma_f32_16x16x32_bf16 v[36:39], v[180:183], v[156:159], v[36:39]
    v_mfma_f32_16x16x32_bf16 v[64:67], v[180:183], v[160:163], v[64:67]
    v_mfma_f32_16x16x32_bf16 v[68:71], v[180:183], v[164:167], v[68:71]
    s_nop 7
    ds_read_b128 v[136:139], v216 offset:0
    ds_read_b128 v[152:155], v216 offset:1024
    ds_read_b128 v[140:143], v216 offset:32
    ds_read_b128 v[156:159], v216 offset:1056
    ds_read_b128 v[144:147], v216 offset:64
    ds_read_b128 v[160:163], v216 offset:1088
    ds_read_b128 v[148:151], v216 offset:96
    ds_read_b128 v[164:167], v216 offset:1120
    s_mov_b32 s70, 0xbdd2d3e8
    s_mov_b32 s71, s70
    v_mov_b32 v6, 0xc0135761
    v_permlane16_swap_b32 v8, v12
    v_permlane16_swap_b32 v9, v13
    v_permlane16_swap_b32 v10, v14
    v_permlane16_swap_b32 v11, v15
    v_permlane16_swap_b32 v16, v20
    v_permlane16_swap_b32 v17, v21
    v_permlane16_swap_b32 v18, v22
    v_permlane16_swap_b32 v19, v23
    s_waitcnt lgkmcnt(0)
    v_pk_fma_f32 v[168:169], v[136:137], v[224:225], v[152:153] op_sel_hi:[1,0,1]
    v_pk_fma_f32 v[170:171], v[138:139], v[224:225], v[154:155] op_sel_hi:[1,0,1]
    v_pk_fma_f32 v[172:173], v[140:141], v[224:225], v[156:157] op_sel_hi:[1,0,1]
    v_pk_fma_f32 v[174:175], v[142:143], v[224:225], v[158:159] op_sel_hi:[1,0,1]
    v_pk_fma_f32 v[176:177], v[144:145], v[224:225], v[160:161] op_sel_hi:[1,0,1]
    v_pk_fma_f32 v[178:179], v[146:147], v[224:225], v[162:163] op_sel_hi:[1,0,1]
    v_pk_fma_f32 v[180:181], v[148:149], v[224:225], v[164:165] op_sel_hi:[1,0,1]
    v_pk_fma_f32 v[182:183], v[150:151], v[224:225], v[166:167] op_sel_hi:[1,0,1]
    v_pk_fma_f32 v[8:9], v[8:9], v[220:221], v[168:169] op_sel_hi:[1,0,1]
    v_pk_fma_f32 v[10:11], v[10:11], v[220:221], v[170:171] op_sel_hi:[1,0,1]
    v_pk_fma_f32 v[12:13], v[12:13], v[220:221], v[172:173] op_sel_hi:[1,0,1]
    v_pk_fma_f32 v[14:15], v[14:15], v[220:221], v[174:175] op_sel_hi:[1,0,1]
    v_pk_fma_f32 v[16:17], v[16:17], v[220:221], v[176:177] op_sel_hi:[1,0,1]
    v_pk_fma_f32 v[18:19], v[18:19], v[220:221], v[178:179] op_sel_hi:[1,0,1]
    v_pk_fma_f32 v[20:21], v[20:21], v[220:221], v[180:181] op_sel_hi:[1,0,1]
    v_pk_fma_f32 v[22:23], v[22:23], v[220:221], v[182:183] op_sel_hi:[1,0,1]
    v_pk_mul_f32 v[168:169], v[8:9], v[8:9]
    v_pk_mul_f32 v[170:171], v[10:11], v[10:11]
    v_pk_mul_f32 v[172:173], v[12:13], v[12:13]
    v_pk_mul_f32 v[174:175], v[14:15], v[14:15]
    v_pk_mul_f32 v[176:177], v[16:17], v[16:17]
    v_pk_mul_f32 v[178:179], v[18:19], v[18:19]
    v_pk_mul_f32 v[180:181], v[20:21], v[20:21]
    v_pk_mul_f32 v[182:183], v[22:23], v[22:23]
    v_pk_fma_f32 v[168:169], v[168:169], s[70:71], v[6:7] op_sel_hi:[1,1,0]
    v_pk_fma_f32 v[170:171], v[170:171], s[70:71], v[6:7] op_sel_hi:[1,1,0]
    v_pk_fma_f32 v[172:173], v[172:173], s[70:71], v[6:7] op_sel_hi:[1,1,0]
    v_pk_fma_f32 v[174:175], v[174:175], s[70:71], v[6:7] op_sel_hi:[1,1,0]
    v_pk_fma_f32 v[176:177], v[176:177], s[70:71], v[6:7] op_sel_hi:[1,1,0]
    v_pk_fma_f32 v[178:179], v[178:179], s[70:71], v[6:7] op_sel_hi:[1,1,0]
    v_pk_fma_f32 v[180:181], v[180:181], s[70:71], v[6:7] op_sel_hi:[1,1,0]
    v_pk_fma_f32 v[182:183], v[182:183], s[70:71], v[6:7] op_sel_hi:[1,1,0]
    v_pk_mul_f32 v[168:169], v[168:169], v[8:9]
    v_pk_mul_f32 v[170:171], v[170:171], v[10:11]
    v_pk_mul_f32 v[172:173], v[172:173], v[12:13]
    v_pk_mul_f32 v[174:175], v[174:175], v[14:15]
    v_pk_mul_f32 v[176:177], v[176:177], v[16:17]
    v_pk_mul_f32 v[178:179], v[178:179], v[18:19]
    v_pk_mul_f32 v[180:181], v[180:181], v[20:21]
    v_pk_mul_f32 v[182:183], v[182:183], v[22:23]
    v_exp_f32 v168, v168
    v_exp_f32 v169, v169
    v_exp_f32 v170, v170
    v_exp_f32 v171, v171
    v_exp_f32 v172, v172
    v_exp_f32 v173, v173
    v_exp_f32 v174, v174
    v_exp_f32 v175, v175
    v_exp_f32 v176, v176
    v_exp_f32 v177, v177
    v_exp_f32 v178, v178
    v_exp_f32 v179, v179
    v_exp_f32 v180, v180
    v_exp_f32 v181, v181
    v_exp_f32 v182, v182
    v_exp_f32 v183, v183
    v_pk_add_f32 v[168:169], v[168:169], 1.0 op_sel_hi:[1,0]
    v_pk_add_f32 v[170:171], v[170:171], 1.0 op_sel_hi:[1,0]
    v_pk_add_f32 v[172:173], v[172:173], 1.0 op_sel_hi:[1,0]
    v_pk_add_f32 v[174:175], v[174:175], 1.0 op_sel_hi:[1,0]
    v_pk_add_f32 v[176:177], v[176:177], 1.0 op_sel_hi:[1,0]
    v_pk_add_f32 v[178:179], v[178:179], 1.0 op_sel_hi:[1,0]
    v_pk_add_f32 v[180:181], v[180:181], 1.0 op_sel_hi:[1,0]
    v_pk_add_f32 v[182:183], v[182:183], 1.0 op_sel_hi:[1,0]
    v_rcp_f32 v168, v168
    v_rcp_f32 v169, v169
    v_rcp_f32 v170, v170
    v_rcp_f32 v171, v171
    v_rcp_f32 v172, v172
    v_rcp_f32 v173, v173
    v_rcp_f32 v174, v174
    v_rcp_f32 v175, v175
    v_rcp_f32 v176, v176
    v_rcp_f32 v177, v177
    v_rcp_f32 v178, v178
    v_rcp_f32 v179, v179
    v_rcp_f32 v180, v180
    v_rcp_f32 v181, v181
    v_rcp_f32 v182, v182
    v_rcp_f32 v183, v183
    v_pk_mul_f32 v[8:9], v[8:9], v[168:169]
    v_pk_mul_f32 v[10:11], v[10:11], v[170:171]
    v_pk_mul_f32 v[12:13], v[12:13], v[172:173]
    v_pk_mul_f32 v[14:15], v[14:15], v[174:175]
    v_pk_mul_f32 v[16:17], v[16:17], v[176:177]
    v_pk_mul_f32 v[18:19], v[18:19], v[178:179]
    v_pk_mul_f32 v[20:21], v[20:21], v[180:181]
    v_pk_mul_f32 v[22:23], v[22:23], v[182:183]
    v_pk_add_f32 v[228:229], v[8:9], v[10:11]
    v_pk_mul_f32 v[230:231], v[8:9], v[8:9]
    v_pk_fma_f32 v[230:231], v[10:11], v[10:11], v[230:231]
    v_pk_add_f32 v[228:229], v[228:229], v[12:13]
    v_pk_fma_f32 v[230:231], v[12:13], v[12:13], v[230:231]
    v_pk_add_f32 v[228:229], v[228:229], v[14:15]
    v_pk_fma_f32 v[230:231], v[14:15], v[14:15], v[230:231]
    v_pk_add_f32 v[228:229], v[228:229], v[16:17]
    v_pk_fma_f32 v[230:231], v[16:17], v[16:17], v[230:231]
    v_pk_add_f32 v[228:229], v[228:229], v[18:19]
    v_pk_fma_f32 v[230:231], v[18:19], v[18:19], v[230:231]
    v_pk_add_f32 v[228:229], v[228:229], v[20:21]
    v_pk_fma_f32 v[230:231], v[20:21], v[20:21], v[230:231]
    v_pk_add_f32 v[228:229], v[228:229], v[22:23]
    v_pk_fma_f32 v[230:231], v[22:23], v[22:23], v[230:231]
    v_permlane16_swap_b32 v40, v44
    v_permlane16_swap_b32 v41, v45
    v_permlane16_swap_b32 v42, v46
    v_permlane16_swap_b32 v43, v47
    v_permlane16_swap_b32 v48, v52
    v_permlane16_swap_b32 v49, v53
    v_permlane16_swap_b32 v50, v54
    v_permlane16_swap_b32 v51, v55
    v_pk_fma_f32 v[168:169], v[136:137], v[226:227], v[152:153] op_sel_hi:[1,0,1]
    v_pk_fma_f32 v[170:171], v[138:139], v[226:227], v[154:155] op_sel_hi:[1,0,1]
    v_pk_fma_f32 v[172:173], v[140:141], v[226:227], v[156:157] op_sel_hi:[1,0,1]
    v_pk_fma_f32 v[174:175], v[142:143], v[226:227], v[158:159] op_sel_hi:[1,0,1]
    v_pk_fma_f32 v[176:177], v[144:145], v[226:227], v[160:161] op_sel_hi:[1,0,1]
    v_pk_fma_f32 v[178:179], v[146:147], v[226:227], v[162:163] op_sel_hi:[1,0,1]
    v_pk_fma_f32 v[180:181], v[148:149], v[226:227], v[164:165] op_sel_hi:[1,0,1]
    v_pk_fma_f32 v[182:183], v[150:151], v[226:227], v[166:167] op_sel_hi:[1,0,1]
    ds_read_b128 v[136:139], v216 offset:128
    ds_read_b128 v[152:155], v216 offset:1152
    ds_read_b128 v[140:143], v216 offset:160
    ds_read_b128 v[156:159], v216 offset:1184
    ds_read_b128 v[144:147], v216 offset:192
    ds_read_b128 v[160:163], v216 offset:1216
    ds_read_b128 v[148:151], v216 offset:224
    ds_read_b128 v[164:167], v216 offset:1248
    v_pk_fma_f32 v[40:41], v[40:41], v[222:223], v[168:169] op_sel_hi:[1,0,1]
    v_pk_fma_f32 v[42:43], v[42:43], v[222:223], v[170:171] op_sel_hi:[1,0,1]
    v_pk_fma_f32 v[44:45], v[44:45], v[222:223], v[172:173] op_sel_hi:[1,0,1]
    v_pk_fma_f32 v[46:47], v[46:47], v[222:223], v[174:175] op_sel_hi:[1,0,1]
    v_pk_fma_f32 v[48:49], v[48:49], v[222:223], v[176:177] op_sel_hi:[1,0,1]
    v_pk_fma_f32 v[50:51], v[50:51], v[222:223], v[178:179] op_sel_hi:[1,0,1]
    v_pk_fma_f32 v[52:53], v[52:53], v[222:223], v[180:181] op_sel_hi:[1,0,1]
    v_pk_fma_f32 v[54:55], v[54:55], v[222:223], v[182:183] op_sel_hi:[1,0,1]
    v_pk_mul_f32 v[168:169], v[40:41], v[40:41]
    v_pk_mul_f32 v[170:171], v[42:43], v[42:43]
    v_pk_mul_f32 v[172:173], v[44:45], v[44:45]
    v_pk_mul_f32 v[174:175], v[46:47], v[46:47]
    v_pk_mul_f32 v[176:177], v[48:49], v[48:49]
    v_pk_mul_f32 v[178:179], v[50:51], v[50:51]
    v_pk_mul_f32 v[180:181], v[52:53], v[52:53]
    v_pk_mul_f32 v[182:183], v[54:55], v[54:55]
    v_pk_fma_f32 v[168:169], v[168:169], s[70:71], v[6:7] op_sel_hi:[1,1,0]
    v_pk_fma_f32 v[170:171], v[170:171], s[70:71], v[6:7] op_sel_hi:[1,1,0]
    v_pk_fma_f32 v[172:173], v[172:173], s[70:71], v[6:7] op_sel_hi:[1,1,0]
    v_pk_fma_f32 v[174:175], v[174:175], s[70:71], v[6:7] op_sel_hi:[1,1,0]
    v_pk_fma_f32 v[176:177], v[176:177], s[70:71], v[6:7] op_sel_hi:[1,1,0]
    v_pk_fma_f32 v[178:179], v[178:179], s[70:71], v[6:7] op_sel_hi:[1,1,0]
    v_pk_fma_f32 v[180:181], v[180:181], s[70:71], v[6:7] op_sel_hi:[1,1,0]
    v_pk_fma_f32 v[182:183], v[182:183], s[70:71], v[6:7] op_sel_hi:[1,1,0]
    v_pk_mul_f32 v[168:169], v[168:169], v[40:41]
    v_pk_mul_f32 v[170:171], v[170:171], v[42:43]
    v_pk_mul_f32 v[172:173], v[172:173], v[44:45]
    v_pk_mul_f32 v[174:175], v[174:175], v[46:47]
    v_pk_mul_f32 v[176:177], v[176:177], v[48:49]
    v_pk_mul_f32 v[178:179], v[178:179], v[50:51]
    v_pk_mul_f32 v[180:181], v[180:181], v[52:53]
    v_pk_mul_f32 v[182:183], v[182:183], v[54:55]
    v_exp_f32 v168, v168
    v_exp_f32 v169, v169
    v_exp_f32 v170, v170
    v_exp_f32 v171, v171
    v_exp_f32 v172, v172
    v_exp_f32 v173, v173
    v_exp_f32 v174, v174
    v_exp_f32 v175, v175
    v_exp_f32 v176, v176
    v_exp_f32 v177, v177
    v_exp_f32 v178, v178
    v_exp_f32 v179, v179
    v_exp_f32 v180, v180
    v_exp_f32 v181, v181
    v_exp_f32 v182, v182
    v_exp_f32 v183, v183
    v_pk_add_f32 v[168:169], v[168:169], 1.0 op_sel_hi:[1,0]
    v_pk_add_f32 v[170:171], v[170:171], 1.0 op_sel_hi:[1,0]
    v_pk_add_f32 v[172:173], v[172:173], 1.0 op_sel_hi:[1,0]
    v_pk_add_f32 v[174:175], v[174:175], 1.0 op_sel_hi:[1,0]
    v_pk_add_f32 v[176:177], v[176:177], 1.0 op_sel_hi:[1,0]
    v_pk_add_f32 v[178:179], v[178:179], 1.0 op_sel_hi:[1,0]
    v_pk_add_f32 v[180:181], v[180:181], 1.0 op_sel_hi:[1,0]
    v_pk_add_f32 v[182:183], v[182:183], 1.0 op_sel_hi:[1,0]
    v_rcp_f32 v168, v168
    v_rcp_f32 v169, v169
    v_rcp_f32 v170, v170
    v_rcp_f32 v171, v171
    v_rcp_f32 v172, v172
    v_rcp_f32 v173, v173
    v_rcp_f32 v174, v174
    v_rcp_f32 v175, v175
    v_rcp_f32 v176, v176
    v_rcp_f32 v177, v177
    v_rcp_f32 v178, v178
    v_rcp_f32 v179, v179
    v_rcp_f32 v180, v180
    v_rcp_f32 v181, v181
    v_rcp_f32 v182, v182
    v_rcp_f32 v183, v183
    v_pk_mul_f32 v[40:41], v[40:41], v[168:169]
    v_pk_mul_f32 v[42:43], v[42:43], v[170:171]
    v_pk_mul_f32 v[44:45], v[44:45], v[172:173]
    v_pk_mul_f32 v[46:47], v[46:47], v[174:175]
    v_pk_mul_f32 v[48:49], v[48:49], v[176:177]
    v_pk_mul_f32 v[50:51], v[50:51], v[178:179]
    v_pk_mul_f32 v[52:53], v[52:53], v[180:181]
    v_pk_mul_f32 v[54:55], v[54:55], v[182:183]
    v_pk_add_f32 v[232:233], v[40:41], v[42:43]
    v_pk_mul_f32 v[234:235], v[40:41], v[40:41]
    v_pk_fma_f32 v[234:235], v[42:43], v[42:43], v[234:235]
    v_pk_add_f32 v[232:233], v[232:233], v[44:45]
    v_pk_fma_f32 v[234:235], v[44:45], v[44:45], v[234:235]
    v_pk_add_f32 v[232:233], v[232:233], v[46:47]
    v_pk_fma_f32 v[234:235], v[46:47], v[46:47], v[234:235]
    v_pk_add_f32 v[232:233], v[232:233], v[48:49]
    v_pk_fma_f32 v[234:235], v[48:49], v[48:49], v[234:235]
    v_pk_add_f32 v[232:233], v[232:233], v[50:51]
    v_pk_fma_f32 v[234:235], v[50:51], v[50:51], v[234:235]
    v_pk_add_f32 v[232:233], v[232:233], v[52:53]
    v_pk_fma_f32 v[234:235], v[52:53], v[52:53], v[234:235]
    v_pk_add_f32 v[232:233], v[232:233], v[54:55]
    v_pk_fma_f32 v[234:235], v[54:55], v[54:55], v[234:235]
    v_permlane16_swap_b32 v24, v28
    v_permlane16_swap_b32 v25, v29
    v_permlane16_swap_b32 v26, v30
    v_permlane16_swap_b32 v27, v31
    v_permlane16_swap_b32 v32, v36
    v_permlane16_swap_b32 v33, v37
    v_permlane16_swap_b32 v34, v38
    v_permlane16_swap_b32 v35, v39
    s_waitcnt lgkmcnt(0)
    s_nop 0
    v_pk_fma_f32 v[168:169], v[136:137], v[224:225], v[152:153] op_sel_hi:[1,0,1]
    v_pk_fma_f32 v[170:171], v[138:139], v[224:225], v[154:155] op_sel_hi:[1,0,1]
    v_pk_fma_f32 v[172:173], v[140:141], v[224:225], v[156:157] op_sel_hi:[1,0,1]
    v_pk_fma_f32 v[174:175], v[142:143], v[224:225], v[158:159] op_sel_hi:[1,0,1]
    v_pk_fma_f32 v[176:177], v[144:145], v[224:225], v[160:161] op_sel_hi:[1,0,1]
    v_pk_fma_f32 v[178:179], v[146:147], v[224:225], v[162:163] op_sel_hi:[1,0,1]
    v_pk_fma_f32 v[180:181], v[148:149], v[224:225], v[164:165] op_sel_hi:[1,0,1]
    v_pk_fma_f32 v[182:183], v[150:151], v[224:225], v[166:167] op_sel_hi:[1,0,1]
    v_pk_fma_f32 v[24:25], v[24:25], v[220:221], v[168:169] op_sel_hi:[1,0,1]
    v_pk_fma_f32 v[26:27], v[26:27], v[220:221], v[170:171] op_sel_hi:[1,0,1]
    v_pk_fma_f32 v[28:29], v[28:29], v[220:221], v[172:173] op_sel_hi:[1,0,1]
    v_pk_fma_f32 v[30:31], v[30:31], v[220:221], v[174:175] op_sel_hi:[1,0,1]
    v_pk_fma_f32 v[32:33], v[32:33], v[220:221], v[176:177] op_sel_hi:[1,0,1]
    v_pk_fma_f32 v[34:35], v[34:35], v[220:221], v[178:179] op_sel_hi:[1,0,1]
    v_pk_fma_f32 v[36:37], v[36:37], v[220:221], v[180:181] op_sel_hi:[1,0,1]
    v_pk_fma_f32 v[38:39], v[38:39], v[220:221], v[182:183] op_sel_hi:[1,0,1]
    v_pk_mul_f32 v[168:169], v[24:25], v[24:25]
    v_pk_mul_f32 v[170:171], v[26:27], v[26:27]
    v_pk_mul_f32 v[172:173], v[28:29], v[28:29]
    v_pk_mul_f32 v[174:175], v[30:31], v[30:31]
    v_pk_mul_f32 v[176:177], v[32:33], v[32:33]
    v_pk_mul_f32 v[178:179], v[34:35], v[34:35]
    v_pk_mul_f32 v[180:181], v[36:37], v[36:37]
    v_pk_mul_f32 v[182:183], v[38:39], v[38:39]
    v_pk_fma_f32 v[168:169], v[168:169], s[70:71], v[6:7] op_sel_hi:[1,1,0]
    v_pk_fma_f32 v[170:171], v[170:171], s[70:71], v[6:7] op_sel_hi:[1,1,0]
    v_pk_fma_f32 v[172:173], v[172:173], s[70:71], v[6:7] op_sel_hi:[1,1,0]
    v_pk_fma_f32 v[174:175], v[174:175], s[70:71], v[6:7] op_sel_hi:[1,1,0]
    v_pk_fma_f32 v[176:177], v[176:177], s[70:71], v[6:7] op_sel_hi:[1,1,0]
    v_pk_fma_f32 v[178:179], v[178:179], s[70:71], v[6:7] op_sel_hi:[1,1,0]
    v_pk_fma_f32 v[180:181], v[180:181], s[70:71], v[6:7] op_sel_hi:[1,1,0]
    v_pk_fma_f32 v[182:183], v[182:183], s[70:71], v[6:7] op_sel_hi:[1,1,0]
    v_pk_mul_f32 v[168:169], v[168:169], v[24:25]
    v_pk_mul_f32 v[170:171], v[170:171], v[26:27]
    v_pk_mul_f32 v[172:173], v[172:173], v[28:29]
    v_pk_mul_f32 v[174:175], v[174:175], v[30:31]
    v_pk_mul_f32 v[176:177], v[176:177], v[32:33]
    v_pk_mul_f32 v[178:179], v[178:179], v[34:35]
    v_pk_mul_f32 v[180:181], v[180:181], v[36:37]
    v_pk_mul_f32 v[182:183], v[182:183], v[38:39]
    v_exp_f32 v168, v168
    v_exp_f32 v169, v169
    v_exp_f32 v170, v170
    v_exp_f32 v171, v171
    v_exp_f32 v172, v172
    v_exp_f32 v173, v173
    v_exp_f32 v174, v174
    v_exp_f32 v175, v175
    v_exp_f32 v176, v176
    v_exp_f32 v177, v177
    v_exp_f32 v178, v178
    v_exp_f32 v179, v179
    v_exp_f32 v180, v180
    v_exp_f32 v181, v181
    v_exp_f32 v182, v182
    v_exp_f32 v183, v183
    v_pk_add_f32 v[168:169], v[168:169], 1.0 op_sel_hi:[1,0]
    v_pk_add_f32 v[170:171], v[170:171], 1.0 op_sel_hi:[1,0]
    v_pk_add_f32 v[172:173], v[172:173], 1.0 op_sel_hi:[1,0]
    v_pk_add_f32 v[174:175], v[174:175], 1.0 op_sel_hi:[1,0]
    v_pk_add_f32 v[176:177], v[176:177], 1.0 op_sel_hi:[1,0]
    v_pk_add_f32 v[178:179], v[178:179], 1.0 op_sel_hi:[1,0]
    v_pk_add_f32 v[180:181], v[180:181], 1.0 op_sel_hi:[1,0]
    v_pk_add_f32 v[182:183], v[182:183], 1.0 op_sel_hi:[1,0]
    v_rcp_f32 v168, v168
    v_rcp_f32 v169, v169
    v_rcp_f32 v170, v170
    v_rcp_f32 v171, v171
    v_rcp_f32 v172, v172
    v_rcp_f32 v173, v173
    v_rcp_f32 v174, v174
    v_rcp_f32 v175, v175
    v_rcp_f32 v176, v176
    v_rcp_f32 v177, v177
    v_rcp_f32 v178, v178
    v_rcp_f32 v179, v179
    v_rcp_f32 v180, v180
    v_rcp_f32 v181, v181
    v_rcp_f32 v182, v182
    v_rcp_f32 v183, v183
    v_pk_mul_f32 v[24:25], v[24:25], v[168:169]
    v_pk_mul_f32 v[26:27], v[26:27], v[170:171]
    v_pk_mul_f32 v[28:29], v[28:29], v[172:173]
    v_pk_mul_f32 v[30:31], v[30:31], v[174:175]
    v_pk_mul_f32 v[32:33], v[32:33], v[176:177]
    v_pk_mul_f32 v[34:35], v[34:35], v[178:179]
    v_pk_mul_f32 v[36:37], v[36:37], v[180:181]
    v_pk_mul_f32 v[38:39], v[38:39], v[182:183]
    v_pk_add_f32 v[228:229], v[228:229], v[24:25]
    v_pk_fma_f32 v[230:231], v[24:25], v[24:25], v[230:231]
    v_pk_add_f32 v[228:229], v[228:229], v[26:27]
    v_pk_fma_f32 v[230:231], v[26:27], v[26:27], v[230:231]
    v_pk_add_f32 v[228:229], v[228:229], v[28:29]
    v_pk_fma_f32 v[230:231], v[28:29], v[28:29], v[230:231]
    v_pk_add_f32 v[228:229], v[228:229], v[30:31]
    v_pk_fma_f32 v[230:231], v[30:31], v[30:31], v[230:231]
    v_pk_add_f32 v[228:229], v[228:229], v[32:33]
    v_pk_fma_f32 v[230:231], v[32:33], v[32:33], v[230:231]
    v_pk_add_f32 v[228:229], v[228:229], v[34:35]
    v_pk_fma_f32 v[230:231], v[34:35], v[34:35], v[230:231]
    v_pk_add_f32 v[228:229], v[228:229], v[36:37]
    v_pk_fma_f32 v[230:231], v[36:37], v[36:37], v[230:231]
    v_pk_add_f32 v[228:229], v[228:229], v[38:39]
    v_pk_fma_f32 v[230:231], v[38:39], v[38:39], v[230:231]
    v_permlane16_swap_b32 v56, v60
    v_permlane16_swap_b32 v57, v61
    v_permlane16_swap_b32 v58, v62
    v_permlane16_swap_b32 v59, v63
    v_permlane16_swap_b32 v64, v68
    v_permlane16_swap_b32 v65, v69
    v_permlane16_swap_b32 v66, v70
    v_permlane16_swap_b32 v67, v71
    v_pk_fma_f32 v[168:169], v[136:137], v[226:227], v[152:153] op_sel_hi:[1,0,1]
    v_pk_fma_f32 v[170:171], v[138:139], v[226:227], v[154:155] op_sel_hi:[1,0,1]
    v_pk_fma_f32 v[172:173], v[140:141], v[226:227], v[156:157] op_sel_hi:[1,0,1]
    v_pk_fma_f32 v[174:175], v[142:143], v[226:227], v[158:159] op_sel_hi:[1,0,1]
    v_pk_fma_f32 v[176:177], v[144:145], v[226:227], v[160:161] op_sel_hi:[1,0,1]
    v_pk_fma_f32 v[178:179], v[146:147], v[226:227], v[162:163] op_sel_hi:[1,0,1]
    v_pk_fma_f32 v[180:181], v[148:149], v[226:227], v[164:165] op_sel_hi:[1,0,1]
    v_pk_fma_f32 v[182:183], v[150:151], v[226:227], v[166:167] op_sel_hi:[1,0,1]
    v_pk_fma_f32 v[56:57], v[56:57], v[222:223], v[168:169] op_sel_hi:[1,0,1]
    v_pk_fma_f32 v[58:59], v[58:59], v[222:223], v[170:171] op_sel_hi:[1,0,1]
    v_pk_fma_f32 v[60:61], v[60:61], v[222:223], v[172:173] op_sel_hi:[1,0,1]
    v_pk_fma_f32 v[62:63], v[62:63], v[222:223], v[174:175] op_sel_hi:[1,0,1]
    v_pk_fma_f32 v[64:65], v[64:65], v[222:223], v[176:177] op_sel_hi:[1,0,1]
    v_pk_fma_f32 v[66:67], v[66:67], v[222:223], v[178:179] op_sel_hi:[1,0,1]
    v_pk_fma_f32 v[68:69], v[68:69], v[222:223], v[180:181] op_sel_hi:[1,0,1]
    v_pk_fma_f32 v[70:71], v[70:71], v[222:223], v[182:183] op_sel_hi:[1,0,1]
    v_pk_mul_f32 v[168:169], v[56:57], v[56:57]
    v_pk_mul_f32 v[170:171], v[58:59], v[58:59]
    v_pk_mul_f32 v[172:173], v[60:61], v[60:61]
    v_pk_mul_f32 v[174:175], v[62:63], v[62:63]
    v_pk_mul_f32 v[176:177], v[64:65], v[64:65]
    v_pk_mul_f32 v[178:179], v[66:67], v[66:67]
    v_pk_mul_f32 v[180:181], v[68:69], v[68:69]
    v_pk_mul_f32 v[182:183], v[70:71], v[70:71]
    v_pk_fma_f32 v[168:169], v[168:169], s[70:71], v[6:7] op_sel_hi:[1,1,0]
    v_pk_fma_f32 v[170:171], v[170:171], s[70:71], v[6:7] op_sel_hi:[1,1,0]
    v_pk_fma_f32 v[172:173], v[172:173], s[70:71], v[6:7] op_sel_hi:[1,1,0]
    v_pk_fma_f32 v[174:175], v[174:175], s[70:71], v[6:7] op_sel_hi:[1,1,0]
    v_pk_fma_f32 v[176:177], v[176:177], s[70:71], v[6:7] op_sel_hi:[1,1,0]
    v_pk_fma_f32 v[178:179], v[178:179], s[70:71], v[6:7] op_sel_hi:[1,1,0]
    v_pk_fma_f32 v[180:181], v[180:181], s[70:71], v[6:7] op_sel_hi:[1,1,0]
    v_pk_fma_f32 v[182:183], v[182:183], s[70:71], v[6:7] op_sel_hi:[1,1,0]
    v_pk_mul_f32 v[168:169], v[168:169], v[56:57]
    v_pk_mul_f32 v[170:171], v[170:171], v[58:59]
    v_pk_mul_f32 v[172:173], v[172:173], v[60:61]
    v_pk_mul_f32 v[174:175], v[174:175], v[62:63]
    v_pk_mul_f32 v[176:177], v[176:177], v[64:65]
    v_pk_mul_f32 v[178:179], v[178:179], v[66:67]
    v_pk_mul_f32 v[180:181], v[180:181], v[68:69]
    v_pk_mul_f32 v[182:183], v[182:183], v[70:71]
    v_exp_f32 v168, v168
    v_exp_f32 v169, v169
    v_exp_f32 v170, v170
    v_exp_f32 v171, v171
    v_exp_f32 v172, v172
    v_exp_f32 v173, v173
    v_exp_f32 v174, v174
    v_exp_f32 v175, v175
    v_exp_f32 v176, v176
    v_exp_f32 v177, v177
    v_exp_f32 v178, v178
    v_exp_f32 v179, v179
    v_exp_f32 v180, v180
    v_exp_f32 v181, v181
    v_exp_f32 v182, v182
    v_exp_f32 v183, v183
    v_pk_add_f32 v[168:169], v[168:169], 1.0 op_sel_hi:[1,0]
    v_pk_add_f32 v[170:171], v[170:171], 1.0 op_sel_hi:[1,0]
    v_pk_add_f32 v[172:173], v[172:173], 1.0 op_sel_hi:[1,0]
    v_pk_add_f32 v[174:175], v[174:175], 1.0 op_sel_hi:[1,0]
    v_pk_add_f32 v[176:177], v[176:177], 1.0 op_sel_hi:[1,0]
    v_pk_add_f32 v[178:179], v[178:179], 1.0 op_sel_hi:[1,0]
    v_pk_add_f32 v[180:181], v[180:181], 1.0 op_sel_hi:[1,0]
    v_pk_add_f32 v[182:183], v[182:183], 1.0 op_sel_hi:[1,0]
    v_rcp_f32 v168, v168
    v_rcp_f32 v169, v169
    v_rcp_f32 v170, v170
    v_rcp_f32 v171, v171
    v_rcp_f32 v172, v172
    v_rcp_f32 v173, v173
    v_rcp_f32 v174, v174
    v_rcp_f32 v175, v175
    v_rcp_f32 v176, v176
    v_rcp_f32 v177, v177
    v_rcp_f32 v178, v178
    v_rcp_f32 v179, v179
    v_rcp_f32 v180, v180
    v_rcp_f32 v181, v181
    v_rcp_f32 v182, v182
    v_rcp_f32 v183, v183
    v_pk_mul_f32 v[56:57], v[56:57], v[168:169]
    v_pk_mul_f32 v[58:59], v[58:59], v[170:171]
    v_pk_mul_f32 v[60:61], v[60:61], v[172:173]
    v_pk_mul_f32 v[62:63], v[62:63], v[174:175]
    v_pk_mul_f32 v[64:65], v[64:65], v[176:177]
    v_pk_mul_f32 v[66:67], v[66:67], v[178:179]
    v_pk_mul_f32 v[68:69], v[68:69], v[180:181]
    v_pk_mul_f32 v[70:71], v[70:71], v[182:183]
    v_pk_add_f32 v[232:233], v[232:233], v[56:57]
    v_pk_fma_f32 v[234:235], v[56:57], v[56:57], v[234:235]
    v_pk_add_f32 v[232:233], v[232:233], v[58:59]
    v_pk_fma_f32 v[234:235], v[58:59], v[58:59], v[234:235]
    v_pk_add_f32 v[232:233], v[232:233], v[60:61]
    v_pk_fma_f32 v[234:235], v[60:61], v[60:61], v[234:235]
    v_pk_add_f32 v[232:233], v[232:233], v[62:63]
    v_pk_fma_f32 v[234:235], v[62:63], v[62:63], v[234:235]
    v_pk_add_f32 v[232:233], v[232:233], v[64:65]
    v_pk_fma_f32 v[234:235], v[64:65], v[64:65], v[234:235]
    v_pk_add_f32 v[232:233], v[232:233], v[66:67]
    v_pk_fma_f32 v[234:235], v[66:67], v[66:67], v[234:235]
    v_pk_add_f32 v[232:233], v[232:233], v[68:69]
    v_pk_fma_f32 v[234:235], v[68:69], v[68:69], v[234:235]
    v_pk_add_f32 v[232:233], v[232:233], v[70:71]
    v_pk_fma_f32 v[234:235], v[70:71], v[70:71], v[234:235]
    v_add_f32 v228, v228, v229
    v_add_f32 v229, v230, v231
    v_add_f32 v232, v232, v233
    v_add_f32 v233, v234, v235
    s_nop 1
    v_permlane32_swap_b32 v228, v232
    v_permlane32_swap_b32 v229, v233
    s_nop 1
    v_pk_add_f32 v[228:229], v[228:229], v[232:233]
    v_min_u32 v228, -2, v228
    v_min_u32 v229, -2, v229
    buffer_store_dwordx2 v[228:229], v215, s[40:43], s66 offen sc1
    v_add_u32 v209, 98304, v208
    v_add_u32 v212, 98304, v210
    v_add_u32 v213, 98304, v211
    ds_read_b128 v[136:139], v209 offset:0
    ds_read_b64_tr_b16 v[168:169], v212 offset:1024
    ds_read_b64_tr_b16 v[170:171], v212 offset:5120
    ds_read_b128 v[140:143], v209 offset:256
    ds_read_b128 v[144:147], v209 offset:2048
    ds_read_b128 v[148:151], v209 offset:2304
    ds_read_b64_tr_b16 v[172:173], v213 offset:1024
    ds_read_b64_tr_b16 v[174:175], v213 offset:5120
    ds_read_b64_tr_b16 v[176:177], v212 offset:1280
    ds_read_b64_tr_b16 v[178:179], v212 offset:5376
    ds_read_b64_tr_b16 v[180:181], v213 offset:1280
    ds_read_b64_tr_b16 v[182:183], v213 offset:5376
    v_add_u32 v209, 0, v208
    v_add_u32 v212, 0, v210
    v_add_u32 v213, 0, v211
    s_waitcnt lgkmcnt(9)
    v_mfma_f32_16x16x32_bf16 v[72:75], v[168:171], v[136:139], v[72:75]
    ds_read_b128 v[152:155], v209 offset:0
    s_waitcnt lgkmcnt(9)
    v_mfma_f32_16x16x32_bf16 v[76:79], v[168:171], v[140:143], v[76:79]
    ds_read_b64_tr_b16 v[184:185], v212 offset:1024
    s_waitcnt lgkmcnt(9)
    v_mfma_f32_16x16x32_bf16 v[104:107], v[168:171], v[144:147], v[104:107]
    ds_read_b64_tr_b16 v[186:187], v212 offset:5120
    s_waitcnt lgkmcnt(9)
    v_mfma_f32_16x16x32_bf16 v[108:111], v[168:171], v[148:151], v[108:111]
    s_waitcnt lgkmcnt(7)
    v_mfma_f32_16x16x32_bf16 v[80:83], v[172:175], v[136:139], v[80:83]
    ds_read_b128 v[156:159], v209 offset:256
    v_mfma_f32_16x16x32_bf16 v[84:87], v[172:175], v[140:143], v[84:87]
    ds_read_b128 v[160:163], v209 offset:2048
    v_mfma_f32_16x16x32_bf16 v[112:115], v[172:175], v[144:147], v[112:115]
    ds_read_b128 v[164:167], v209 offset:2304
    v_mfma_f32_16x16x32_bf16 v[116:119], v[172:175], v[148:151], v[116:119]
    s_waitcnt lgkmcnt(8)
    v_mfma_f32_16x16x32_bf16 v[88:91], v[176:179], v[136:139], v[88:91]
    ds_read_b64_tr_b16 v[188:189], v213 offset:1024
    v_mfma_f32_16x16x32_bf16 v[92:95], v[176:179], v[140:143], v[92:95]
    ds_read_b64_tr_b16 v[190:191], v213 offset:5120
    v_mfma_f32_16x16x32_bf16 v[120:123], v[176:179], v[144:147], v[120:123]
    ds_read_b64_tr_b16 v[192:193], v212 offset:1280
    v_mfma_f32_16x16x32_bf16 v[124:127], v[176:179], v[148:151], v[124:127]
    s_waitcnt lgkmcnt(9)
    v_mfma_f32_16x16x32_bf16 v[96:99], v[180:183], v[136:139], v[96:99]
    ds_read_b64_tr_b16 v[194:195], v212 offset:5376
    v_mfma_f32_16x16x32_bf16 v[100:103], v[180:183], v[140:143], v[100:103]
    ds_read_b64_tr_b16 v[196:197], v213 offset:1280
    v_mfma_f32_16x16x32_bf16 v[128:131], v[180:183], v[144:147], v[128:131]
    ds_read_b64_tr_b16 v[198:199], v213 offset:5376
    v_mfma_f32_16x16x32_bf16 v[132:135], v[180:183], v[148:151], v[132:135]
    v_add_u32 v209, 24576, v208
    v_add_u32 v212, 24576, v210
    v_add_u32 v213, 24576, v211
    s_waitcnt lgkmcnt(9)
    v_mfma_f32_16x16x32_bf16 v[72:75], v[184:187], v[152:155], v[72:75]
    ds_read_b128 v[136:139], v209 offset:0
    s_waitcnt lgkmcnt(9)
    v_mfma_f32_16x16x32_bf16 v[76:79], v[184:187], v[156:159], v[76:79]
    ds_read_b64_tr_b16 v[168:169], v212 offset:1024
    s_waitcnt lgkmcnt(9)
    v_mfma_f32_16x16x32_bf16 v[104:107], v[184:187], v[160:163], v[104:107]
    ds_read_b64_tr_b16 v[170:171], v212 offset:5120
    s_waitcnt lgkmcnt(9)
    v_mfma_f32_16x16x32_bf16 v[108:111], v[184:187], v[164:167], v[108:111]
    s_waitcnt lgkmcnt(7)
    v_mfma_f32_16x16x32_bf16 v[80:83], v[188:191], v[152:155], v[80:83]
    ds_read_b128 v[140:143], v209 offset:256
    v_mfma_f32_16x16x32_bf16 v[84:87], v[188:191], v[156:159], v[84:87]
    ds_read_b128 v[144:147], v209 offset:2048
    v_mfma_f32_16x16x32_bf16 v[112:115], v[188:191], v[160:163], v[112:115]
    ds_read_b128 v[148:151], v209 offset:2304
    v_mfma_f32_16x16x32_bf16 v[116:119], v[188:191], v[164:167], v[116:119]
    s_waitcnt lgkmcnt(8)
    v_mfma_f32_16x16x32_bf16 v[88:91], v[192:195], v[152:155], v[88:91]
    ds_read_b64_tr_b16 v[172:173], v213 offset:1024
    v_mfma_f32_16x16x32_bf16 v[92:95], v[192:195], v[156:159], v[92:95]
    ds_read_b64_tr_b16 v[174:175], v213 offset:5120
    v_mfma_f32_16x16x32_bf16 v[120:123], v[192:195], v[160:163], v[120:123]
    ds_read_b64_tr_b16 v[176:177], v212 offset:1280
    v_mfma_f32_16x16x32_bf16 v[124:127], v[192:195], v[164:167], v[124:127]
    s_waitcnt lgkmcnt(9)
    v_mfma_f32_16x16x32_bf16 v[96:99], v[196:199], v[152:155], v[96:99]
    ds_read_b64_tr_b16 v[178:179], v212 offset:5376
    v_mfma_f32_16x16x32_bf16 v[100:103], v[196:199], v[156:159], v[100:103]
    ds_read_b64_tr_b16 v[180:181], v213 offset:1280
    v_mfma_f32_16x16x32_bf16 v[128:131], v[196:199], v[160:163], v[128:131]
    ds_read_b64_tr_b16 v[182:183], v213 offset:5376
    v_mfma_f32_16x16x32_bf16 v[132:135], v[196:199], v[164:167], v[132:135]
    s_waitcnt lgkmcnt(0)
    s_barrier
    s_waitcnt lgkmcnt(9)
    v_mfma_f32_16x16x32_bf16 v[72:75], v[168:171], v[136:139], v[72:75]
    s_waitcnt lgkmcnt(8)
    v_mfma_f32_16x16x32_bf16 v[76:79], v[168:171], v[140:143], v[76:79]
    s_waitcnt lgkmcnt(7)
    v_mfma_f32_16x16x32_bf16 v[104:107], v[168:171], v[144:147], v[104:107]
    s_waitcnt lgkmcnt(6)
    v_mfma_f32_16x16x32_bf16 v[108:111], v[168:171], v[148:151], v[108:111]
    s_waitcnt lgkmcnt(4)
    v_mfma_f32_16x16x32_bf16 v[80:83], v[172:175], v[136:139], v[80:83]
    v_mfma_f32_16x16x32_bf16 v[84:87], v[172:175], v[140:143], v[84:87]
    v_mfma_f32_16x16x32_bf16 v[112:115], v[172:175], v[144:147], v[112:115]
    v_mfma_f32_16x16x32_bf16 v[116:119], v[172:175], v[148:151], v[116:119]
    s_waitcnt lgkmcnt(2)
    v_mfma_f32_16x16x32_bf16 v[88:91], v[176:179], v[136:139], v[88:91]
    v_mfma_f32_16x16x32_bf16 v[92:95], v[176:179], v[140:143], v[92:95]
    v_mfma_f32_16x16x32_bf16 v[120:123], v[176:179], v[144:147], v[120:123]
    v_mfma_f32_16x16x32_bf16 v[124:127], v[176:179], v[148:151], v[124:127]
    s_waitcnt lgkmcnt(0)
    v_mfma_f32_16x16x32_bf16 v[96:99], v[180:183], v[136:139], v[96:99]
    v_mfma_f32_16x16x32_bf16 v[100:103], v[180:183], v[140:143], v[100:103]
    v_mfma_f32_16x16x32_bf16 v[128:131], v[180:183], v[144:147], v[128:131]
    v_mfma_f32_16x16x32_bf16 v[132:135], v[180:183], v[148:151], v[132:135]
    s_nop 7
    s_nop 0
    ds_read_b128 v[136:139], v216 offset:512
    ds_read_b128 v[152:155], v216 offset:1536
    ds_read_b128 v[140:143], v216 offset:544
    ds_read_b128 v[156:159], v216 offset:1568
    ds_read_b128 v[144:147], v216 offset:576
    ds_read_b128 v[160:163], v216 offset:1600
    ds_read_b128 v[148:151], v216 offset:608
    ds_read_b128 v[164:167], v216 offset:1632
    s_barrier
    v_permlane16_swap_b32 v72, v76
    v_permlane16_swap_b32 v73, v77
    v_permlane16_swap_b32 v74, v78
    v_permlane16_swap_b32 v75, v79
    v_permlane16_swap_b32 v80, v84
    v_permlane16_swap_b32 v81, v85
    v_permlane16_swap_b32 v82, v86
    v_permlane16_swap_b32 v83, v87
    s_waitcnt lgkmcnt(0)
    v_pk_fma_f32 v[168:169], v[136:137], v[224:225], v[152:153] op_sel_hi:[1,0,1]
    v_pk_fma_f32 v[170:171], v[138:139], v[224:225], v[154:155] op_sel_hi:[1,0,1]
    v_pk_fma_f32 v[172:173], v[140:141], v[224:225], v[156:157] op_sel_hi:[1,0,1]
    v_pk_fma_f32 v[174:175], v[142:143], v[224:225], v[158:159] op_sel_hi:[1,0,1]
    v_pk_fma_f32 v[176:177], v[144:145], v[224:225], v[160:161] op_sel_hi:[1,0,1]
    v_pk_fma_f32 v[178:179], v[146:147], v[224:225], v[162:163] op_sel_hi:[1,0,1]
    v_pk_fma_f32 v[180:181], v[148:149], v[224:225], v[164:165] op_sel_hi:[1,0,1]
    v_pk_fma_f32 v[182:183], v[150:151], v[224:225], v[166:167] op_sel_hi:[1,0,1]
    v_pk_fma_f32 v[72:73], v[72:73], v[220:221], v[168:169] op_sel_hi:[1,0,1]
    v_pk_fma_f32 v[74:75], v[74:75], v[220:221], v[170:171] op_sel_hi:[1,0,1]
    v_pk_fma_f32 v[76:77], v[76:77], v[220:221], v[172:173] op_sel_hi:[1,0,1]
    v_pk_fma_f32 v[78:79], v[78:79], v[220:221], v[174:175] op_sel_hi:[1,0,1]
    v_pk_fma_f32 v[80:81], v[80:81], v[220:221], v[176:177] op_sel_hi:[1,0,1]
    v_pk_fma_f32 v[82:83], v[82:83], v[220:221], v[178:179] op_sel_hi:[1,0,1]
    v_pk_fma_f32 v[84:85], v[84:85], v[220:221], v[180:181] op_sel_hi:[1,0,1]
    v_pk_fma_f32 v[86:87], v[86:87], v[220:221], v[182:183] op_sel_hi:[1,0,1]
    v_pk_mul_f32 v[168:169], v[72:73], v[72:73]
    v_pk_mul_f32 v[170:171], v[74:75], v[74:75]
    v_pk_mul_f32 v[172:173], v[76:77], v[76:77]
    v_pk_mul_f32 v[174:175], v[78:79], v[78:79]
    v_pk_mul_f32 v[176:177], v[80:81], v[80:81]
    v_pk_mul_f32 v[178:179], v[82:83], v[82:83]
    v_pk_mul_f32 v[180:181], v[84:85], v[84:85]
    v_pk_mul_f32 v[182:183], v[86:87], v[86:87]
    v_pk_fma_f32 v[168:169], v[168:169], s[70:71], v[6:7] op_sel_hi:[1,1,0]
    v_pk_fma_f32 v[170:171], v[170:171], s[70:71], v[6:7] op_sel_hi:[1,1,0]
    v_pk_fma_f32 v[172:173], v[172:173], s[70:71], v[6:7] op_sel_hi:[1,1,0]
    v_pk_fma_f32 v[174:175], v[174:175], s[70:71], v[6:7] op_sel_hi:[1,1,0]
    v_pk_fma_f32 v[176:177], v[176:177], s[70:71], v[6:7] op_sel_hi:[1,1,0]
    v_pk_fma_f32 v[178:179], v[178:179], s[70:71], v[6:7] op_sel_hi:[1,1,0]
    v_pk_fma_f32 v[180:181], v[180:181], s[70:71], v[6:7] op_sel_hi:[1,1,0]
    v_pk_fma_f32 v[182:183], v[182:183], s[70:71], v[6:7] op_sel_hi:[1,1,0]
    v_pk_mul_f32 v[168:169], v[168:169], v[72:73]
    v_pk_mul_f32 v[170:171], v[170:171], v[74:75]
    v_pk_mul_f32 v[172:173], v[172:173], v[76:77]
    v_pk_mul_f32 v[174:175], v[174:175], v[78:79]
    v_pk_mul_f32 v[176:177], v[176:177], v[80:81]
    v_pk_mul_f32 v[178:179], v[178:179], v[82:83]
    v_pk_mul_f32 v[180:181], v[180:181], v[84:85]
    v_pk_mul_f32 v[182:183], v[182:183], v[86:87]
    v_exp_f32 v168, v168
    v_exp_f32 v169, v169
    v_exp_f32 v170, v170
    v_exp_f32 v171, v171
    v_exp_f32 v172, v172
    v_exp_f32 v173, v173
    v_exp_f32 v174, v174
    v_exp_f32 v175, v175
    v_exp_f32 v176, v176
    v_exp_f32 v177, v177
    v_exp_f32 v178, v178
    v_exp_f32 v179, v179
    v_exp_f32 v180, v180
    v_exp_f32 v181, v181
    v_exp_f32 v182, v182
    v_exp_f32 v183, v183
    v_pk_add_f32 v[168:169], v[168:169], 1.0 op_sel_hi:[1,0]
    v_pk_add_f32 v[170:171], v[170:171], 1.0 op_sel_hi:[1,0]
    v_pk_add_f32 v[172:173], v[172:173], 1.0 op_sel_hi:[1,0]
    v_pk_add_f32 v[174:175], v[174:175], 1.0 op_sel_hi:[1,0]
    v_pk_add_f32 v[176:177], v[176:177], 1.0 op_sel_hi:[1,0]
    v_pk_add_f32 v[178:179], v[178:179], 1.0 op_sel_hi:[1,0]
    v_pk_add_f32 v[180:181], v[180:181], 1.0 op_sel_hi:[1,0]
    v_pk_add_f32 v[182:183], v[182:183], 1.0 op_sel_hi:[1,0]
    v_rcp_f32 v168, v168
    v_rcp_f32 v169, v169
    v_rcp_f32 v170, v170
    v_rcp_f32 v171, v171
    v_rcp_f32 v172, v172
    v_rcp_f32 v173, v173
    v_rcp_f32 v174, v174
    v_rcp_f32 v175, v175
    v_rcp_f32 v176, v176
    v_rcp_f32 v177, v177
    v_rcp_f32 v178, v178
    v_rcp_f32 v179, v179
    v_rcp_f32 v180, v180
    v_rcp_f32 v181, v181
    v_rcp_f32 v182, v182
    v_rcp_f32 v183, v183
    v_pk_mul_f32 v[72:73], v[72:73], v[168:169]
    v_pk_mul_f32 v[74:75], v[74:75], v[170:171]
    v_pk_mul_f32 v[76:77], v[76:77], v[172:173]
    v_pk_mul_f32 v[78:79], v[78:79], v[174:175]
    v_pk_mul_f32 v[80:81], v[80:81], v[176:177]
    v_pk_mul_f32 v[82:83], v[82:83], v[178:179]
    v_pk_mul_f32 v[84:85], v[84:85], v[180:181]
    v_pk_mul_f32 v[86:87], v[86:87], v[182:183]
    s_lshl_b32 s67, s50, 10
    s_add_u32 s67, s67, 153600
    v_add_u32_e64 v7, s67, v215
    s_lshl_b32 s67, s50, 15
    s_lshl_b32 s68, s51, 11
    s_add_u32 s67, s67, s68
    s_add_u32 s67, s67, 16384
    v_bfe_u32 v5, v1, 4, 1
    v_lshl_add_u32 v240, v5, 12, s67
    v_bfe_u32 v5, v1, 2, 2
    v_lshl_add_u32 v240, v5, 8, v240
    v_and_b32 v5, 2, v5
    v_or_b32 v5, v5, v4
    v_lshl_add_u32 v240, v5, 6, v240
    v_and_b32_e64 v5, 3, v1
    v_lshl_add_u32 v240, v5, 4, v240
    v_xor_b32 v241, 128, v240
    s_barrier
    ds_read_b64 v[232:233], v7
    ds_read_b64 v[236:237], v7 offset:512
    s_waitcnt lgkmcnt(0)
    v_mov_b32 v234, v233
    v_mov_b32 v238, v237
    v_pk_fma_f32 v[8:9], v[8:9], v[232:233], v[234:235] op_sel_hi:[1,0,0]
    v_pk_fma_f32 v[10:11], v[10:11], v[232:233], v[234:235] op_sel_hi:[1,0,0]
    v_pk_fma_f32 v[12:13], v[12:13], v[232:233], v[234:235] op_sel_hi:[1,0,0]
    v_pk_fma_f32 v[14:15], v[14:15], v[232:233], v[234:235] op_sel_hi:[1,0,0]
    v_pk_fma_f32 v[16:17], v[16:17], v[232:233], v[234:235] op_sel_hi:[1,0,0]
    v_pk_fma_f32 v[18:19], v[18:19], v[232:233], v[234:235] op_sel_hi:[1,0,0]
    v_pk_fma_f32 v[20:21], v[20:21], v[232:233], v[234:235] op_sel_hi:[1,0,0]
    v_pk_fma_f32 v[22:23], v[22:23], v[232:233], v[234:235] op_sel_hi:[1,0,0]
    v_cvt_pk_bf16_f32 v8, v8, v9
    v_cvt_pk_bf16_f32 v9, v10, v11
    v_cvt_pk_bf16_f32 v10, v12, v13
    v_cvt_pk_bf16_f32 v11, v14, v15
    v_cvt_pk_bf16_f32 v12, v16, v17
    v_cvt_pk_bf16_f32 v13, v18, v19
    v_cvt_pk_bf16_f32 v14, v20, v21
    v_cvt_pk_bf16_f32 v15, v22, v23
    buffer_store_dwordx4 v[8:11], v214, s[32:35], s60 offen offset:0 sc1
    buffer_store_dwordx4 v[12:15], v214, s[32:35], s60 offen offset:1024 sc1
    v_pk_fma_f32 v[24:25], v[24:25], v[232:233], v[234:235] op_sel_hi:[1,0,0]
    v_pk_fma_f32 v[26:27], v[26:27], v[232:233], v[234:235] op_sel_hi:[1,0,0]
    v_pk_fma_f32 v[28:29], v[28:29], v[232:233], v[234:235] op_sel_hi:[1,0,0]
    v_pk_fma_f32 v[30:31], v[30:31], v[232:233], v[234:235] op_sel_hi:[1,0,0]
    v_pk_fma_f32 v[32:33], v[32:33], v[232:233], v[234:235] op_sel_hi:[1,0,0]
    v_pk_fma_f32 v[34:35], v[34:35], v[232:233], v[234:235] op_sel_hi:[1,0,0]
    v_pk_fma_f32 v[36:37], v[36:37], v[232:233], v[234:235] op_sel_hi:[1,0,0]
    v_pk_fma_f32 v[38:39], v[38:39], v[232:233], v[234:235] op_sel_hi:[1,0,0]
    v_cvt_pk_bf16_f32 v24, v24, v25
    v_cvt_pk_bf16_f32 v25, v26, v27
    v_cvt_pk_bf16_f32 v26, v28, v29
    v_cvt_pk_bf16_f32 v27, v30, v31
    v_cvt_pk_bf16_f32 v28, v32, v33
    v_cvt_pk_bf16_f32 v29, v34, v35
    v_cvt_pk_bf16_f32 v30, v36, v37
    v_cvt_pk_bf16_f32 v31, v38, v39
    buffer_store_dwordx4 v[24:27], v214, s[32:35], s60 offen offset:2048 sc1
    buffer_store_dwordx4 v[28:31], v214, s[32:35], s60 offen offset:3072 sc1
    v_pk_fma_f32 v[40:41], v[40:41], v[236:237], v[238:239] op_sel_hi:[1,0,0]
    v_pk_fma_f32 v[42:43], v[42:43], v[236:237], v[238:239] op_sel_hi:[1,0,0]
    v_pk_fma_f32 v[44:45], v[44:45], v[236:237], v[238:239] op_sel_hi:[1,0,0]
    v_pk_fma_f32 v[46:47], v[46:47], v[236:237], v[238:239] op_sel_hi:[1,0,0]
    v_pk_fma_f32 v[48:49], v[48:49], v[236:237], v[238:239] op_sel_hi:[1,0,0]
    v_pk_fma_f32 v[50:51], v[50:51], v[236:237], v[238:239] op_sel_hi:[1,0,0]
    v_pk_fma_f32 v[52:53], v[52:53], v[236:237], v[238:239] op_sel_hi:[1,0,0]
    v_pk_fma_f32 v[54:55], v[54:55], v[236:237], v[238:239] op_sel_hi:[1,0,0]
    v_cvt_pk_bf16_f32 v40, v40, v41
    v_cvt_pk_bf16_f32 v41, v42, v43
    v_cvt_pk_bf16_f32 v42, v44, v45
    v_cvt_pk_bf16_f32 v43, v46, v47
    v_cvt_pk_bf16_f32 v44, v48, v49
    v_cvt_pk_bf16_f32 v45, v50, v51
    v_cvt_pk_bf16_f32 v46, v52, v53
    v_cvt_pk_bf16_f32 v47, v54, v55
    buffer_store_dwordx4 v[40:43], v214, s[32:35], s61 offen offset:0 sc1
    buffer_store_dwordx4 v[44:47], v214, s[32:35], s61 offen offset:1024 sc1
    v_pk_fma_f32 v[56:57], v[56:57], v[236:237], v[238:239] op_sel_hi:[1,0,0]
    v_pk_fma_f32 v[58:59], v[58:59], v[236:237], v[238:239] op_sel_hi:[1,0,0]
    v_pk_fma_f32 v[60:61], v[60:61], v[236:237], v[238:239] op_sel_hi:[1,0,0]
    v_pk_fma_f32 v[62:63], v[62:63], v[236:237], v[238:239] op_sel_hi:[1,0,0]
    v_pk_fma_f32 v[64:65], v[64:65], v[236:237], v[238:239] op_sel_hi:[1,0,0]
    v_pk_fma_f32 v[66:67], v[66:67], v[236:237], v[238:239] op_sel_hi:[1,0,0]
    v_pk_fma_f32 v[68:69], v[68:69], v[236:237], v[238:239] op_sel_hi:[1,0,0]
    v_pk_fma_f32 v[70:71], v[70:71], v[236:237], v[238:239] op_sel_hi:[1,0,0]
    v_cvt_pk_bf16_f32 v56, v56, v57
    v_cvt_pk_bf16_f32 v57, v58, v59
    v_cvt_pk_bf16_f32 v58, v60, v61
    v_cvt_pk_bf16_f32 v59, v62, v63
    v_cvt_pk_bf16_f32 v60, v64, v65
    v_cvt_pk_bf16_f32 v61, v66, v67
    v_cvt_pk_bf16_f32 v62, v68, v69
    v_cvt_pk_bf16_f32 v63, v70, v71
    buffer_store_dwordx4 v[56:59], v214, s[32:35], s61 offen offset:2048 sc1
    buffer_store_dwordx4 v[60:63], v214, s[32:35], s61 offen offset:3072 sc1
    ds_write_b128 v240, v[8:11] offset:0
    ds_write_b128 v241, v[12:15] offset:0
    ds_write_b128 v240, v[24:27] offset:1024
    ds_write_b128 v241, v[28:31] offset:1024
    ds_write_b128 v240, v[40:43] offset:8192
    ds_write_b128 v241, v[44:47] offset:8192
    ds_write_b128 v240, v[56:59] offset:9216
    ds_write_b128 v241, v[60:63] offset:9216
    v_permlane16_swap_b32 v104, v108
    v_permlane16_swap_b32 v105, v109
    v_permlane16_swap_b32 v106, v110
    v_permlane16_swap_b32 v107, v111
    v_permlane16_swap_b32 v112, v116
    v_permlane16_swap_b32 v113, v117
    v_permlane16_swap_b32 v114, v118
    v_permlane16_swap_b32 v115, v119
    v_pk_fma_f32 v[168:169], v[136:137], v[226:227], v[152:153] op_sel_hi:[1,0,1]
    v_pk_fma_f32 v[170:171], v[138:139], v[226:227], v[154:155] op_sel_hi:[1,0,1]
    v_pk_fma_f32 v[172:173], v[140:141], v[226:227], v[156:157] op_sel_hi:[1,0,1]
    v_pk_fma_f32 v[174:175], v[142:143], v[226:227], v[158:159] op_sel_hi:[1,0,1]
    v_pk_fma_f32 v[176:177], v[144:145], v[226:227], v[160:161] op_sel_hi:[1,0,1]
    v_pk_fma_f32 v[178:179], v[146:147], v[226:227], v[162:163] op_sel_hi:[1,0,1]
    v_pk_fma_f32 v[180:181], v[148:149], v[226:227], v[164:165] op_sel_hi:[1,0,1]
    v_pk_fma_f32 v[182:183], v[150:151], v[226:227], v[166:167] op_sel_hi:[1,0,1]
    ds_read_b128 v[136:139], v216 offset:640
    ds_read_b128 v[152:155], v216 offset:1664
    ds_read_b128 v[140:143], v216 offset:672
    ds_read_b128 v[156:159], v216 offset:1696
    ds_read_b128 v[144:147], v216 offset:704
    ds_read_b128 v[160:163], v216 offset:1728
    ds_read_b128 v[148:151], v216 offset:736
    ds_read_b128 v[164:167], v216 offset:1760
    v_pk_fma_f32 v[104:105], v[104:105], v[222:223], v[168:169] op_sel_hi:[1,0,1]
    v_pk_fma_f32 v[106:107], v[106:107], v[222:223], v[170:171] op_sel_hi:[1,0,1]
    v_pk_fma_f32 v[108:109], v[108:109], v[222:223], v[172:173] op_sel_hi:[1,0,1]
    v_pk_fma_f32 v[110:111], v[110:111], v[222:223], v[174:175] op_sel_hi:[1,0,1]
    v_pk_fma_f32 v[112:113], v[112:113], v[222:223], v[176:177] op_sel_hi:[1,0,1]
    v_pk_fma_f32 v[114:115], v[114:115], v[222:223], v[178:179] op_sel_hi:[1,0,1]
    v_pk_fma_f32 v[116:117], v[116:117], v[222:223], v[180:181] op_sel_hi:[1,0,1]
    v_pk_fma_f32 v[118:119], v[118:119], v[222:223], v[182:183] op_sel_hi:[1,0,1]
    v_pk_mul_f32 v[168:169], v[104:105], v[104:105]
    v_pk_mul_f32 v[170:171], v[106:107], v[106:107]
    v_pk_mul_f32 v[172:173], v[108:109], v[108:109]
    v_pk_mul_f32 v[174:175], v[110:111], v[110:111]
    v_pk_mul_f32 v[176:177], v[112:113], v[112:113]
    v_pk_mul_f32 v[178:179], v[114:115], v[114:115]
    v_pk_mul_f32 v[180:181], v[116:117], v[116:117]
    v_pk_mul_f32 v[182:183], v[118:119], v[118:119]
    v_pk_fma_f32 v[168:169], v[168:169], s[70:71], v[6:7] op_sel_hi:[1,1,0]
    v_pk_fma_f32 v[170:171], v[170:171], s[70:71], v[6:7] op_sel_hi:[1,1,0]
    v_pk_fma_f32 v[172:173], v[172:173], s[70:71], v[6:7] op_sel_hi:[1,1,0]
    v_pk_fma_f32 v[174:175], v[174:175], s[70:71], v[6:7] op_sel_hi:[1,1,0]
    v_pk_fma_f32 v[176:177], v[176:177], s[70:71], v[6:7] op_sel_hi:[1,1,0]
    v_pk_fma_f32 v[178:179], v[178:179], s[70:71], v[6:7] op_sel_hi:[1,1,0]
    v_pk_fma_f32 v[180:181], v[180:181], s[70:71], v[6:7] op_sel_hi:[1,1,0]
    v_pk_fma_f32 v[182:183], v[182:183], s[70:71], v[6:7] op_sel_hi:[1,1,0]
    v_pk_mul_f32 v[168:169], v[168:169], v[104:105]
    v_pk_mul_f32 v[170:171], v[170:171], v[106:107]
    v_pk_mul_f32 v[172:173], v[172:173], v[108:109]
    v_pk_mul_f32 v[174:175], v[174:175], v[110:111]
    v_pk_mul_f32 v[176:177], v[176:177], v[112:113]
    v_pk_mul_f32 v[178:179], v[178:179], v[114:115]
    v_pk_mul_f32 v[180:181], v[180:181], v[116:117]
    v_pk_mul_f32 v[182:183], v[182:183], v[118:119]
    v_exp_f32 v168, v168
    v_exp_f32 v169, v169
    v_exp_f32 v170, v170
    v_exp_f32 v171, v171
    v_exp_f32 v172, v172
    v_exp_f32 v173, v173
    v_exp_f32 v174, v174
    v_exp_f32 v175, v175
    v_exp_f32 v176, v176
    v_exp_f32 v177, v177
    v_exp_f32 v178, v178
    v_exp_f32 v179, v179
    v_exp_f32 v180, v180
    v_exp_f32 v181, v181
    v_exp_f32 v182, v182
    v_exp_f32 v183, v183
    v_pk_add_f32 v[168:169], v[168:169], 1.0 op_sel_hi:[1,0]
    v_pk_add_f32 v[170:171], v[170:171], 1.0 op_sel_hi:[1,0]
    v_pk_add_f32 v[172:173], v[172:173], 1.0 op_sel_hi:[1,0]
    v_pk_add_f32 v[174:175], v[174:175], 1.0 op_sel_hi:[1,0]
    v_pk_add_f32 v[176:177], v[176:177], 1.0 op_sel_hi:[1,0]
    v_pk_add_f32 v[178:179], v[178:179], 1.0 op_sel_hi:[1,0]
    v_pk_add_f32 v[180:181], v[180:181], 1.0 op_sel_hi:[1,0]
    v_pk_add_f32 v[182:183], v[182:183], 1.0 op_sel_hi:[1,0]
    v_rcp_f32 v168, v168
    v_rcp_f32 v169, v169
    v_rcp_f32 v170, v170
    v_rcp_f32 v171, v171
    v_rcp_f32 v172, v172
    v_rcp_f32 v173, v173
    v_rcp_f32 v174, v174
    v_rcp_f32 v175, v175
    v_rcp_f32 v176, v176
    v_rcp_f32 v177, v177
    v_rcp_f32 v178, v178
    v_rcp_f32 v179, v179
    v_rcp_f32 v180, v180
    v_rcp_f32 v181, v181
    v_rcp_f32 v182, v182
    v_rcp_f32 v183, v183
    v_pk_mul_f32 v[104:105], v[104:105], v[168:169]
    v_pk_mul_f32 v[106:107], v[106:107], v[170:171]
    v_pk_mul_f32 v[108:109], v[108:109], v[172:173]
    v_pk_mul_f32 v[110:111], v[110:111], v[174:175]
    v_pk_mul_f32 v[112:113], v[112:113], v[176:177]
    v_pk_mul_f32 v[114:115], v[114:115], v[178:179]
    v_pk_mul_f32 v[116:117], v[116:117], v[180:181]
    v_pk_mul_f32 v[118:119], v[118:119], v[182:183]
    v_permlane16_swap_b32 v88, v92
    v_permlane16_swap_b32 v89, v93
    v_permlane16_swap_b32 v90, v94
    v_permlane16_swap_b32 v91, v95
    v_permlane16_swap_b32 v96, v100
    v_permlane16_swap_b32 v97, v101
    v_permlane16_swap_b32 v98, v102
    v_permlane16_swap_b32 v99, v103
    s_waitcnt lgkmcnt(0)
    s_nop 0
    v_pk_fma_f32 v[168:169], v[136:137], v[224:225], v[152:153] op_sel_hi:[1,0,1]
    v_pk_fma_f32 v[170:171], v[138:139], v[224:225], v[154:155] op_sel_hi:[1,0,1]
    v_pk_fma_f32 v[172:173], v[140:141], v[224:225], v[156:157] op_sel_hi:[1,0,1]
    v_pk_fma_f32 v[174:175], v[142:143], v[224:225], v[158:159] op_sel_hi:[1,0,1]
    v_pk_fma_f32 v[176:177], v[144:145], v[224:225], v[160:161] op_sel_hi:[1,0,1]
    v_pk_fma_f32 v[178:179], v[146:147], v[224:225], v[162:163] op_sel_hi:[1,0,1]
    v_pk_fma_f32 v[180:181], v[148:149], v[224:225], v[164:165] op_sel_hi:[1,0,1]
    v_pk_fma_f32 v[182:183], v[150:151], v[224:225], v[166:167] op_sel_hi:[1,0,1]
    v_pk_fma_f32 v[88:89], v[88:89], v[220:221], v[168:169] op_sel_hi:[1,0,1]
    v_pk_fma_f32 v[90:91], v[90:91], v[220:221], v[170:171] op_sel_hi:[1,0,1]
    v_pk_fma_f32 v[92:93], v[92:93], v[220:221], v[172:173] op_sel_hi:[1,0,1]
    v_pk_fma_f32 v[94:95], v[94:95], v[220:221], v[174:175] op_sel_hi:[1,0,1]
    v_pk_fma_f32 v[96:97], v[96:97], v[220:221], v[176:177] op_sel_hi:[1,0,1]
    v_pk_fma_f32 v[98:99], v[98:99], v[220:221], v[178:179] op_sel_hi:[1,0,1]
    v_pk_fma_f32 v[100:101], v[100:101], v[220:221], v[180:181] op_sel_hi:[1,0,1]
    v_pk_fma_f32 v[102:103], v[102:103], v[220:221], v[182:183] op_sel_hi:[1,0,1]
    v_pk_mul_f32 v[168:169], v[88:89], v[88:89]
    v_pk_mul_f32 v[170:171], v[90:91], v[90:91]
    v_pk_mul_f32 v[172:173], v[92:93], v[92:93]
    v_pk_mul_f32 v[174:175], v[94:95], v[94:95]
    v_pk_mul_f32 v[176:177], v[96:97], v[96:97]
    v_pk_mul_f32 v[178:179], v[98:99], v[98:99]
    v_pk_mul_f32 v[180:181], v[100:101], v[100:101]
    v_pk_mul_f32 v[182:183], v[102:103], v[102:103]
    v_pk_fma_f32 v[168:169], v[168:169], s[70:71], v[6:7] op_sel_hi:[1,1,0]
    v_pk_fma_f32 v[170:171], v[170:171], s[70:71], v[6:7] op_sel_hi:[1,1,0]
    v_pk_fma_f32 v[172:173], v[172:173], s[70:71], v[6:7] op_sel_hi:[1,1,0]
    v_pk_fma_f32 v[174:175], v[174:175], s[70:71], v[6:7] op_sel_hi:[1,1,0]
    v_pk_fma_f32 v[176:177], v[176:177], s[70:71], v[6:7] op_sel_hi:[1,1,0]
    v_pk_fma_f32 v[178:179], v[178:179], s[70:71], v[6:7] op_sel_hi:[1,1,0]
    v_pk_fma_f32 v[180:181], v[180:181], s[70:71], v[6:7] op_sel_hi:[1,1,0]
    v_pk_fma_f32 v[182:183], v[182:183], s[70:71], v[6:7] op_sel_hi:[1,1,0]
    v_pk_mul_f32 v[168:169], v[168:169], v[88:89]
    v_pk_mul_f32 v[170:171], v[170:171], v[90:91]
    v_pk_mul_f32 v[172:173], v[172:173], v[92:93]
    v_pk_mul_f32 v[174:175], v[174:175], v[94:95]
    v_pk_mul_f32 v[176:177], v[176:177], v[96:97]
    v_pk_mul_f32 v[178:179], v[178:179], v[98:99]
    v_pk_mul_f32 v[180:181], v[180:181], v[100:101]
    v_pk_mul_f32 v[182:183], v[182:183], v[102:103]
    v_exp_f32 v168, v168
    v_exp_f32 v169, v169
    v_exp_f32 v170, v170
    v_exp_f32 v171, v171
    v_exp_f32 v172, v172
    v_exp_f32 v173, v173
    v_exp_f32 v174, v174
    v_exp_f32 v175, v175
    v_exp_f32 v176, v176
    v_exp_f32 v177, v177
    v_exp_f32 v178, v178
    v_exp_f32 v179, v179
    v_exp_f32 v180, v180
    v_exp_f32 v181, v181
    v_exp_f32 v182, v182
    v_exp_f32 v183, v183
    v_pk_add_f32 v[168:169], v[168:169], 1.0 op_sel_hi:[1,0]
    v_pk_add_f32 v[170:171], v[170:171], 1.0 op_sel_hi:[1,0]
    v_pk_add_f32 v[172:173], v[172:173], 1.0 op_sel_hi:[1,0]
    v_pk_add_f32 v[174:175], v[174:175], 1.0 op_sel_hi:[1,0]
    v_pk_add_f32 v[176:177], v[176:177], 1.0 op_sel_hi:[1,0]
    v_pk_add_f32 v[178:179], v[178:179], 1.0 op_sel_hi:[1,0]
    v_pk_add_f32 v[180:181], v[180:181], 1.0 op_sel_hi:[1,0]
    v_pk_add_f32 v[182:183], v[182:183], 1.0 op_sel_hi:[1,0]
    v_rcp_f32 v168, v168
    v_rcp_f32 v169, v169
    v_rcp_f32 v170, v170
    v_rcp_f32 v171, v171
    v_rcp_f32 v172, v172
    v_rcp_f32 v173, v173
    v_rcp_f32 v174, v174
    v_rcp_f32 v175, v175
    v_rcp_f32 v176, v176
    v_rcp_f32 v177, v177
    v_rcp_f32 v178, v178
    v_rcp_f32 v179, v179
    v_rcp_f32 v180, v180
    v_rcp_f32 v181, v181
    v_rcp_f32 v182, v182
    v_rcp_f32 v183, v183
    v_pk_mul_f32 v[88:89], v[88:89], v[168:169]
    v_pk_mul_f32 v[90:91], v[90:91], v[170:171]
    v_pk_mul_f32 v[92:93], v[92:93], v[172:173]
    v_pk_mul_f32 v[94:95], v[94:95], v[174:175]
    v_pk_mul_f32 v[96:97], v[96:97], v[176:177]
    v_pk_mul_f32 v[98:99], v[98:99], v[178:179]
    v_pk_mul_f32 v[100:101], v[100:101], v[180:181]
    v_pk_mul_f32 v[102:103], v[102:103], v[182:183]
    s_add_u32 s96, s28, 0x3a00000
    s_addc_u32 s97, s29, 0
    s_and_b32 s97, s97, 0xffff
    s_mov_b32 s98, 0x200000
    s_mov_b32 s99, 0x20000
    v_mov_b32 v252, s84
    v_mov_b32 v253, s85
    v_mov_b32_e64 v254, 0
    s_and_b32 s100, s3, 3
    s_lshl_b32 s100, s100, 7
    s_add_u32 s100, s100, s87
    s_waitcnt vmcnt(0)
    s_mov_b64 exec, 1
    buffer_store_dwordx2 v[252:253], v254, s[96:99], s100 offen sc1
    s_mov_b64 exec, -1
    s_barrier
    v_permlane16_swap_b32 v120, v124
    v_permlane16_swap_b32 v121, v125
    v_permlane16_swap_b32 v122, v126
    v_permlane16_swap_b32 v123, v127
    v_permlane16_swap_b32 v128, v132
    v_permlane16_swap_b32 v129, v133
    v_permlane16_swap_b32 v130, v134
    v_permlane16_swap_b32 v131, v135
    v_pk_fma_f32 v[168:169], v[136:137], v[226:227], v[152:153] op_sel_hi:[1,0,1]
    v_pk_fma_f32 v[170:171], v[138:139], v[226:227], v[154:155] op_sel_hi:[1,0,1]
    v_pk_fma_f32 v[172:173], v[140:141], v[226:227], v[156:157] op_sel_hi:[1,0,1]
    v_pk_fma_f32 v[174:175], v[142:143], v[226:227], v[158:159] op_sel_hi:[1,0,1]
    v_pk_fma_f32 v[176:177], v[144:145], v[226:227], v[160:161] op_sel_hi:[1,0,1]
    v_pk_fma_f32 v[178:179], v[146:147], v[226:227], v[162:163] op_sel_hi:[1,0,1]
    v_pk_fma_f32 v[180:181], v[148:149], v[226:227], v[164:165] op_sel_hi:[1,0,1]
    v_pk_fma_f32 v[182:183], v[150:151], v[226:227], v[166:167] op_sel_hi:[1,0,1]
    v_pk_fma_f32 v[120:121], v[120:121], v[222:223], v[168:169] op_sel_hi:[1,0,1]
    v_pk_fma_f32 v[122:123], v[122:123], v[222:223], v[170:171] op_sel_hi:[1,0,1]
    v_pk_fma_f32 v[124:125], v[124:125], v[222:223], v[172:173] op_sel_hi:[1,0,1]
    v_pk_fma_f32 v[126:127], v[126:127], v[222:223], v[174:175] op_sel_hi:[1,0,1]
    v_pk_fma_f32 v[128:129], v[128:129], v[222:223], v[176:177] op_sel_hi:[1,0,1]
    v_pk_fma_f32 v[130:131], v[130:131], v[222:223], v[178:179] op_sel_hi:[1,0,1]
    v_pk_fma_f32 v[132:133], v[132:133], v[222:223], v[180:181] op_sel_hi:[1,0,1]
    v_pk_fma_f32 v[134:135], v[134:135], v[222:223], v[182:183] op_sel_hi:[1,0,1]
    v_pk_mul_f32 v[168:169], v[120:121], v[120:121]
    v_pk_mul_f32 v[170:171], v[122:123], v[122:123]
    v_pk_mul_f32 v[172:173], v[124:125], v[124:125]
    v_pk_mul_f32 v[174:175], v[126:127], v[126:127]
    v_pk_mul_f32 v[176:177], v[128:129], v[128:129]
    v_pk_mul_f32 v[178:179], v[130:131], v[130:131]
    v_pk_mul_f32 v[180:181], v[132:133], v[132:133]
    v_pk_mul_f32 v[182:183], v[134:135], v[134:135]
    v_pk_fma_f32 v[168:169], v[168:169], s[70:71], v[6:7] op_sel_hi:[1,1,0]
    v_pk_fma_f32 v[170:171], v[170:171], s[70:71], v[6:7] op_sel_hi:[1,1,0]
    v_pk_fma_f32 v[172:173], v[172:173], s[70:71], v[6:7] op_sel_hi:[1,1,0]
    v_pk_fma_f32 v[174:175], v[174:175], s[70:71], v[6:7] op_sel_hi:[1,1,0]
    v_pk_fma_f32 v[176:177], v[176:177], s[70:71], v[6:7] op_sel_hi:[1,1,0]
    v_pk_fma_f32 v[178:179], v[178:179], s[70:71], v[6:7] op_sel_hi:[1,1,0]
    v_pk_fma_f32 v[180:181], v[180:181], s[70:71], v[6:7] op_sel_hi:[1,1,0]
    v_pk_fma_f32 v[182:183], v[182:183], s[70:71], v[6:7] op_sel_hi:[1,1,0]
    v_pk_mul_f32 v[168:169], v[168:169], v[120:121]
    v_pk_mul_f32 v[170:171], v[170:171], v[122:123]
    v_pk_mul_f32 v[172:173], v[172:173], v[124:125]
    v_pk_mul_f32 v[174:175], v[174:175], v[126:127]
    v_pk_mul_f32 v[176:177], v[176:177], v[128:129]
    v_pk_mul_f32 v[178:179], v[178:179], v[130:131]
    v_pk_mul_f32 v[180:181], v[180:181], v[132:133]
    v_pk_mul_f32 v[182:183], v[182:183], v[134:135]
    v_exp_f32 v168, v168
    v_exp_f32 v169, v169
    v_exp_f32 v170, v170
    v_exp_f32 v171, v171
    v_exp_f32 v172, v172
    v_exp_f32 v173, v173
    v_exp_f32 v174, v174
    v_exp_f32 v175, v175
    v_exp_f32 v176, v176
    v_exp_f32 v177, v177
    v_exp_f32 v178, v178
    v_exp_f32 v179, v179
    v_exp_f32 v180, v180
    v_exp_f32 v181, v181
    v_exp_f32 v182, v182
    v_exp_f32 v183, v183
    v_pk_add_f32 v[168:169], v[168:169], 1.0 op_sel_hi:[1,0]
    v_pk_add_f32 v[170:171], v[170:171], 1.0 op_sel_hi:[1,0]
    v_pk_add_f32 v[172:173], v[172:173], 1.0 op_sel_hi:[1,0]
    v_pk_add_f32 v[174:175], v[174:175], 1.0 op_sel_hi:[1,0]
    v_pk_add_f32 v[176:177], v[176:177], 1.0 op_sel_hi:[1,0]
    v_pk_add_f32 v[178:179], v[178:179], 1.0 op_sel_hi:[1,0]
    v_pk_add_f32 v[180:181], v[180:181], 1.0 op_sel_hi:[1,0]
    v_pk_add_f32 v[182:183], v[182:183], 1.0 op_sel_hi:[1,0]
    v_rcp_f32 v168, v168
    v_rcp_f32 v169, v169
    v_rcp_f32 v170, v170
    v_rcp_f32 v171, v171
    v_rcp_f32 v172, v172
    v_rcp_f32 v173, v173
    v_rcp_f32 v174, v174
    v_rcp_f32 v175, v175
    v_rcp_f32 v176, v176
    v_rcp_f32 v177, v177
    v_rcp_f32 v178, v178
    v_rcp_f32 v179, v179
    v_rcp_f32 v180, v180
    v_rcp_f32 v181, v181
    v_rcp_f32 v182, v182
    v_rcp_f32 v183, v183
    v_pk_mul_f32 v[120:121], v[120:121], v[168:169]
    v_pk_mul_f32 v[122:123], v[122:123], v[170:171]
    v_pk_mul_f32 v[124:125], v[124:125], v[172:173]
    v_pk_mul_f32 v[126:127], v[126:127], v[174:175]
    v_pk_mul_f32 v[128:129], v[128:129], v[176:177]
    v_pk_mul_f32 v[130:131], v[130:131], v[178:179]
    v_pk_mul_f32 v[132:133], v[132:133], v[180:181]
    v_pk_mul_f32 v[134:135], v[134:135], v[182:183]
    s_waitcnt lgkmcnt(0)
    s_mov_b64 exec, -1
    s_setprio 0
    s_branch L_wsp_entry
L_win_pf:
    s_sub_u32 s30, s2, 224
    s_cmp_ge_u32 s30, 28
    s_cbranch_scc1 L_win_pfe
    v_lshrrev_b32 v2, 3, v0
    v_and_b32 v3, 7, v0
    v_lshlrev_b32_e64 v4, 6, v2
    s_mov_b32 s31, 114688
    v_mul_lo_u32 v5, v2, s31
    v_lshl_add_u32 v5, v3, 4, v5
    s_movk_i32 s44, 16384
    s_movk_i32 s45, 12288
    s_lshl_b32 s30, s30, 1
    s_waitcnt lgkmcnt(0)
    s_mov_b32 s36, s12
    s_and_b32 s37, s13, 0xffff
    s_mov_b32 s38, 0x700000
    s_mov_b32 s39, 0x20000
    s_mov_b32 s40, s28
    s_and_b32 s41, s29, 0xffff
    s_mov_b32 s42, 0x10000
    s_mov_b32 s43, 0x20000
    s_mov_b32 s101, 0x100000
L_mp0_uwq40:
    buffer_load_dwordx4 v[72:75], v4, s[40:43], s44 offen offset:0 sc1
    buffer_load_dwordx4 v[76:79], v4, s[40:43], s44 offen offset:16 sc1
    buffer_load_dwordx4 v[80:83], v4, s[40:43], s44 offen offset:32 sc1
    buffer_load_dwordx4 v[84:87], v4, s[40:43], s44 offen offset:48 sc1
    buffer_load_dwordx4 v[88:91], v4, s[40:43], s45 offen offset:0 sc1
    buffer_load_dwordx4 v[92:95], v4, s[40:43], s45 offen offset:16 sc1
    buffer_load_dwordx4 v[96:99], v4, s[40:43], s45 offen offset:32 sc1
    buffer_load_dwordx4 v[100:103], v4, s[40:43], s45 offen offset:48 sc1
    s_waitcnt vmcnt(0)
    v_max_u32 v6, v72, v73
    v_max3_u32 v6, v6, v74, v75
    v_max3_u32 v6, v6, v76, v77
    v_max3_u32 v6, v6, v78, v79
    v_max3_u32 v6, v6, v80, v81
    v_max3_u32 v6, v6, v82, v83
    v_max3_u32 v6, v6, v84, v85
    v_max3_u32 v6, v6, v86, v87
    v_max3_u32 v6, v6, v88, v89
    v_max3_u32 v6, v6, v90, v91
    v_max3_u32 v6, v6, v92, v93
    v_max3_u32 v6, v6, v94, v95
    v_max3_u32 v6, v6, v96, v97
    v_max3_u32 v6, v6, v98, v99
    v_max3_u32 v6, v6, v100, v101
    v_max3_u32 v6, v6, v102, v103
    v_cmp_eq_u32 vcc, -1, v6
    s_sub_u32 s101, s101, 1
    s_nop 3
    s_cbranch_vccz L_mp0_pd41
    s_cmp_lg_u32 s101, 0
    s_cbranch_scc1 L_mp0_uwq40
L_mp0_pd41:
    s_mov_b32 s50, 155648
L_mp0_uw42:
    s_lshl_b32 s31, s30, 7
    s_nop 0
    buffer_load_dwordx4 v[8:11], v5, s[36:39], s31 offen
    s_add_u32 s31, s31, 7168
    buffer_load_dwordx4 v[12:15], v5, s[36:39], s31 offen
    s_add_u32 s31, s31, 7168
    buffer_load_dwordx4 v[16:19], v5, s[36:39], s31 offen
    s_add_u32 s31, s31, 7168
    buffer_load_dwordx4 v[20:23], v5, s[36:39], s31 offen
    s_add_u32 s31, s31, 7168
    buffer_load_dwordx4 v[24:27], v5, s[36:39], s31 offen
    s_add_u32 s31, s31, 7168
    buffer_load_dwordx4 v[28:31], v5, s[36:39], s31 offen
    s_add_u32 s31, s31, 7168
    buffer_load_dwordx4 v[32:35], v5, s[36:39], s31 offen
    s_add_u32 s31, s31, 7168
    buffer_load_dwordx4 v[36:39], v5, s[36:39], s31 offen
    s_add_u32 s31, s31, 7168
    buffer_load_dwordx4 v[40:43], v5, s[36:39], s31 offen
    s_add_u32 s31, s31, 7168
    buffer_load_dwordx4 v[44:47], v5, s[36:39], s31 offen
    s_add_u32 s31, s31, 7168
    buffer_load_dwordx4 v[48:51], v5, s[36:39], s31 offen
    s_add_u32 s31, s31, 7168
    buffer_load_dwordx4 v[52:55], v5, s[36:39], s31 offen
    s_add_u32 s31, s31, 7168
    buffer_load_dwordx4 v[56:59], v5, s[36:39], s31 offen
    s_add_u32 s31, s31, 7168
    buffer_load_dwordx4 v[60:63], v5, s[36:39], s31 offen
    s_add_u32 s31, s31, 7168
    buffer_load_dwordx4 v[64:67], v5, s[36:39], s31 offen
    s_add_u32 s31, s31, 7168
    buffer_load_dwordx4 v[68:71], v5, s[36:39], s31 offen
    s_add_u32 s31, s31, 7168
    s_waitcnt vmcnt(15)
    v_lshlrev_b32 v6, 16, v8
    v_and_b32 v7, 0xffff0000, v8
    v_mul_f32 v104, v6, v72
    v_mul_f32 v105, v7, v72
    v_mul_f32 v112, v6, v88
    v_mul_f32 v113, v7, v88
    v_lshlrev_b32_e64 v6, 16, v9
    v_and_b32 v7, 0xffff0000, v9
    v_mul_f32 v106, v6, v72
    v_mul_f32 v107, v7, v72
    v_mul_f32 v114, v6, v88
    v_mul_f32 v115, v7, v88
    v_lshlrev_b32_e64 v6, 16, v10
    v_and_b32 v7, 0xffff0000, v10
    v_mul_f32 v108, v6, v72
    v_mul_f32 v109, v7, v72
    v_mul_f32 v116, v6, v88
    v_mul_f32 v117, v7, v88
    v_lshlrev_b32_e64 v6, 16, v11
    v_and_b32 v7, 0xffff0000, v11
    v_mul_f32 v110, v6, v72
    v_mul_f32 v111, v7, v72
    v_mul_f32 v118, v6, v88
    v_mul_f32 v119, v7, v88
    s_waitcnt vmcnt(14)
    v_lshlrev_b32 v6, 16, v12
    v_and_b32 v7, 0xffff0000, v12
    v_fmac_f32 v104, v6, v73
    v_fmac_f32 v105, v7, v73
    v_fmac_f32 v112, v6, v89
    v_fmac_f32 v113, v7, v89
    v_lshlrev_b32_e64 v6, 16, v13
    v_and_b32 v7, 0xffff0000, v13
    v_fmac_f32 v106, v6, v73
    v_fmac_f32 v107, v7, v73
    v_fmac_f32 v114, v6, v89
    v_fmac_f32 v115, v7, v89
    v_lshlrev_b32_e64 v6, 16, v14
    v_and_b32 v7, 0xffff0000, v14
    v_fmac_f32 v108, v6, v73
    v_fmac_f32 v109, v7, v73
    v_fmac_f32 v116, v6, v89
    v_fmac_f32 v117, v7, v89
    v_lshlrev_b32_e64 v6, 16, v15
    v_and_b32 v7, 0xffff0000, v15
    v_fmac_f32 v110, v6, v73
    v_fmac_f32 v111, v7, v73
    v_fmac_f32 v118, v6, v89
    v_fmac_f32 v119, v7, v89
    s_waitcnt vmcnt(13)
    v_lshlrev_b32 v6, 16, v16
    v_and_b32 v7, 0xffff0000, v16
    v_fmac_f32 v104, v6, v74
    v_fmac_f32 v105, v7, v74
    v_fmac_f32 v112, v6, v90
    v_fmac_f32 v113, v7, v90
    v_lshlrev_b32_e64 v6, 16, v17
    v_and_b32 v7, 0xffff0000, v17
    v_fmac_f32 v106, v6, v74
    v_fmac_f32 v107, v7, v74
    v_fmac_f32 v114, v6, v90
    v_fmac_f32 v115, v7, v90
    v_lshlrev_b32_e64 v6, 16, v18
    v_and_b32 v7, 0xffff0000, v18
    v_fmac_f32 v108, v6, v74
    v_fmac_f32 v109, v7, v74
    v_fmac_f32 v116, v6, v90
    v_fmac_f32 v117, v7, v90
    v_lshlrev_b32_e64 v6, 16, v19
    v_and_b32 v7, 0xffff0000, v19
    v_fmac_f32 v110, v6, v74
    v_fmac_f32 v111, v7, v74
    v_fmac_f32 v118, v6, v90
    v_fmac_f32 v119, v7, v90
    s_waitcnt vmcnt(12)
    v_lshlrev_b32 v6, 16, v20
    v_and_b32 v7, 0xffff0000, v20
    v_fmac_f32 v104, v6, v75
    v_fmac_f32 v105, v7, v75
    v_fmac_f32 v112, v6, v91
    v_fmac_f32 v113, v7, v91
    v_lshlrev_b32_e64 v6, 16, v21
    v_and_b32 v7, 0xffff0000, v21
    v_fmac_f32 v106, v6, v75
    v_fmac_f32 v107, v7, v75
    v_fmac_f32 v114, v6, v91
    v_fmac_f32 v115, v7, v91
    v_lshlrev_b32_e64 v6, 16, v22
    v_and_b32 v7, 0xffff0000, v22
    v_fmac_f32 v108, v6, v75
    v_fmac_f32 v109, v7, v75
    v_fmac_f32 v116, v6, v91
    v_fmac_f32 v117, v7, v91
    v_lshlrev_b32_e64 v6, 16, v23
    v_and_b32 v7, 0xffff0000, v23
    v_fmac_f32 v110, v6, v75
    v_fmac_f32 v111, v7, v75
    v_fmac_f32 v118, v6, v91
    v_fmac_f32 v119, v7, v91
    s_waitcnt vmcnt(11)
    v_lshlrev_b32 v6, 16, v24
    v_and_b32 v7, 0xffff0000, v24
    v_fmac_f32 v104, v6, v76
    v_fmac_f32 v105, v7, v76
    v_fmac_f32 v112, v6, v92
    v_fmac_f32 v113, v7, v92
    v_lshlrev_b32_e64 v6, 16, v25
    v_and_b32 v7, 0xffff0000, v25
    v_fmac_f32 v106, v6, v76
    v_fmac_f32 v107, v7, v76
    v_fmac_f32 v114, v6, v92
    v_fmac_f32 v115, v7, v92
    v_lshlrev_b32_e64 v6, 16, v26
    v_and_b32 v7, 0xffff0000, v26
    v_fmac_f32 v108, v6, v76
    v_fmac_f32 v109, v7, v76
    v_fmac_f32 v116, v6, v92
    v_fmac_f32 v117, v7, v92
    v_lshlrev_b32_e64 v6, 16, v27
    v_and_b32 v7, 0xffff0000, v27
    v_fmac_f32 v110, v6, v76
    v_fmac_f32 v111, v7, v76
    v_fmac_f32 v118, v6, v92
    v_fmac_f32 v119, v7, v92
    s_waitcnt vmcnt(10)
    v_lshlrev_b32 v6, 16, v28
    v_and_b32 v7, 0xffff0000, v28
    v_fmac_f32 v104, v6, v77
    v_fmac_f32 v105, v7, v77
    v_fmac_f32 v112, v6, v93
    v_fmac_f32 v113, v7, v93
    v_lshlrev_b32_e64 v6, 16, v29
    v_and_b32 v7, 0xffff0000, v29
    v_fmac_f32 v106, v6, v77
    v_fmac_f32 v107, v7, v77
    v_fmac_f32 v114, v6, v93
    v_fmac_f32 v115, v7, v93
    v_lshlrev_b32_e64 v6, 16, v30
    v_and_b32 v7, 0xffff0000, v30
    v_fmac_f32 v108, v6, v77
    v_fmac_f32 v109, v7, v77
    v_fmac_f32 v116, v6, v93
    v_fmac_f32 v117, v7, v93
    v_lshlrev_b32_e64 v6, 16, v31
    v_and_b32 v7, 0xffff0000, v31
    v_fmac_f32 v110, v6, v77
    v_fmac_f32 v111, v7, v77
    v_fmac_f32 v118, v6, v93
    v_fmac_f32 v119, v7, v93
    s_waitcnt vmcnt(9)
    v_lshlrev_b32 v6, 16, v32
    v_and_b32 v7, 0xffff0000, v32
    v_fmac_f32 v104, v6, v78
    v_fmac_f32 v105, v7, v78
    v_fmac_f32 v112, v6, v94
    v_fmac_f32 v113, v7, v94
    v_lshlrev_b32_e64 v6, 16, v33
    v_and_b32 v7, 0xffff0000, v33
    v_fmac_f32 v106, v6, v78
    v_fmac_f32 v107, v7, v78
    v_fmac_f32 v114, v6, v94
    v_fmac_f32 v115, v7, v94
    v_lshlrev_b32_e64 v6, 16, v34
    v_and_b32 v7, 0xffff0000, v34
    v_fmac_f32 v108, v6, v78
    v_fmac_f32 v109, v7, v78
    v_fmac_f32 v116, v6, v94
    v_fmac_f32 v117, v7, v94
    v_lshlrev_b32_e64 v6, 16, v35
    v_and_b32 v7, 0xffff0000, v35
    v_fmac_f32 v110, v6, v78
    v_fmac_f32 v111, v7, v78
    v_fmac_f32 v118, v6, v94
    v_fmac_f32 v119, v7, v94
    s_waitcnt vmcnt(8)
    v_lshlrev_b32 v6, 16, v36
    v_and_b32 v7, 0xffff0000, v36
    v_fmac_f32 v104, v6, v79
    v_fmac_f32 v105, v7, v79
    v_fmac_f32 v112, v6, v95
    v_fmac_f32 v113, v7, v95
    v_lshlrev_b32_e64 v6, 16, v37
    v_and_b32 v7, 0xffff0000, v37
    v_fmac_f32 v106, v6, v79
    v_fmac_f32 v107, v7, v79
    v_fmac_f32 v114, v6, v95
    v_fmac_f32 v115, v7, v95
    v_lshlrev_b32_e64 v6, 16, v38
    v_and_b32 v7, 0xffff0000, v38
    v_fmac_f32 v108, v6, v79
    v_fmac_f32 v109, v7, v79
    v_fmac_f32 v116, v6, v95
    v_fmac_f32 v117, v7, v95
    v_lshlrev_b32_e64 v6, 16, v39
    v_and_b32 v7, 0xffff0000, v39
    v_fmac_f32 v110, v6, v79
    v_fmac_f32 v111, v7, v79
    v_fmac_f32 v118, v6, v95
    v_fmac_f32 v119, v7, v95
    s_waitcnt vmcnt(7)
    v_lshlrev_b32 v6, 16, v40
    v_and_b32 v7, 0xffff0000, v40
    v_fmac_f32 v104, v6, v80
    v_fmac_f32 v105, v7, v80
    v_fmac_f32 v112, v6, v96
    v_fmac_f32 v113, v7, v96
    v_lshlrev_b32_e64 v6, 16, v41
    v_and_b32 v7, 0xffff0000, v41
    v_fmac_f32 v106, v6, v80
    v_fmac_f32 v107, v7, v80
    v_fmac_f32 v114, v6, v96
    v_fmac_f32 v115, v7, v96
    v_lshlrev_b32_e64 v6, 16, v42
    v_and_b32 v7, 0xffff0000, v42
    v_fmac_f32 v108, v6, v80
    v_fmac_f32 v109, v7, v80
    v_fmac_f32 v116, v6, v96
    v_fmac_f32 v117, v7, v96
    v_lshlrev_b32_e64 v6, 16, v43
    v_and_b32 v7, 0xffff0000, v43
    v_fmac_f32 v110, v6, v80
    v_fmac_f32 v111, v7, v80
    v_fmac_f32 v118, v6, v96
    v_fmac_f32 v119, v7, v96
    s_waitcnt vmcnt(6)
    v_lshlrev_b32 v6, 16, v44
    v_and_b32 v7, 0xffff0000, v44
    v_fmac_f32 v104, v6, v81
    v_fmac_f32 v105, v7, v81
    v_fmac_f32 v112, v6, v97
    v_fmac_f32 v113, v7, v97
    v_lshlrev_b32_e64 v6, 16, v45
    v_and_b32 v7, 0xffff0000, v45
    v_fmac_f32 v106, v6, v81
    v_fmac_f32 v107, v7, v81
    v_fmac_f32 v114, v6, v97
    v_fmac_f32 v115, v7, v97
    v_lshlrev_b32_e64 v6, 16, v46
    v_and_b32 v7, 0xffff0000, v46
    v_fmac_f32 v108, v6, v81
    v_fmac_f32 v109, v7, v81
    v_fmac_f32 v116, v6, v97
    v_fmac_f32 v117, v7, v97
    v_lshlrev_b32_e64 v6, 16, v47
    v_and_b32 v7, 0xffff0000, v47
    v_fmac_f32 v110, v6, v81
    v_fmac_f32 v111, v7, v81
    v_fmac_f32 v118, v6, v97
    v_fmac_f32 v119, v7, v97
    s_waitcnt vmcnt(5)
    v_lshlrev_b32 v6, 16, v48
    v_and_b32 v7, 0xffff0000, v48
    v_fmac_f32 v104, v6, v82
    v_fmac_f32 v105, v7, v82
    v_fmac_f32 v112, v6, v98
    v_fmac_f32 v113, v7, v98
    v_lshlrev_b32_e64 v6, 16, v49
    v_and_b32 v7, 0xffff0000, v49
    v_fmac_f32 v106, v6, v82
    v_fmac_f32 v107, v7, v82
    v_fmac_f32 v114, v6, v98
    v_fmac_f32 v115, v7, v98
    v_lshlrev_b32_e64 v6, 16, v50
    v_and_b32 v7, 0xffff0000, v50
    v_fmac_f32 v108, v6, v82
    v_fmac_f32 v109, v7, v82
    v_fmac_f32 v116, v6, v98
    v_fmac_f32 v117, v7, v98
    v_lshlrev_b32_e64 v6, 16, v51
    v_and_b32 v7, 0xffff0000, v51
    v_fmac_f32 v110, v6, v82
    v_fmac_f32 v111, v7, v82
    v_fmac_f32 v118, v6, v98
    v_fmac_f32 v119, v7, v98
    s_waitcnt vmcnt(4)
    v_lshlrev_b32 v6, 16, v52
    v_and_b32 v7, 0xffff0000, v52
    v_fmac_f32 v104, v6, v83
    v_fmac_f32 v105, v7, v83
    v_fmac_f32 v112, v6, v99
    v_fmac_f32 v113, v7, v99
    v_lshlrev_b32_e64 v6, 16, v53
    v_and_b32 v7, 0xffff0000, v53
    v_fmac_f32 v106, v6, v83
    v_fmac_f32 v107, v7, v83
    v_fmac_f32 v114, v6, v99
    v_fmac_f32 v115, v7, v99
    v_lshlrev_b32_e64 v6, 16, v54
    v_and_b32 v7, 0xffff0000, v54
    v_fmac_f32 v108, v6, v83
    v_fmac_f32 v109, v7, v83
    v_fmac_f32 v116, v6, v99
    v_fmac_f32 v117, v7, v99
    v_lshlrev_b32_e64 v6, 16, v55
    v_and_b32 v7, 0xffff0000, v55
    v_fmac_f32 v110, v6, v83
    v_fmac_f32 v111, v7, v83
    v_fmac_f32 v118, v6, v99
    v_fmac_f32 v119, v7, v99
    s_waitcnt vmcnt(3)
    v_lshlrev_b32 v6, 16, v56
    v_and_b32 v7, 0xffff0000, v56
    v_fmac_f32 v104, v6, v84
    v_fmac_f32 v105, v7, v84
    v_fmac_f32 v112, v6, v100
    v_fmac_f32 v113, v7, v100
    v_lshlrev_b32_e64 v6, 16, v57
    v_and_b32 v7, 0xffff0000, v57
    v_fmac_f32 v106, v6, v84
    v_fmac_f32 v107, v7, v84
    v_fmac_f32 v114, v6, v100
    v_fmac_f32 v115, v7, v100
    v_lshlrev_b32_e64 v6, 16, v58
    v_and_b32 v7, 0xffff0000, v58
    v_fmac_f32 v108, v6, v84
    v_fmac_f32 v109, v7, v84
    v_fmac_f32 v116, v6, v100
    v_fmac_f32 v117, v7, v100
    v_lshlrev_b32_e64 v6, 16, v59
    v_and_b32 v7, 0xffff0000, v59
    v_fmac_f32 v110, v6, v84
    v_fmac_f32 v111, v7, v84
    v_fmac_f32 v118, v6, v100
    v_fmac_f32 v119, v7, v100
    s_waitcnt vmcnt(2)
    v_lshlrev_b32 v6, 16, v60
    v_and_b32 v7, 0xffff0000, v60
    v_fmac_f32 v104, v6, v85
    v_fmac_f32 v105, v7, v85
    v_fmac_f32 v112, v6, v101
    v_fmac_f32 v113, v7, v101
    v_lshlrev_b32_e64 v6, 16, v61
    v_and_b32 v7, 0xffff0000, v61
    v_fmac_f32 v106, v6, v85
    v_fmac_f32 v107, v7, v85
    v_fmac_f32 v114, v6, v101
    v_fmac_f32 v115, v7, v101
    v_lshlrev_b32_e64 v6, 16, v62
    v_and_b32 v7, 0xffff0000, v62
    v_fmac_f32 v108, v6, v85
    v_fmac_f32 v109, v7, v85
    v_fmac_f32 v116, v6, v101
    v_fmac_f32 v117, v7, v101
    v_lshlrev_b32_e64 v6, 16, v63
    v_and_b32 v7, 0xffff0000, v63
    v_fmac_f32 v110, v6, v85
    v_fmac_f32 v111, v7, v85
    v_fmac_f32 v118, v6, v101
    v_fmac_f32 v119, v7, v101
    s_waitcnt vmcnt(1)
    v_lshlrev_b32 v6, 16, v64
    v_and_b32 v7, 0xffff0000, v64
    v_fmac_f32 v104, v6, v86
    v_fmac_f32 v105, v7, v86
    v_fmac_f32 v112, v6, v102
    v_fmac_f32 v113, v7, v102
    v_lshlrev_b32_e64 v6, 16, v65
    v_and_b32 v7, 0xffff0000, v65
    v_fmac_f32 v106, v6, v86
    v_fmac_f32 v107, v7, v86
    v_fmac_f32 v114, v6, v102
    v_fmac_f32 v115, v7, v102
    v_lshlrev_b32_e64 v6, 16, v66
    v_and_b32 v7, 0xffff0000, v66
    v_fmac_f32 v108, v6, v86
    v_fmac_f32 v109, v7, v86
    v_fmac_f32 v116, v6, v102
    v_fmac_f32 v117, v7, v102
    v_lshlrev_b32_e64 v6, 16, v67
    v_and_b32 v7, 0xffff0000, v67
    v_fmac_f32 v110, v6, v86
    v_fmac_f32 v111, v7, v86
    v_fmac_f32 v118, v6, v102
    v_fmac_f32 v119, v7, v102
    s_waitcnt vmcnt(0)
    v_lshlrev_b32 v6, 16, v68
    v_and_b32 v7, 0xffff0000, v68
    v_fmac_f32 v104, v6, v87
    v_fmac_f32 v105, v7, v87
    v_fmac_f32 v112, v6, v103
    v_fmac_f32 v113, v7, v103
    v_lshlrev_b32_e64 v6, 16, v69
    v_and_b32 v7, 0xffff0000, v69
    v_fmac_f32 v106, v6, v87
    v_fmac_f32 v107, v7, v87
    v_fmac_f32 v114, v6, v103
    v_fmac_f32 v115, v7, v103
    v_lshlrev_b32_e64 v6, 16, v70
    v_and_b32 v7, 0xffff0000, v70
    v_fmac_f32 v108, v6, v87
    v_fmac_f32 v109, v7, v87
    v_fmac_f32 v116, v6, v103
    v_fmac_f32 v117, v7, v103
    v_lshlrev_b32_e64 v6, 16, v71
    v_and_b32 v7, 0xffff0000, v71
    v_fmac_f32 v110, v6, v87
    v_fmac_f32 v111, v7, v87
    v_fmac_f32 v118, v6, v103
    v_fmac_f32_e64 v119, v7, v103
    s_nop 1
    v_add_f32_dpp v104, v104, v104 row_ror:8 row_mask:0xf bank_mask:0xf
    v_add_f32_dpp v105, v105, v105 row_ror:8 row_mask:0xf bank_mask:0xf
    v_add_f32_dpp v106, v106, v106 row_ror:8 row_mask:0xf bank_mask:0xf
    v_add_f32_dpp v107, v107, v107 row_ror:8 row_mask:0xf bank_mask:0xf
    v_add_f32_dpp v108, v108, v108 row_ror:8 row_mask:0xf bank_mask:0xf
    v_add_f32_dpp v109, v109, v109 row_ror:8 row_mask:0xf bank_mask:0xf
    v_add_f32_dpp v110, v110, v110 row_ror:8 row_mask:0xf bank_mask:0xf
    v_add_f32_dpp v111, v111, v111 row_ror:8 row_mask:0xf bank_mask:0xf
    v_add_f32_dpp v112, v112, v112 row_ror:8 row_mask:0xf bank_mask:0xf
    v_add_f32_dpp v113, v113, v113 row_ror:8 row_mask:0xf bank_mask:0xf
    v_add_f32_dpp v114, v114, v114 row_ror:8 row_mask:0xf bank_mask:0xf
    v_add_f32_dpp v115, v115, v115 row_ror:8 row_mask:0xf bank_mask:0xf
    v_add_f32_dpp v116, v116, v116 row_ror:8 row_mask:0xf bank_mask:0xf
    v_add_f32_dpp v117, v117, v117 row_ror:8 row_mask:0xf bank_mask:0xf
    v_add_f32_dpp v118, v118, v118 row_ror:8 row_mask:0xf bank_mask:0xf
    v_add_f32_dpp v119, v119, v119 row_ror:8 row_mask:0xf bank_mask:0xf
    v_mov_b32 v8, v104
    v_mov_b32 v9, v105
    v_mov_b32 v10, v106
    v_mov_b32 v11, v107
    v_mov_b32 v12, v108
    v_mov_b32 v13, v109
    v_mov_b32 v14, v110
    v_mov_b32 v15, v111
    v_mov_b32 v16, v112
    v_mov_b32 v17, v113
    v_mov_b32 v18, v114
    v_mov_b32 v19, v115
    v_mov_b32 v20, v116
    v_mov_b32 v21, v117
    v_mov_b32 v22, v118
    v_mov_b32 v23, v119
    s_nop 1
    v_permlane16_swap_b32 v104, v8
    v_permlane16_swap_b32 v105, v9
    v_permlane16_swap_b32 v106, v10
    v_permlane16_swap_b32 v107, v11
    v_permlane16_swap_b32 v108, v12
    v_permlane16_swap_b32 v109, v13
    v_permlane16_swap_b32 v110, v14
    v_permlane16_swap_b32 v111, v15
    v_permlane16_swap_b32 v112, v16
    v_permlane16_swap_b32 v113, v17
    v_permlane16_swap_b32 v114, v18
    v_permlane16_swap_b32 v115, v19
    v_permlane16_swap_b32 v116, v20
    v_permlane16_swap_b32 v117, v21
    v_permlane16_swap_b32 v118, v22
    v_permlane16_swap_b32 v119, v23
    s_nop 1
    v_add_f32 v104, v104, v8
    v_add_f32 v105, v105, v9
    v_add_f32 v106, v106, v10
    v_add_f32 v107, v107, v11
    v_add_f32 v108, v108, v12
    v_add_f32 v109, v109, v13
    v_add_f32 v110, v110, v14
    v_add_f32 v111, v111, v15
    v_add_f32 v112, v112, v16
    v_add_f32 v113, v113, v17
    v_add_f32 v114, v114, v18
    v_add_f32 v115, v115, v19
    v_add_f32 v116, v116, v20
    v_add_f32 v117, v117, v21
    v_add_f32 v118, v118, v22
    v_add_f32 v119, v119, v23
    v_mov_b32 v8, v104
    v_mov_b32 v9, v105
    v_mov_b32 v10, v106
    v_mov_b32 v11, v107
    v_mov_b32 v12, v108
    v_mov_b32 v13, v109
    v_mov_b32 v14, v110
    v_mov_b32 v15, v111
    v_mov_b32 v16, v112
    v_mov_b32 v17, v113
    v_mov_b32 v18, v114
    v_mov_b32 v19, v115
    v_mov_b32 v20, v116
    v_mov_b32 v21, v117
    v_mov_b32 v22, v118
    v_mov_b32 v23, v119
    s_nop 1
    v_permlane32_swap_b32 v104, v8
    v_permlane32_swap_b32 v105, v9
    v_permlane32_swap_b32 v106, v10
    v_permlane32_swap_b32 v107, v11
    v_permlane32_swap_b32 v108, v12
    v_permlane32_swap_b32 v109, v13
    v_permlane32_swap_b32 v110, v14
    v_permlane32_swap_b32 v111, v15
    v_permlane32_swap_b32 v112, v16
    v_permlane32_swap_b32 v113, v17
    v_permlane32_swap_b32 v114, v18
    v_permlane32_swap_b32 v115, v19
    v_permlane32_swap_b32 v116, v20
    v_permlane32_swap_b32 v117, v21
    v_permlane32_swap_b32 v118, v22
    v_permlane32_swap_b32 v119, v23
    s_nop 1
    v_add_f32 v104, v104, v8
    v_add_f32 v105, v105, v9
    v_add_f32 v106, v106, v10
    v_add_f32 v107, v107, v11
    v_add_f32 v108, v108, v12
    v_add_f32 v109, v109, v13
    v_add_f32 v110, v110, v14
    v_add_f32 v111, v111, v15
    v_add_f32 v112, v112, v16
    v_add_f32 v113, v113, v17
    v_add_f32 v114, v114, v18
    v_add_f32 v115, v115, v19
    v_add_f32 v116, v116, v20
    v_add_f32 v117, v117, v21
    v_add_f32 v118, v118, v22
    v_add_f32 v119, v119, v23
    s_lshl_b32 s47, s46, 9
    s_add_u32 s47, s47, s50
    v_lshl_add_u32 v2, v3, 5, s47
    v_cmp_gt_u32 vcc, 8, v1
    s_and_saveexec_b64 s[48:49], vcc
    ds_write_b128 v2, v[104:107]
    ds_write_b128 v2, v[108:111] offset:16
    ds_write_b128 v2, v[112:115] offset:256
    ds_write_b128 v2, v[116:119] offset:272
    s_mov_b64 exec, s[48:49]
    s_waitcnt lgkmcnt(0)
    s_barrier
    s_cmp_ge_u32 s46, 2
    s_cbranch_scc1 L_mp0_uwskip43
    s_nop 0
    v_lshl_add_u32 v2, v0, 2, s50
    ds_read_b32 v8, v2 offset:0
    ds_read_b32 v9, v2 offset:512
    ds_read_b32 v10, v2 offset:1024
    ds_read_b32 v11, v2 offset:1536
    ds_read_b32 v12, v2 offset:2048
    ds_read_b32 v13, v2 offset:2560
    ds_read_b32 v14, v2 offset:3072
    ds_read_b32 v15, v2 offset:3584
    s_waitcnt lgkmcnt(0)
    v_add_f32 v8, v8, v9
    v_add_f32 v8, v8, v10
    v_add_f32 v8, v8, v11
    v_add_f32 v8, v8, v12
    v_add_f32 v8, v8, v13
    v_add_f32 v8, v8, v14
    v_add_f32 v8, v8, v15
    v_min_u32 v8, -2, v8
    v_lshlrev_b32_e64 v2, 2, v1
    s_lshl_b32 s31, s30, 8
    s_lshl_b32 s47, s46, 14
    s_add_u32 s31, s31, s47
    s_add_u32 s31, s31, 32768
    buffer_store_dword v8, v2, s[40:43], s31 offen sc1
    s_waitcnt vmcnt(0)
L_mp0_uwskip43:
    s_add_u32 s30, s30, 1
    s_add_u32 s50, s50, 4096
    s_cmp_lt_u32 s50, 163840
    s_cbranch_scc1 L_mp0_uw42
L_win_pfe:
    s_waitcnt vmcnt(0)
    s_mov_b64 exec, -1
    s_setprio 0
    s_branch L_wsp_entry
L_wsp_entry:
    v_and_b32 v1, 63, v0
    s_mov_b32 s46, s3
    s_and_b32 s47, s2, 7
    s_lshr_b32 s48, s2, 3
    s_and_b32 s30, s47, 3
    s_lshl_b32 s30, s30, 2
    s_and_b32 s49, s48, 3
    s_add_u32 s30, s30, s49
    s_lshr_b32 s31, s47, 2
    s_mul_i32 s31, s31, 7
    s_lshr_b32 s49, s48, 2
    s_add_u32 s31, s31, s49
    s_lshl_b32 s100, s30, 8
    s_lshl_b32 s101, s31, 4
    s_add_u32 s100, s100, s101
    s_add_u32 s100, s100, 40960
    s_lshl_b32 s87, s100, 5
    s_cmp_ge_u32 s2, 224
    s_cbranch_scc1 L_wsp_pf
    s_cmp_ge_u32 s46, 4
    s_cbranch_scc1 L_wsp_comp
    s_mul_i32 s50, s30, 524288
    s_mul_i32 s51, s46, 131072
    s_add_u32 s50, s50, s51
    v_lshrrev_b32 v2, 3, v1
    v_lshl_add_u32 v2, v2, 12, s50
    v_and_b32 v3, 7, v1
    v_lshrrev_b32 v4, 4, v1
    v_xor_b32_e64 v5, v4, v3
    v_lshl_add_u32 v8, v5, 4, v2
    v_xor_b32_e64 v5, 64, v8
    v_add_u32 v9, 32768, v5
    v_add_u32 v10, 65536, v8
    v_add_u32 v11, 65536, v9
    v_lshrrev_b32_e64 v2, 4, v1
    v_bfe_u32 v3, v1, 2, 2
    v_and_b32 v4, 3, v1
    v_and_b32 v5, 2, v2
    v_xor_b32_e64 v3, v3, v5
    v_lshl_add_u32 v5, v2, 2, v4
    v_lshlrev_b32_e64 v5, 4, v5
    v_lshl_add_u32 v5, v3, 9, v5
    s_lshr_b32 s50, s46, 1
    s_mul_i32 s50, s50, 114688
    s_and_b32 s51, s46, 1
    s_lshl_b32 s51, s51, 8
    s_add_u32 s50, s50, s51
    s_mul_i32 s51, s31, 8192
    s_add_u32 s50, s50, s51
    v_add_u32 v12, s50, v5
    v_add_u32 v13, 2048, v12
    v_add_u32 v14, 4096, v12
    v_add_u32 v15, 6144, v12
    s_mul_i32 s55, s46, 4096
    s_mul_i32 s56, s46, 4096
    s_add_u32 s56, s56, 16384
    s_waitcnt lgkmcnt(0)
    s_add_u32 s36, s28, 0x2400000
    s_addc_u32 s37, s29, 0
    s_and_b32 s37, s37, 0xffff
    s_mov_b32 s38, 0x700000
    s_mov_b32 s39, 0x20000
    s_mov_b32 s32, s14
    s_and_b32 s33, s15, 0xffff
    s_mov_b32 s34, 0x800000
    s_mov_b32 s35, 0x20000
    s_mul_i32 s54, s31, 1
    s_add_u32 s54, s54, s30
    s_lshl_b32 s68, s30, 1
    s_and_b32 s54, s54, 1
    s_add_u32 s57, s68, 0
    s_mul_i32 s57, s57, 128
    s_add_u32 m0, s55, 0
    s_nop 0
    buffer_load_dwordx4 v8, s[32:35], s57 offen lds
    s_add_u32 m0, s55, 1024
    s_nop 0
    buffer_load_dwordx4 v9, s[32:35], s57 offen lds
    s_add_u32 m0, s55, 2048
    s_nop 0
    buffer_load_dwordx4 v10, s[32:35], s57 offen lds
    s_add_u32 m0, s55, 3072
    s_nop 0
    buffer_load_dwordx4 v11, s[32:35], s57 offen lds
    s_add_u32 s57, s68, 1
    s_mul_i32 s57, s57, 128
    s_add_u32 m0, s55, 32768
    s_nop 0
    buffer_load_dwordx4 v8, s[32:35], s57 offen lds
    s_add_u32 m0, s55, 33792
    s_nop 0
    buffer_load_dwordx4 v9, s[32:35], s57 offen lds
    s_add_u32 m0, s55, 34816
    s_nop 0
    buffer_load_dwordx4 v10, s[32:35], s57 offen lds
    s_add_u32 m0, s55, 35840
    s_nop 0
    buffer_load_dwordx4 v11, s[32:35], s57 offen lds
    s_cmp_le_u32 s68, 0
    s_cselect_b32 s57, 2, 0
    s_xor_b32 s57, s57, s54
    s_mul_i32 s57, s57, 128
    s_add_u32 m0, s55, 65536
    s_nop 0
    buffer_load_dwordx4 v8, s[32:35], s57 offen lds
    s_add_u32 m0, s55, 66560
    s_nop 0
    buffer_load_dwordx4 v9, s[32:35], s57 offen lds
    s_add_u32 m0, s55, 67584
    s_nop 0
    buffer_load_dwordx4 v10, s[32:35], s57 offen lds
    s_add_u32 m0, s55, 68608
    s_nop 0
    buffer_load_dwordx4 v11, s[32:35], s57 offen lds
    s_cmp_le_u32 s68, 1
    s_cselect_b32 s57, 3, 1
    s_xor_b32 s57, s57, s54
    s_mul_i32 s57, s57, 128
    s_add_u32 m0, s55, 98304
    s_nop 0
    buffer_load_dwordx4 v8, s[32:35], s57 offen lds
    s_add_u32 m0, s55, 99328
    s_nop 0
    buffer_load_dwordx4 v9, s[32:35], s57 offen lds
    s_add_u32 m0, s55, 100352
    s_nop 0
    buffer_load_dwordx4 v10, s[32:35], s57 offen lds
    s_add_u32 m0, s55, 101376
    s_nop 0
    buffer_load_dwordx4 v11, s[32:35], s57 offen lds
    s_barrier
    s_cmp_le_u32 s68, 0
    s_cselect_b32 s57, 2, 0
    s_xor_b32 s57, s57, s54
    s_mul_i32 s57, s57, 229376
    s_add_u32 m0, s56, 65536
    s_nop 0
    buffer_load_dwordx4 v12, s[36:39], s57 offen sc1 lds
    s_add_u32 m0, s56, 66560
    s_nop 0
    buffer_load_dwordx4 v13, s[36:39], s57 offen sc1 lds
    s_add_u32 m0, s56, 67584
    s_nop 0
    buffer_load_dwordx4 v14, s[36:39], s57 offen sc1 lds
    s_add_u32 m0, s56, 68608
    s_nop 0
    buffer_load_dwordx4 v15, s[36:39], s57 offen sc1 lds
    s_waitcnt vmcnt(16)
    s_barrier
    s_cmp_le_u32 s68, 1
    s_cselect_b32 s57, 3, 1
    s_xor_b32 s57, s57, s54
    s_mul_i32 s57, s57, 229376
    s_add_u32 m0, s56, 98304
    s_nop 0
    buffer_load_dwordx4 v12, s[36:39], s57 offen sc1 lds
    s_add_u32 m0, s56, 99328
    s_nop 0
    buffer_load_dwordx4 v13, s[36:39], s57 offen sc1 lds
    s_add_u32 m0, s56, 100352
    s_nop 0
    buffer_load_dwordx4 v14, s[36:39], s57 offen sc1 lds
    s_add_u32 m0, s56, 101376
    s_nop 0
    buffer_load_dwordx4 v15, s[36:39], s57 offen sc1 lds
    s_waitcnt vmcnt(16)
    s_barrier
    s_waitcnt vmcnt(4)
    s_barrier
    s_cmp_le_u32 s68, 2
    s_cselect_b32 s57, 4, 2
    s_xor_b32 s57, s57, s54
    s_mul_i32 s57, s57, 229376
    s_add_u32 m0, s56, 0
    s_nop 0
    buffer_load_dwordx4 v12, s[36:39], s57 offen sc1 lds
    s_add_u32 m0, s56, 1024
    s_nop 0
    buffer_load_dwordx4 v13, s[36:39], s57 offen sc1 lds
    s_add_u32 m0, s56, 2048
    s_nop 0
    buffer_load_dwordx4 v14, s[36:39], s57 offen sc1 lds
    s_add_u32 m0, s56, 3072
    s_nop 0
    buffer_load_dwordx4 v15, s[36:39], s57 offen sc1 lds
    s_cmp_le_u32 s68, 2
    s_cselect_b32 s57, 4, 2
    s_xor_b32 s57, s57, s54
    s_mul_i32 s57, s57, 128
    s_add_u32 m0, s55, 0
    s_nop 0
    buffer_load_dwordx4 v8, s[32:35], s57 offen lds
    s_add_u32 m0, s55, 1024
    s_nop 0
    buffer_load_dwordx4 v9, s[32:35], s57 offen lds
    s_add_u32 m0, s55, 2048
    s_nop 0
    buffer_load_dwordx4 v10, s[32:35], s57 offen lds
    s_add_u32 m0, s55, 3072
    s_nop 0
    buffer_load_dwordx4 v11, s[32:35], s57 offen lds
    s_waitcnt vmcnt(8)
    s_barrier
    s_cmp_le_u32 s68, 3
    s_cselect_b32 s57, 5, 3
    s_xor_b32 s57, s57, s54
    s_mul_i32 s57, s57, 229376
    s_add_u32 m0, s56, 32768
    s_nop 0
    buffer_load_dwordx4 v12, s[36:39], s57 offen sc1 lds
    s_add_u32 m0, s56, 33792
    s_nop 0
    buffer_load_dwordx4 v13, s[36:39], s57 offen sc1 lds
    s_add_u32 m0, s56, 34816
    s_nop 0
    buffer_load_dwordx4 v14, s[36:39], s57 offen sc1 lds
    s_add_u32 m0, s56, 35840
    s_nop 0
    buffer_load_dwordx4 v15, s[36:39], s57 offen sc1 lds
    s_cmp_le_u32 s68, 3
    s_cselect_b32 s57, 5, 3
    s_xor_b32 s57, s57, s54
    s_mul_i32 s57, s57, 128
    s_add_u32 m0, s55, 32768
    s_nop 0
    buffer_load_dwordx4 v8, s[32:35], s57 offen lds
    s_add_u32 m0, s55, 33792
    s_nop 0
    buffer_load_dwordx4 v9, s[32:35], s57 offen lds
    s_add_u32 m0, s55, 34816
    s_nop 0
    buffer_load_dwordx4 v10, s[32:35], s57 offen lds
    s_add_u32 m0, s55, 35840
    s_nop 0
    buffer_load_dwordx4 v11, s[32:35], s57 offen lds
    s_add_u32 s60, s55, 131072
    s_add_u32 s55, s55, 65536
    s_add_u32 s56, s56, 65536
    s_mov_b32 s57, 768
    s_mov_b32 s58, 1376256
    s_mov_b32 s59, 6
L_wsp_lloop:
    s_sub_u32 s57, s59, 2
    s_cmp_le_u32 s68, s57
    s_cselect_b32 s57, s59, s57
    s_xor_b32 s57, s57, s54
    s_mul_i32 s58, s57, 229376
    s_mul_i32 s57, s57, 128
    s_waitcnt vmcnt(8)
    s_barrier
    s_add_u32 m0, s56, 0
    s_nop 0
    buffer_load_dwordx4 v12, s[36:39], s58 offen sc1 lds
    s_add_u32 m0, s56, 1024
    s_nop 0
    buffer_load_dwordx4 v13, s[36:39], s58 offen sc1 lds
    s_add_u32 m0, s56, 2048
    s_nop 0
    buffer_load_dwordx4 v14, s[36:39], s58 offen sc1 lds
    s_add_u32 m0, s56, 3072
    s_nop 0
    buffer_load_dwordx4 v15, s[36:39], s58 offen sc1 lds
    s_add_u32 m0, s55, 0
    s_nop 0
    buffer_load_dwordx4 v8, s[32:35], s57 offen lds
    s_add_u32 m0, s55, 1024
    s_nop 0
    buffer_load_dwordx4 v9, s[32:35], s57 offen lds
    s_add_u32 m0, s55, 2048
    s_nop 0
    buffer_load_dwordx4 v10, s[32:35], s57 offen lds
    s_add_u32 m0, s55, 3072
    s_nop 0
    buffer_load_dwordx4 v11, s[32:35], s57 offen lds
    s_add_u32 s57, s57, 128
    s_add_u32 s58, s58, 229376
    s_add_u32 s55, s55, 32768
    s_add_u32 s56, s56, 32768
    s_cmp_eq_u32 s55, s60
    s_cselect_b32 s61, 131072, 0
    s_sub_u32 s55, s55, s61
    s_sub_u32 s56, s56, s61
    s_add_u32 s59, s59, 1
    s_cmp_lt_u32 s59, 32
    s_cbranch_scc1 L_wsp_lloop
    s_and_b32 s44, s46, 1
    s_lshl_b32 s44, s44, 13
    s_cmp_ge_u32 s2, 32
    s_cbranch_scc1 L_mp0_ct44
    s_getpc_b64 s[64:65]
L_mp0_pc45:
    s_add_u32 s64, s64, L_wsp_epi-L_mp0_pc45
    s_addc_u32 s65, s65, 0
    v_and_b32_e64 v60, 63, v0
    v_lshl_add_u32 v60, v60, 7, s44
    v_min_u32 v60, L_text_end-L_wsp_epi-4, v60
    v_mov_b32 v61, s65
    v_add_co_u32 v60, vcc, s64, v60
    s_nop 1
    v_addc_co_u32 v61, vcc, 0, v61, vcc
    global_load_dword v62, v[60:61], off
L_mp0_ct44:
    s_waitcnt vmcnt(8)
    s_barrier
    s_waitcnt vmcnt(0)
    s_barrier
    s_barrier
    s_waitcnt vmcnt(0)
    s_mov_b64 exec, -1
    s_setprio 0
    s_branch L_wout_entry
L_wsp_comp:
    s_setprio 1
    s_sub_u32 s46, s46, 4
    s_lshr_b32 s50, s46, 1
    s_and_b32 s51, s46, 1
    v_and_b32 v3, 31, v1
    v_lshrrev_b32 v4, 5, v1
    v_and_b32 v5, 15, v1
    v_lshrrev_b32_e64 v6, 4, v1
    s_mul_i32 s52, s50, 8192
    v_lshl_add_u32 v2, v5, 7, s52
    v_lshrrev_b32 v5, 1, v5
    v_add_u32 v7, 0, v6
    v_xor_b32_e64 v7, v7, v5
    v_lshl_add_u32 v200, v7, 4, v2
    v_add_u32 v7, 4, v6
    v_xor_b32 v7, v7, v5
    v_lshl_add_u32 v201, v7, 4, v2
    v_mul_u32_u24 v5, 4096, v4
    v_and_b32_e64 v6, 1, v6
    v_lshl_add_u32 v5, v6, 9, v5
    v_lshl_add_u32 v5, v6, 7, v5
    v_bfe_u32 v6, v1, 2, 2
    v_lshl_add_u32 v5, v6, 4, v5
    v_bfe_u32 v6, v1, 1, 1
    v_lshl_add_u32 v5, v6, 6, v5
    v_and_b32_e64 v6, 1, v1
    v_lshl_add_u32 v5, v6, 3, v5
    s_mul_i32 s52, s51, 2048
    s_add_u32 s52, s52, 16384
    v_add_u32_e64 v204, s52, v5
    v_xor_b32 v205, 128, v204
    s_waitcnt lgkmcnt(0)
    s_add_u32 s36, s28, 0x3200000
    s_addc_u32 s37, s29, 0
    s_and_b32 s37, s37, 0xffff
    s_mov_b32 s38, 0x700000
    s_mov_b32 s39, 0x20000
    s_mov_b32 s40, s16
    s_and_b32 s41, s17, 0xffff
    s_mov_b32 s42, 0x1000
    s_mov_b32 s43, 0x20000
    v_lshlrev_b32_e64 v208, 4, v1
    s_lshl_b32 s60, s31, 13
    s_lshl_b32 s61, s51, 12
    s_add_u32 s60, s60, s61
    s_lshl_b32 s61, s30, 2
    s_lshl_b32 s62, s50, 1
    s_add_u32 s61, s61, s62
    s_lshl_b32 s63, s61, 6
    s_mul_i32 s61, s61, 114688
    s_add_u32 s60, s60, s61
    s_add_u32 s61, s60, 114688
    v_lshlrev_b32 v209, 1, v3
    v_lshlrev_b32 v244, 16, v244
    v_lshlrev_b32 v245, 16, v245
    v_lshlrev_b32 v246, 16, v246
    v_lshlrev_b32 v247, 16, v247
    v_mov_b32 v8, v244
    v_mov_b32 v9, v244
    v_mov_b32 v10, v244
    v_mov_b32 v11, v244
    v_mov_b32 v12, v245
    v_mov_b32 v13, v245
    v_mov_b32 v14, v245
    v_mov_b32 v15, v245
    v_mov_b32 v16, v244
    v_mov_b32 v17, v244
    v_mov_b32 v18, v244
    v_mov_b32 v19, v244
    v_mov_b32 v20, v245
    v_mov_b32 v21, v245
    v_mov_b32 v22, v245
    v_mov_b32 v23, v245
    v_mov_b32 v24, v244
    v_mov_b32 v25, v244
    v_mov_b32 v26, v244
    v_mov_b32 v27, v244
    v_mov_b32 v28, v245
    v_mov_b32 v29, v245
    v_mov_b32 v30, v245
    v_mov_b32 v31, v245
    v_mov_b32 v32, v244
    v_mov_b32 v33, v244
    v_mov_b32 v34, v244
    v_mov_b32 v35, v244
    v_mov_b32 v36, v245
    v_mov_b32 v37, v245
    v_mov_b32 v38, v245
    v_mov_b32 v39, v245
    v_mov_b32 v40, v246
    v_mov_b32 v41, v246
    v_mov_b32 v42, v246
    v_mov_b32 v43, v246
    v_mov_b32 v44, v247
    v_mov_b32 v45, v247
    v_mov_b32 v46, v247
    v_mov_b32 v47, v247
    v_mov_b32 v48, v246
    v_mov_b32 v49, v246
    v_mov_b32 v50, v246
    v_mov_b32 v51, v246
    v_mov_b32 v52, v247
    v_mov_b32 v53, v247
    v_mov_b32 v54, v247
    v_mov_b32 v55, v247
    v_mov_b32 v56, v246
    v_mov_b32 v57, v246
    v_mov_b32 v58, v246
    v_mov_b32 v59, v246
    v_mov_b32 v60, v247
    v_mov_b32 v61, v247
    v_mov_b32 v62, v247
    v_mov_b32 v63, v247
    v_mov_b32 v64, v246
    v_mov_b32 v65, v246
    v_mov_b32 v66, v246
    v_mov_b32 v67, v246
    v_mov_b32 v68, v247
    v_mov_b32 v69, v247
    v_mov_b32 v70, v247
    v_mov_b32 v71, v247
    s_mov_b32 s53, 0
    v_add_u32 v202, s53, v200
    v_add_u32 v203, s53, v201
    v_add_u32 v206, s53, v204
    v_add_u32_e64 v207, s53, v205
    s_cmp_lg_u32 s3, 4
    s_cbranch_scc1 L_mp0_wd46
    s_add_u32 s96, s28, 0x3a00000
    s_addc_u32 s97, s29, 0
    s_and_b32 s97, s97, 0xffff
    s_mov_b32 s98, 0x200000
    s_mov_b32 s99, 0x20000
    s_lshl_b32 s100, s31, 8
    s_add_u32 s100, s100, 32768
    s_lshl_b32 s100, s100, 5
    v_lshlrev_b32 v254, 7, v1
    s_mov_b32 s101, 0x100000
L_mp0_wf47:
    buffer_load_dwordx2 v[252:253], v254, s[96:99], s100 offen sc1
    s_waitcnt vmcnt(0)
    v_cmp_ne_u64 vcc, s[84:85], v[252:253]
    s_sub_u32 s101, s101, 1
    s_nop 3
    s_cbranch_vccz L_mp0_we48
    s_mov_b64 exec, vcc
    s_sleep 1
    s_cmp_lg_u32 s101, 0
    s_cbranch_scc1 L_mp0_wf47
L_mp0_we48:
    s_mov_b64 exec, -1
L_mp0_wd46:
    s_barrier
    s_barrier
    ds_read_b128 v[136:139], v202 offset:0
    ds_read_b64_tr_b16 v[168:169], v206 offset:0
    ds_read_b64_tr_b16 v[170:171], v206 offset:256
    ds_read_b128 v[140:143], v202 offset:2048
    ds_read_b128 v[144:147], v202 offset:4096
    ds_read_b128 v[148:151], v202 offset:6144
    ds_read_b64_tr_b16 v[172:173], v207 offset:0
    ds_read_b64_tr_b16 v[174:175], v207 offset:256
    ds_read_b64_tr_b16 v[176:177], v206 offset:1024
    ds_read_b64_tr_b16 v[178:179], v206 offset:1280
    ds_read_b64_tr_b16 v[180:181], v207 offset:1024
    ds_read_b64_tr_b16 v[182:183], v207 offset:1280
    s_waitcnt lgkmcnt(9)
    v_mfma_f32_16x16x32_bf16 v[8:11], v[168:171], v[136:139], v[8:11]
    ds_read_b128 v[152:155], v203 offset:0
    s_waitcnt lgkmcnt(9)
    v_mfma_f32_16x16x32_bf16 v[12:15], v[168:171], v[140:143], v[12:15]
    ds_read_b64_tr_b16 v[184:185], v206 offset:8192
    s_waitcnt lgkmcnt(9)
    v_mfma_f32_16x16x32_bf16 v[40:43], v[168:171], v[144:147], v[40:43]
    ds_read_b64_tr_b16 v[186:187], v206 offset:8448
    s_waitcnt lgkmcnt(9)
    v_mfma_f32_16x16x32_bf16 v[44:47], v[168:171], v[148:151], v[44:47]
    ds_read_b128 v[156:159], v203 offset:2048
    s_waitcnt lgkmcnt(8)
    s_nop 0
    v_mfma_f32_16x16x32_bf16 v[16:19], v[172:175], v[136:139], v[16:19]
    ds_read_b128 v[160:163], v203 offset:4096
    v_mfma_f32_16x16x32_bf16 v[20:23], v[172:175], v[140:143], v[20:23]
    ds_read_b128 v[164:167], v203 offset:6144
    v_mfma_f32_16x16x32_bf16 v[48:51], v[172:175], v[144:147], v[48:51]
    ds_read_b64_tr_b16 v[188:189], v207 offset:8192
    v_mfma_f32_16x16x32_bf16 v[52:55], v[172:175], v[148:151], v[52:55]
    ds_read_b64_tr_b16 v[190:191], v207 offset:8448
    s_waitcnt lgkmcnt(9)
    s_nop 0
    v_mfma_f32_16x16x32_bf16 v[24:27], v[176:179], v[136:139], v[24:27]
    ds_read_b64_tr_b16 v[192:193], v206 offset:9216
    v_mfma_f32_16x16x32_bf16 v[28:31], v[176:179], v[140:143], v[28:31]
    ds_read_b64_tr_b16 v[194:195], v206 offset:9472
    v_mfma_f32_16x16x32_bf16 v[56:59], v[176:179], v[144:147], v[56:59]
    ds_read_b64_tr_b16 v[196:197], v207 offset:9216
    v_mfma_f32_16x16x32_bf16 v[60:63], v[176:179], v[148:151], v[60:63]
    ds_read_b64_tr_b16 v[198:199], v207 offset:9472
    s_waitcnt lgkmcnt(9)
    v_mfma_f32_16x16x32_bf16 v[32:35], v[180:183], v[136:139], v[32:35]
    s_add_u32 s53, s53, 32768
    s_cmp_eq_u32 s53, 131072
    v_mfma_f32_16x16x32_bf16 v[36:39], v[180:183], v[140:143], v[36:39]
    s_cselect_b32 s53, 0, s53
    v_add_u32_e64 v202, s53, v200
    v_mfma_f32_16x16x32_bf16 v[64:67], v[180:183], v[144:147], v[64:67]
    v_add_u32 v203, s53, v201
    v_add_u32 v206, s53, v204
    v_mfma_f32_16x16x32_bf16 v[68:71], v[180:183], v[148:151], v[68:71]
    v_add_u32_e64 v207, s53, v205
    s_barrier
    s_waitcnt lgkmcnt(9)
    v_mfma_f32_16x16x32_bf16 v[8:11], v[184:187], v[152:155], v[8:11]
    ds_read_b128 v[136:139], v202 offset:0
    s_waitcnt lgkmcnt(9)
    v_mfma_f32_16x16x32_bf16 v[12:15], v[184:187], v[156:159], v[12:15]
    ds_read_b64_tr_b16 v[168:169], v206 offset:0
    s_waitcnt lgkmcnt(9)
    v_mfma_f32_16x16x32_bf16 v[40:43], v[184:187], v[160:163], v[40:43]
    ds_read_b64_tr_b16 v[170:171], v206 offset:256
    s_waitcnt lgkmcnt(9)
    v_mfma_f32_16x16x32_bf16 v[44:47], v[184:187], v[164:167], v[44:47]
    s_waitcnt lgkmcnt(7)
    v_mfma_f32_16x16x32_bf16 v[16:19], v[188:191], v[152:155], v[16:19]
    ds_read_b128 v[140:143], v202 offset:2048
    v_mfma_f32_16x16x32_bf16 v[20:23], v[188:191], v[156:159], v[20:23]
    ds_read_b128 v[144:147], v202 offset:4096
    v_mfma_f32_16x16x32_bf16 v[48:51], v[188:191], v[160:163], v[48:51]
    ds_read_b128 v[148:151], v202 offset:6144
    v_mfma_f32_16x16x32_bf16 v[52:55], v[188:191], v[164:167], v[52:55]
    s_waitcnt lgkmcnt(8)
    v_mfma_f32_16x16x32_bf16 v[24:27], v[192:195], v[152:155], v[24:27]
    ds_read_b64_tr_b16 v[172:173], v207 offset:0
    v_mfma_f32_16x16x32_bf16 v[28:31], v[192:195], v[156:159], v[28:31]
    ds_read_b64_tr_b16 v[174:175], v207 offset:256
    v_mfma_f32_16x16x32_bf16 v[56:59], v[192:195], v[160:163], v[56:59]
    ds_read_b64_tr_b16 v[176:177], v206 offset:1024
    v_mfma_f32_16x16x32_bf16 v[60:63], v[192:195], v[164:167], v[60:63]
    s_waitcnt lgkmcnt(9)
    v_mfma_f32_16x16x32_bf16 v[32:35], v[196:199], v[152:155], v[32:35]
    ds_read_b64_tr_b16 v[178:179], v206 offset:1280
    v_mfma_f32_16x16x32_bf16 v[36:39], v[196:199], v[156:159], v[36:39]
    ds_read_b64_tr_b16 v[180:181], v207 offset:1024
    v_mfma_f32_16x16x32_bf16 v[64:67], v[196:199], v[160:163], v[64:67]
    ds_read_b64_tr_b16 v[182:183], v207 offset:1280
    v_mfma_f32_16x16x32_bf16 v[68:71], v[196:199], v[164:167], v[68:71]
    s_mov_b32 s54, 15
L_wsp_loop:
    s_waitcnt lgkmcnt(9)
    v_mfma_f32_16x16x32_bf16 v[8:11], v[168:171], v[136:139], v[8:11]
    ds_read_b128 v[152:155], v203 offset:0
    s_waitcnt lgkmcnt(9)
    v_mfma_f32_16x16x32_bf16 v[12:15], v[168:171], v[140:143], v[12:15]
    ds_read_b64_tr_b16 v[184:185], v206 offset:8192
    s_waitcnt lgkmcnt(9)
    v_mfma_f32_16x16x32_bf16 v[40:43], v[168:171], v[144:147], v[40:43]
    ds_read_b64_tr_b16 v[186:187], v206 offset:8448
    s_waitcnt lgkmcnt(9)
    v_mfma_f32_16x16x32_bf16 v[44:47], v[168:171], v[148:151], v[44:47]
    ds_read_b128 v[156:159], v203 offset:2048
    s_waitcnt lgkmcnt(8)
    v_mfma_f32_16x16x32_bf16 v[16:19], v[172:175], v[136:139], v[16:19]
    ds_read_b128 v[160:163], v203 offset:4096
    v_mfma_f32_16x16x32_bf16 v[20:23], v[172:175], v[140:143], v[20:23]
    ds_read_b128 v[164:167], v203 offset:6144
    v_mfma_f32_16x16x32_bf16 v[48:51], v[172:175], v[144:147], v[48:51]
    ds_read_b64_tr_b16 v[188:189], v207 offset:8192
    v_mfma_f32_16x16x32_bf16 v[52:55], v[172:175], v[148:151], v[52:55]
    ds_read_b64_tr_b16 v[190:191], v207 offset:8448
    s_waitcnt lgkmcnt(9)
    s_nop 0
    v_mfma_f32_16x16x32_bf16 v[24:27], v[176:179], v[136:139], v[24:27]
    ds_read_b64_tr_b16 v[192:193], v206 offset:9216
    v_mfma_f32_16x16x32_bf16 v[28:31], v[176:179], v[140:143], v[28:31]
    ds_read_b64_tr_b16 v[194:195], v206 offset:9472
    v_mfma_f32_16x16x32_bf16 v[56:59], v[176:179], v[144:147], v[56:59]
    ds_read_b64_tr_b16 v[196:197], v207 offset:9216
    v_mfma_f32_16x16x32_bf16 v[60:63], v[176:179], v[148:151], v[60:63]
    ds_read_b64_tr_b16 v[198:199], v207 offset:9472
    s_waitcnt lgkmcnt(9)
    v_mfma_f32_16x16x32_bf16 v[32:35], v[180:183], v[136:139], v[32:35]
    s_add_u32 s53, s53, 32768
    s_cmp_eq_u32 s53, 131072
    v_mfma_f32_16x16x32_bf16 v[36:39], v[180:183], v[140:143], v[36:39]
    s_cselect_b32 s53, 0, s53
    v_add_u32_e64 v202, s53, v200
    v_mfma_f32_16x16x32_bf16 v[64:67], v[180:183], v[144:147], v[64:67]
    v_add_u32 v203, s53, v201
    v_add_u32 v206, s53, v204
    v_mfma_f32_16x16x32_bf16 v[68:71], v[180:183], v[148:151], v[68:71]
    v_add_u32_e64 v207, s53, v205
    s_barrier
    s_waitcnt lgkmcnt(9)
    v_mfma_f32_16x16x32_bf16 v[8:11], v[184:187], v[152:155], v[8:11]
    ds_read_b128 v[136:139], v202 offset:0
    s_waitcnt lgkmcnt(9)
    v_mfma_f32_16x16x32_bf16 v[12:15], v[184:187], v[156:159], v[12:15]
    ds_read_b64_tr_b16 v[168:169], v206 offset:0
    s_waitcnt lgkmcnt(9)
    v_mfma_f32_16x16x32_bf16 v[40:43], v[184:187], v[160:163], v[40:43]
    ds_read_b64_tr_b16 v[170:171], v206 offset:256
    s_waitcnt lgkmcnt(9)
    v_mfma_f32_16x16x32_bf16 v[44:47], v[184:187], v[164:167], v[44:47]
    s_waitcnt lgkmcnt(7)
    v_mfma_f32_16x16x32_bf16 v[16:19], v[188:191], v[152:155], v[16:19]
    ds_read_b128 v[140:143], v202 offset:2048
    v_mfma_f32_16x16x32_bf16 v[20:23], v[188:191], v[156:159], v[20:23]
    ds_read_b128 v[144:147], v202 offset:4096
    v_mfma_f32_16x16x32_bf16 v[48:51], v[188:191], v[160:163], v[48:51]
    ds_read_b128 v[148:151], v202 offset:6144
    v_mfma_f32_16x16x32_bf16 v[52:55], v[188:191], v[164:167], v[52:55]
    s_waitcnt lgkmcnt(8)
    v_mfma_f32_16x16x32_bf16 v[24:27], v[192:195], v[152:155], v[24:27]
    ds_read_b64_tr_b16 v[172:173], v207 offset:0
    v_mfma_f32_16x16x32_bf16 v[28:31], v[192:195], v[156:159], v[28:31]
    ds_read_b64_tr_b16 v[174:175], v207 offset:256
    v_mfma_f32_16x16x32_bf16 v[56:59], v[192:195], v[160:163], v[56:59]
    ds_read_b64_tr_b16 v[176:177], v206 offset:1024
    v_mfma_f32_16x16x32_bf16 v[60:63], v[192:195], v[164:167], v[60:63]
    s_waitcnt lgkmcnt(9)
    v_mfma_f32_16x16x32_bf16 v[32:35], v[196:199], v[152:155], v[32:35]
    ds_read_b64_tr_b16 v[178:179], v206 offset:1280
    v_mfma_f32_16x16x32_bf16 v[36:39], v[196:199], v[156:159], v[36:39]
    ds_read_b64_tr_b16 v[180:181], v207 offset:1024
    v_mfma_f32_16x16x32_bf16 v[64:67], v[196:199], v[160:163], v[64:67]
    ds_read_b64_tr_b16 v[182:183], v207 offset:1280
    v_mfma_f32_16x16x32_bf16 v[68:71], v[196:199], v[164:167], v[68:71]
    s_waitcnt lgkmcnt(9)
    v_mfma_f32_16x16x32_bf16 v[8:11], v[168:171], v[136:139], v[8:11]
    ds_read_b128 v[152:155], v203 offset:0
    s_waitcnt lgkmcnt(9)
    v_mfma_f32_16x16x32_bf16 v[12:15], v[168:171], v[140:143], v[12:15]
    ds_read_b64_tr_b16 v[184:185], v206 offset:8192
    s_waitcnt lgkmcnt(9)
    v_mfma_f32_16x16x32_bf16 v[40:43], v[168:171], v[144:147], v[40:43]
    ds_read_b64_tr_b16 v[186:187], v206 offset:8448
    s_waitcnt lgkmcnt(9)
    v_mfma_f32_16x16x32_bf16 v[44:47], v[168:171], v[148:151], v[44:47]
    ds_read_b128 v[156:159], v203 offset:2048
    s_waitcnt lgkmcnt(8)
    s_nop 0
    v_mfma_f32_16x16x32_bf16 v[16:19], v[172:175], v[136:139], v[16:19]
    ds_read_b128 v[160:163], v203 offset:4096
    v_mfma_f32_16x16x32_bf16 v[20:23], v[172:175], v[140:143], v[20:23]
    ds_read_b128 v[164:167], v203 offset:6144
    v_mfma_f32_16x16x32_bf16 v[48:51], v[172:175], v[144:147], v[48:51]
    ds_read_b64_tr_b16 v[188:189], v207 offset:8192
    v_mfma_f32_16x16x32_bf16 v[52:55], v[172:175], v[148:151], v[52:55]
    ds_read_b64_tr_b16 v[190:191], v207 offset:8448
    s_waitcnt lgkmcnt(9)
    s_nop 0
    v_mfma_f32_16x16x32_bf16 v[24:27], v[176:179], v[136:139], v[24:27]
    ds_read_b64_tr_b16 v[192:193], v206 offset:9216
    v_mfma_f32_16x16x32_bf16 v[28:31], v[176:179], v[140:143], v[28:31]
    ds_read_b64_tr_b16 v[194:195], v206 offset:9472
    v_mfma_f32_16x16x32_bf16 v[56:59], v[176:179], v[144:147], v[56:59]
    ds_read_b64_tr_b16 v[196:197], v207 offset:9216
    v_mfma_f32_16x16x32_bf16 v[60:63], v[176:179], v[148:151], v[60:63]
    ds_read_b64_tr_b16 v[198:199], v207 offset:9472
    s_waitcnt lgkmcnt(9)
    v_mfma_f32_16x16x32_bf16 v[32:35], v[180:183], v[136:139], v[32:35]
    s_add_u32 s53, s53, 32768
    s_cmp_eq_u32 s53, 131072
    v_mfma_f32_16x16x32_bf16 v[36:39], v[180:183], v[140:143], v[36:39]
    s_cselect_b32 s53, 0, s53
    v_add_u32_e64 v202, s53, v200
    v_mfma_f32_16x16x32_bf16 v[64:67], v[180:183], v[144:147], v[64:67]
    v_add_u32 v203, s53, v201
    v_add_u32 v206, s53, v204
    v_mfma_f32_16x16x32_bf16 v[68:71], v[180:183], v[148:151], v[68:71]
    v_add_u32_e64 v207, s53, v205
    s_barrier
    s_waitcnt lgkmcnt(9)
    v_mfma_f32_16x16x32_bf16 v[8:11], v[184:187], v[152:155], v[8:11]
    ds_read_b128 v[136:139], v202 offset:0
    s_waitcnt lgkmcnt(9)
    v_mfma_f32_16x16x32_bf16 v[12:15], v[184:187], v[156:159], v[12:15]
    ds_read_b64_tr_b16 v[168:169], v206 offset:0
    s_waitcnt lgkmcnt(9)
    v_mfma_f32_16x16x32_bf16 v[40:43], v[184:187], v[160:163], v[40:43]
    ds_read_b64_tr_b16 v[170:171], v206 offset:256
    s_waitcnt lgkmcnt(9)
    v_mfma_f32_16x16x32_bf16 v[44:47], v[184:187], v[164:167], v[44:47]
    ds_read_b128 v[140:143], v202 offset:2048
    s_waitcnt lgkmcnt(8)
    v_mfma_f32_16x16x32_bf16 v[16:19], v[188:191], v[152:155], v[16:19]
    ds_read_b128 v[144:147], v202 offset:4096
    v_mfma_f32_16x16x32_bf16 v[20:23], v[188:191], v[156:159], v[20:23]
    ds_read_b128 v[148:151], v202 offset:6144
    v_mfma_f32_16x16x32_bf16 v[48:51], v[188:191], v[160:163], v[48:51]
    v_mfma_f32_16x16x32_bf16 v[52:55], v[188:191], v[164:167], v[52:55]
    ds_read_b64_tr_b16 v[172:173], v207 offset:0
    s_waitcnt lgkmcnt(9)
    s_nop 0
    v_mfma_f32_16x16x32_bf16 v[24:27], v[192:195], v[152:155], v[24:27]
    ds_read_b64_tr_b16 v[174:175], v207 offset:256
    v_mfma_f32_16x16x32_bf16 v[28:31], v[192:195], v[156:159], v[28:31]
    ds_read_b64_tr_b16 v[176:177], v206 offset:1024
    v_mfma_f32_16x16x32_bf16 v[56:59], v[192:195], v[160:163], v[56:59]
    ds_read_b64_tr_b16 v[178:179], v206 offset:1280
    v_mfma_f32_16x16x32_bf16 v[60:63], v[192:195], v[164:167], v[60:63]
    ds_read_b64_tr_b16 v[180:181], v207 offset:1024
    s_waitcnt lgkmcnt(9)
    v_mfma_f32_16x16x32_bf16 v[32:35], v[196:199], v[152:155], v[32:35]
    ds_read_b64_tr_b16 v[182:183], v207 offset:1280
    v_mfma_f32_16x16x32_bf16 v[36:39], v[196:199], v[156:159], v[36:39]
    s_sub_u32 s54, s54, 1
    s_cmp_lg_u32 s54, 0
    v_mfma_f32_16x16x32_bf16 v[64:67], v[196:199], v[160:163], v[64:67]
    v_mfma_f32_16x16x32_bf16 v[68:71], v[196:199], v[164:167], v[68:71]
    s_cbranch_scc1 L_wsp_loop
L_wsp_epi:
    s_waitcnt lgkmcnt(9)
    v_mfma_f32_16x16x32_bf16 v[8:11], v[168:171], v[136:139], v[8:11]
    ds_read_b128 v[152:155], v203 offset:0
    s_waitcnt lgkmcnt(9)
    v_mfma_f32_16x16x32_bf16 v[12:15], v[168:171], v[140:143], v[12:15]
    ds_read_b64_tr_b16 v[184:185], v206 offset:8192
    s_waitcnt lgkmcnt(9)
    v_mfma_f32_16x16x32_bf16 v[40:43], v[168:171], v[144:147], v[40:43]
    ds_read_b64_tr_b16 v[186:187], v206 offset:8448
    s_waitcnt lgkmcnt(9)
    v_mfma_f32_16x16x32_bf16 v[44:47], v[168:171], v[148:151], v[44:47]
    s_waitcnt lgkmcnt(7)
    v_mfma_f32_16x16x32_bf16 v[16:19], v[172:175], v[136:139], v[16:19]
    ds_read_b128 v[156:159], v203 offset:2048
    v_mfma_f32_16x16x32_bf16 v[20:23], v[172:175], v[140:143], v[20:23]
    ds_read_b128 v[160:163], v203 offset:4096
    v_mfma_f32_16x16x32_bf16 v[48:51], v[172:175], v[144:147], v[48:51]
    ds_read_b128 v[164:167], v203 offset:6144
    v_mfma_f32_16x16x32_bf16 v[52:55], v[172:175], v[148:151], v[52:55]
    s_waitcnt lgkmcnt(8)
    v_mfma_f32_16x16x32_bf16 v[24:27], v[176:179], v[136:139], v[24:27]
    ds_read_b64_tr_b16 v[188:189], v207 offset:8192
    v_mfma_f32_16x16x32_bf16 v[28:31], v[176:179], v[140:143], v[28:31]
    ds_read_b64_tr_b16 v[190:191], v207 offset:8448
    v_mfma_f32_16x16x32_bf16 v[56:59], v[176:179], v[144:147], v[56:59]
    ds_read_b64_tr_b16 v[192:193], v206 offset:9216
    v_mfma_f32_16x16x32_bf16 v[60:63], v[176:179], v[148:151], v[60:63]
    s_waitcnt lgkmcnt(9)
    v_mfma_f32_16x16x32_bf16 v[32:35], v[180:183], v[136:139], v[32:35]
    ds_read_b64_tr_b16 v[194:195], v206 offset:9472
    v_mfma_f32_16x16x32_bf16 v[36:39], v[180:183], v[140:143], v[36:39]
    ds_read_b64_tr_b16 v[196:197], v207 offset:9216
    v_mfma_f32_16x16x32_bf16 v[64:67], v[180:183], v[144:147], v[64:67]
    ds_read_b64_tr_b16 v[198:199], v207 offset:9472
    v_mfma_f32_16x16x32_bf16 v[68:71], v[180:183], v[148:151], v[68:71]
    s_waitcnt lgkmcnt(9)
    v_mfma_f32_16x16x32_bf16 v[8:11], v[184:187], v[152:155], v[8:11]
    s_waitcnt lgkmcnt(8)
    v_mfma_f32_16x16x32_bf16 v[12:15], v[184:187], v[156:159], v[12:15]
    s_waitcnt lgkmcnt(7)
    v_mfma_f32_16x16x32_bf16 v[40:43], v[184:187], v[160:163], v[40:43]
    s_waitcnt lgkmcnt(6)
    v_mfma_f32_16x16x32_bf16 v[44:47], v[184:187], v[164:167], v[44:47]
    s_waitcnt lgkmcnt(4)
    v_mfma_f32_16x16x32_bf16 v[16:19], v[188:191], v[152:155], v[16:19]
    v_mfma_f32_16x16x32_bf16 v[20:23], v[188:191], v[156:159], v[20:23]
    v_mfma_f32_16x16x32_bf16 v[48:51], v[188:191], v[160:163], v[48:51]
    v_mfma_f32_16x16x32_bf16 v[52:55], v[188:191], v[164:167], v[52:55]
    s_waitcnt lgkmcnt(2)
    v_mfma_f32_16x16x32_bf16 v[24:27], v[192:195], v[152:155], v[24:27]
    v_mfma_f32_16x16x32_bf16 v[28:31], v[192:195], v[156:159], v[28:31]
    v_mfma_f32_16x16x32_bf16 v[56:59], v[192:195], v[160:163], v[56:59]
    v_mfma_f32_16x16x32_bf16 v[60:63], v[192:195], v[164:167], v[60:63]
    s_waitcnt lgkmcnt(0)
    v_mfma_f32_16x16x32_bf16 v[32:35], v[196:199], v[152:155], v[32:35]
    v_mfma_f32_16x16x32_bf16 v[36:39], v[196:199], v[156:159], v[36:39]
    v_mfma_f32_16x16x32_bf16 v[64:67], v[196:199], v[160:163], v[64:67]
    v_mfma_f32_16x16x32_bf16 v[68:71], v[196:199], v[164:167], v[68:71]
    s_nop 7
    v_permlane16_swap_b32 v8, v12
    v_permlane16_swap_b32 v9, v13
    v_permlane16_swap_b32 v10, v14
    v_permlane16_swap_b32 v11, v15
    v_permlane16_swap_b32 v16, v20
    v_permlane16_swap_b32 v17, v21
    v_permlane16_swap_b32 v18, v22
    v_permlane16_swap_b32 v19, v23
    s_nop 0
    v_pk_mul_f32 v[8:9], v[8:9], v[72:73]
    v_pk_mul_f32 v[10:11], v[10:11], v[74:75]
    v_pk_mul_f32 v[12:13], v[12:13], v[76:77]
    v_pk_mul_f32 v[14:15], v[14:15], v[78:79]
    v_pk_mul_f32 v[16:17], v[16:17], v[80:81]
    v_pk_mul_f32 v[18:19], v[18:19], v[82:83]
    v_pk_mul_f32 v[20:21], v[20:21], v[84:85]
    v_pk_mul_f32 v[22:23], v[22:23], v[86:87]
    v_cvt_pk_bf16_f32 v8, v8, v9
    v_cvt_pk_bf16_f32 v9, v10, v11
    v_cvt_pk_bf16_f32 v10, v12, v13
    v_cvt_pk_bf16_f32 v11, v14, v15
    v_cvt_pk_bf16_f32 v12, v16, v17
    v_cvt_pk_bf16_f32 v13, v18, v19
    v_cvt_pk_bf16_f32 v14, v20, v21
    v_cvt_pk_bf16_f32 v15, v22, v23
    buffer_store_dwordx4 v[8:11], v208, s[36:39], s60 offen offset:0 sc1
    buffer_store_dwordx4 v[12:15], v208, s[36:39], s60 offen offset:1024 sc1
    v_permlane16_swap_b32 v40, v44
    v_permlane16_swap_b32 v41, v45
    v_permlane16_swap_b32 v42, v46
    v_permlane16_swap_b32 v43, v47
    v_permlane16_swap_b32 v48, v52
    v_permlane16_swap_b32 v49, v53
    v_permlane16_swap_b32 v50, v54
    v_permlane16_swap_b32 v51, v55
    s_nop 0
    s_nop 0
    v_pk_mul_f32 v[40:41], v[40:41], v[104:105]
    v_pk_mul_f32 v[42:43], v[42:43], v[106:107]
    v_pk_mul_f32 v[44:45], v[44:45], v[108:109]
    v_pk_mul_f32 v[46:47], v[46:47], v[110:111]
    v_pk_mul_f32 v[48:49], v[48:49], v[112:113]
    v_pk_mul_f32 v[50:51], v[50:51], v[114:115]
    v_pk_mul_f32 v[52:53], v[52:53], v[116:117]
    v_pk_mul_f32 v[54:55], v[54:55], v[118:119]
    v_cvt_pk_bf16_f32 v40, v40, v41
    v_cvt_pk_bf16_f32 v41, v42, v43
    v_cvt_pk_bf16_f32 v42, v44, v45
    v_cvt_pk_bf16_f32 v43, v46, v47
    v_cvt_pk_bf16_f32 v44, v48, v49
    v_cvt_pk_bf16_f32 v45, v50, v51
    v_cvt_pk_bf16_f32 v46, v52, v53
    v_cvt_pk_bf16_f32 v47, v54, v55
    buffer_store_dwordx4 v[40:43], v208, s[36:39], s61 offen offset:0 sc1
    buffer_store_dwordx4 v[44:47], v208, s[36:39], s61 offen offset:1024 sc1
    v_permlane16_swap_b32 v24, v28
    v_permlane16_swap_b32 v25, v29
    v_permlane16_swap_b32 v26, v30
    v_permlane16_swap_b32 v27, v31
    v_permlane16_swap_b32 v32, v36
    v_permlane16_swap_b32 v33, v37
    v_permlane16_swap_b32 v34, v38
    v_permlane16_swap_b32 v35, v39
    s_nop 0
    s_nop 0
    v_pk_mul_f32 v[24:25], v[24:25], v[88:89]
    v_pk_mul_f32 v[26:27], v[26:27], v[90:91]
    v_pk_mul_f32 v[28:29], v[28:29], v[92:93]
    v_pk_mul_f32 v[30:31], v[30:31], v[94:95]
    v_pk_mul_f32 v[32:33], v[32:33], v[96:97]
    v_pk_mul_f32 v[34:35], v[34:35], v[98:99]
    v_pk_mul_f32 v[36:37], v[36:37], v[100:101]
    v_pk_mul_f32 v[38:39], v[38:39], v[102:103]
    v_cvt_pk_bf16_f32 v24, v24, v25
    v_cvt_pk_bf16_f32 v25, v26, v27
    v_cvt_pk_bf16_f32 v26, v28, v29
    v_cvt_pk_bf16_f32 v27, v30, v31
    v_cvt_pk_bf16_f32 v28, v32, v33
    v_cvt_pk_bf16_f32 v29, v34, v35
    v_cvt_pk_bf16_f32 v30, v36, v37
    v_cvt_pk_bf16_f32 v31, v38, v39
    buffer_store_dwordx4 v[24:27], v208, s[36:39], s60 offen offset:2048 sc1
    buffer_store_dwordx4 v[28:31], v208, s[36:39], s60 offen offset:3072 sc1
    v_permlane16_swap_b32 v56, v60
    v_permlane16_swap_b32 v57, v61
    v_permlane16_swap_b32 v58, v62
    v_permlane16_swap_b32 v59, v63
    v_permlane16_swap_b32 v64, v68
    v_permlane16_swap_b32 v65, v69
    v_permlane16_swap_b32 v66, v70
    v_permlane16_swap_b32 v67, v71
    s_nop 0
    s_nop 0
    v_pk_mul_f32 v[56:57], v[56:57], v[120:121]
    v_pk_mul_f32 v[58:59], v[58:59], v[122:123]
    v_pk_mul_f32 v[60:61], v[60:61], v[124:125]
    v_pk_mul_f32 v[62:63], v[62:63], v[126:127]
    v_pk_mul_f32 v[64:65], v[64:65], v[128:129]
    v_pk_mul_f32 v[66:67], v[66:67], v[130:131]
    v_pk_mul_f32 v[68:69], v[68:69], v[132:133]
    v_pk_mul_f32 v[70:71], v[70:71], v[134:135]
    v_cvt_pk_bf16_f32 v56, v56, v57
    v_cvt_pk_bf16_f32 v57, v58, v59
    v_cvt_pk_bf16_f32 v58, v60, v61
    v_cvt_pk_bf16_f32 v59, v62, v63
    v_cvt_pk_bf16_f32 v60, v64, v65
    v_cvt_pk_bf16_f32 v61, v66, v67
    v_cvt_pk_bf16_f32 v62, v68, v69
    v_cvt_pk_bf16_f32 v63, v70, v71
    buffer_store_dwordx4 v[56:59], v208, s[36:39], s61 offen offset:2048 sc1
    buffer_store_dwordx4 v[60:63], v208, s[36:39], s61 offen offset:3072 sc1
    s_add_u32 s96, s28, 0x3a00000
    s_addc_u32 s97, s29, 0
    s_and_b32 s97, s97, 0xffff
    s_mov_b32 s98, 0x200000
    s_mov_b32 s99, 0x20000
    v_mov_b32 v252, s84
    v_mov_b32 v253, s85
    v_mov_b32_e64 v254, 0
    s_and_b32 s100, s3, 3
    s_lshl_b32 s100, s100, 7
    s_add_u32 s100, s100, s87
    s_waitcnt vmcnt(0)
    s_mov_b64 exec, 1
    buffer_store_dwordx2 v[252:253], v254, s[96:99], s100 offen sc1
    s_mov_b64 exec, -1
    s_barrier
    s_mov_b64 exec, -1
    s_setprio 0
    s_branch L_wout_entry
L_wsp_pf:
    s_sub_u32 s30, s2, 224
    s_mul_i32 s30, s30, 114688
    v_lshlrev_b32_e64 v2, 4, v0
    s_mov_b32 s31, 7
    s_waitcnt lgkmcnt(0)
    s_mov_b32 s32, s18
    s_and_b32 s33, s19, 0xffff
    s_mov_b32 s34, 0x380000
    s_mov_b32 s35, 0x20000
L_wsp_pfl:
    buffer_load_dwordx4 v[8:11], v2, s[32:35], s30 offen
    s_add_u32 s30, s30, 8192
    buffer_load_dwordx4 v[12:15], v2, s[32:35], s30 offen
    s_add_u32 s30, s30, 8192
    s_waitcnt vmcnt(6)
    s_sub_u32 s31, s31, 1
    s_cmp_lg_u32 s31, 0
    s_cbranch_scc1 L_wsp_pfl
    s_waitcnt vmcnt(0)
    s_mov_b64 exec, -1
    s_setprio 0
    s_branch L_wout_entry
L_wout_entry:
    v_and_b32_e64 v1, 63, v0
    s_mov_b32 s46, s3
    s_and_b32 s47, s2, 7
    s_lshr_b32 s48, s2, 3
    s_and_b32 s30, s47, 3
    s_lshl_b32 s30, s30, 3
    s_and_b32 s49, s48, 7
    s_add_u32 s30, s30, s49
    s_lshr_b32 s31, s47, 2
    s_mul_i32 s31, s31, 4
    s_lshr_b32 s49, s48, 3
    s_add_u32 s31, s31, s49
    s_and_b32 s30, s47, 3
    s_lshl_b32 s30, s30, 3
    s_and_b32 s49, s48, 3
    s_lshl_b32 s49, s49, 1
    s_add_u32 s30, s30, s49
    s_bfe_u32 s49, s48, 0x10002
    s_add_u32 s30, s30, s49
    s_cmp_ge_u32 s46, 4
    s_cbranch_scc1 L_wout_comp
    s_mul_i32 s50, s30, 229376
    s_mul_i32 s51, s46, 2
    s_lshr_b32 s52, s51, 2
    s_and_b32 s51, s51, 3
    s_mul_i32 s52, s52, 114688
    s_lshl_b32 s51, s51, 10
    s_add_u32 s50, s50, s52
    s_add_u32 s50, s50, s51
    v_lshl_add_u32 v8, v1, 4, s50
    v_add_u32 v9, 1024, v8
    v_lshrrev_b32 v2, 4, v1
    v_bfe_u32 v3, v1, 2, 2
    v_and_b32 v4, 3, v1
    v_and_b32 v5, 2, v2
    v_xor_b32 v4, v4, v5
    v_lshrrev_b32 v5, 1, v2
    v_lshl_add_u32 v5, v5, 2, v3
    v_mul_u32_u24 v5, 2048, v5
    v_and_b32_e64 v6, 1, v2
    v_lshl_add_u32 v5, v6, 6, v5
    v_lshl_add_u32 v5, v4, 4, v5
    s_mul_i32 s50, s46, 32768
    s_mul_i32 s51, s31, 256
    s_add_u32 s50, s50, s51
    v_add_u32 v5, s50, v5
    v_add_u32_e64 v10, 0, v5
    v_add_u32 v11, 128, v5
    v_add_u32 v12, 16384, v5
    v_add_u32 v13, 16512, v5
    s_mul_i32 s55, s46, 2048
    s_mul_i32 s56, s46, 4096
    s_add_u32 s56, s56, 8192
    s_waitcnt lgkmcnt(0)
    s_mov_b32 s36, s18
    s_and_b32 s37, s19, 0xffff
    s_mov_b32 s38, 0x380000
    s_mov_b32 s39, 0x20000
    s_add_u32 s32, s28, 0x3200000
    s_addc_u32 s33, s29, 0
    s_and_b32 s33, s33, 0xffff
    s_mov_b32 s34, 0x700000
    s_mov_b32 s35, 0x20000
    s_mul_i32 s54, s31, 1
    s_add_u32 s54, s54, s30
    s_add_u32 s57, s54, 0
    s_and_b32 s57, s57, 3
    s_mul_i32 s57, s57, 131072
    s_add_u32 m0, s56, 0
    s_nop 0
    buffer_load_dwordx4 v10, s[36:39], s57 offen lds
    s_add_u32 m0, s56, 1024
    s_nop 0
    buffer_load_dwordx4 v11, s[36:39], s57 offen lds
    s_add_u32 m0, s56, 2048
    s_nop 0
    buffer_load_dwordx4 v12, s[36:39], s57 offen lds
    s_add_u32 m0, s56, 3072
    s_nop 0
    buffer_load_dwordx4 v13, s[36:39], s57 offen lds
    s_add_u32 s57, s54, 1
    s_and_b32 s57, s57, 3
    s_mul_i32 s57, s57, 131072
    s_add_u32 m0, s56, 24576
    s_nop 0
    buffer_load_dwordx4 v10, s[36:39], s57 offen lds
    s_add_u32 m0, s56, 25600
    s_nop 0
    buffer_load_dwordx4 v11, s[36:39], s57 offen lds
    s_add_u32 m0, s56, 26624
    s_nop 0
    buffer_load_dwordx4 v12, s[36:39], s57 offen lds
    s_add_u32 m0, s56, 27648
    s_nop 0
    buffer_load_dwordx4 v13, s[36:39], s57 offen lds
    s_add_u32 s57, s54, 2
    s_and_b32 s57, s57, 3
    s_mul_i32 s57, s57, 131072
    s_add_u32 m0, s56, 49152
    s_nop 0
    buffer_load_dwordx4 v10, s[36:39], s57 offen lds
    s_add_u32 m0, s56, 50176
    s_nop 0
    buffer_load_dwordx4 v11, s[36:39], s57 offen lds
    s_add_u32 m0, s56, 51200
    s_nop 0
    buffer_load_dwordx4 v12, s[36:39], s57 offen lds
    s_add_u32 m0, s56, 52224
    s_nop 0
    buffer_load_dwordx4 v13, s[36:39], s57 offen lds
    s_add_u32 s57, s54, 3
    s_and_b32 s57, s57, 3
    s_mul_i32 s57, s57, 131072
    s_add_u32 m0, s56, 73728
    s_nop 0
    buffer_load_dwordx4 v10, s[36:39], s57 offen lds
    s_add_u32 m0, s56, 74752
    s_nop 0
    buffer_load_dwordx4 v11, s[36:39], s57 offen lds
    s_add_u32 m0, s56, 75776
    s_nop 0
    buffer_load_dwordx4 v12, s[36:39], s57 offen lds
    s_add_u32 m0, s56, 76800
    s_nop 0
    buffer_load_dwordx4 v13, s[36:39], s57 offen lds
    s_add_u32 s57, s54, 4
    s_and_b32 s57, s57, 3
    s_mul_i32 s57, s57, 131072
    s_add_u32 s57, s57, 524288
    s_add_u32 m0, s56, 98304
    s_nop 0
    buffer_load_dwordx4 v10, s[36:39], s57 offen lds
    s_add_u32 m0, s56, 99328
    s_nop 0
    buffer_load_dwordx4 v11, s[36:39], s57 offen lds
    s_add_u32 m0, s56, 100352
    s_nop 0
    buffer_load_dwordx4 v12, s[36:39], s57 offen lds
    s_add_u32 m0, s56, 101376
    s_nop 0
    buffer_load_dwordx4 v13, s[36:39], s57 offen lds
    s_barrier
    s_add_u32 s57, s54, 0
    s_and_b32 s57, s57, 3
    s_mul_i32 s57, s57, 4096
    s_add_u32 m0, s55, 0
    s_nop 0
    buffer_load_dwordx4 v8, s[32:35], s57 offen sc1 lds
    s_add_u32 m0, s55, 1024
    s_nop 0
    buffer_load_dwordx4 v9, s[32:35], s57 offen sc1 lds
    s_add_u32 s57, s54, 1
    s_and_b32 s57, s57, 3
    s_mul_i32 s57, s57, 4096
    s_add_u32 m0, s55, 24576
    s_nop 0
    buffer_load_dwordx4 v8, s[32:35], s57 offen sc1 lds
    s_add_u32 m0, s55, 25600
    s_nop 0
    buffer_load_dwordx4 v9, s[32:35], s57 offen sc1 lds
    s_waitcnt vmcnt(2)
    s_barrier
    s_add_u32 s57, s54, 2
    s_and_b32 s57, s57, 3
    s_mul_i32 s57, s57, 4096
    s_add_u32 m0, s55, 49152
    s_nop 0
    buffer_load_dwordx4 v8, s[32:35], s57 offen sc1 lds
    s_add_u32 m0, s55, 50176
    s_nop 0
    buffer_load_dwordx4 v9, s[32:35], s57 offen sc1 lds
    s_add_u32 s57, s54, 3
    s_and_b32 s57, s57, 3
    s_mul_i32 s57, s57, 4096
    s_add_u32 m0, s55, 73728
    s_nop 0
    buffer_load_dwordx4 v8, s[32:35], s57 offen sc1 lds
    s_add_u32 m0, s55, 74752
    s_nop 0
    buffer_load_dwordx4 v9, s[32:35], s57 offen sc1 lds
    s_add_u32 s57, s54, 4
    s_and_b32 s57, s57, 3
    s_mul_i32 s57, s57, 4096
    s_add_u32 s57, s57, 16384
    s_add_u32 m0, s55, 98304
    s_nop 0
    buffer_load_dwordx4 v8, s[32:35], s57 offen sc1 lds
    s_add_u32 m0, s55, 99328
    s_nop 0
    buffer_load_dwordx4 v9, s[32:35], s57 offen sc1 lds
    s_waitcnt vmcnt(6)
    s_barrier
    s_waitcnt vmcnt(4)
    s_barrier
    s_add_u32 s57, s54, 5
    s_and_b32 s57, s57, 3
    s_mul_i32 s57, s57, 131072
    s_add_u32 s57, s57, 524288
    s_add_u32 m0, s56, 0
    s_nop 0
    buffer_load_dwordx4 v10, s[36:39], s57 offen lds
    s_add_u32 m0, s56, 1024
    s_nop 0
    buffer_load_dwordx4 v11, s[36:39], s57 offen lds
    s_add_u32 m0, s56, 2048
    s_nop 0
    buffer_load_dwordx4 v12, s[36:39], s57 offen lds
    s_add_u32 m0, s56, 3072
    s_nop 0
    buffer_load_dwordx4 v13, s[36:39], s57 offen lds
    s_add_u32 s57, s54, 5
    s_and_b32 s57, s57, 3
    s_mul_i32 s57, s57, 4096
    s_add_u32 s57, s57, 16384
    s_add_u32 m0, s55, 0
    s_nop 0
    buffer_load_dwordx4 v8, s[32:35], s57 offen sc1 lds
    s_add_u32 m0, s55, 1024
    s_nop 0
    buffer_load_dwordx4 v9, s[32:35], s57 offen sc1 lds
    s_waitcnt vmcnt(8)
    s_barrier
    s_add_u32 s57, s54, 6
    s_and_b32 s57, s57, 3
    s_mul_i32 s57, s57, 131072
    s_add_u32 s57, s57, 524288
    s_add_u32 m0, s56, 24576
    s_nop 0
    buffer_load_dwordx4 v10, s[36:39], s57 offen lds
    s_add_u32 m0, s56, 25600
    s_nop 0
    buffer_load_dwordx4 v11, s[36:39], s57 offen lds
    s_add_u32 m0, s56, 26624
    s_nop 0
    buffer_load_dwordx4 v12, s[36:39], s57 offen lds
    s_add_u32 m0, s56, 27648
    s_nop 0
    buffer_load_dwordx4 v13, s[36:39], s57 offen lds
    s_add_u32 s57, s54, 6
    s_and_b32 s57, s57, 3
    s_mul_i32 s57, s57, 4096
    s_add_u32 s57, s57, 16384
    s_add_u32 m0, s55, 24576
    s_nop 0
    buffer_load_dwordx4 v8, s[32:35], s57 offen sc1 lds
    s_add_u32 m0, s55, 25600
    s_nop 0
    buffer_load_dwordx4 v9, s[32:35], s57 offen sc1 lds
    s_waitcnt vmcnt(12)
    s_barrier
    s_add_u32 s57, s54, 7
    s_and_b32 s57, s57, 3
    s_mul_i32 s57, s57, 131072
    s_add_u32 s57, s57, 524288
    s_add_u32 m0, s56, 49152
    s_nop 0
    buffer_load_dwordx4 v10, s[36:39], s57 offen lds
    s_add_u32 m0, s56, 50176
    s_nop 0
    buffer_load_dwordx4 v11, s[36:39], s57 offen lds
    s_add_u32 m0, s56, 51200
    s_nop 0
    buffer_load_dwordx4 v12, s[36:39], s57 offen lds
    s_add_u32 m0, s56, 52224
    s_nop 0
    buffer_load_dwordx4 v13, s[36:39], s57 offen lds
    s_add_u32 s57, s54, 7
    s_and_b32 s57, s57, 3
    s_mul_i32 s57, s57, 4096
    s_add_u32 s57, s57, 16384
    s_add_u32 m0, s55, 49152
    s_nop 0
    buffer_load_dwordx4 v8, s[32:35], s57 offen sc1 lds
    s_add_u32 m0, s55, 50176
    s_nop 0
    buffer_load_dwordx4 v9, s[32:35], s57 offen sc1 lds
    s_add_u32 s60, s55, 122880
    s_add_u32 s55, s55, 73728
    s_add_u32 s56, s56, 73728
    s_mov_b32 s57, 32768
    s_mov_b32 s58, 1048576
    s_mov_b32 s59, 8
L_wout_lloop:
    s_add_u32 s57, s54, s59
    s_and_b32 s57, s57, 3
    s_andn2_b32 s58, s59, 3
    s_or_b32 s57, s57, s58
    s_mul_i32 s58, s57, 131072
    s_mul_i32 s57, s57, 4096
    s_waitcnt vmcnt(12)
    s_barrier
    s_add_u32 m0, s56, 0
    s_nop 0
    buffer_load_dwordx4 v10, s[36:39], s58 offen lds
    s_add_u32 m0, s56, 1024
    s_nop 0
    buffer_load_dwordx4 v11, s[36:39], s58 offen lds
    s_add_u32 m0, s56, 2048
    s_nop 0
    buffer_load_dwordx4 v12, s[36:39], s58 offen lds
    s_add_u32 m0, s56, 3072
    s_nop 0
    buffer_load_dwordx4 v13, s[36:39], s58 offen lds
    s_add_u32 m0, s55, 0
    s_nop 0
    buffer_load_dwordx4 v8, s[32:35], s57 offen sc1 lds
    s_add_u32 m0, s55, 1024
    s_nop 0
    buffer_load_dwordx4 v9, s[32:35], s57 offen sc1 lds
    s_add_u32 s57, s57, 4096
    s_add_u32 s58, s58, 131072
    s_add_u32 s55, s55, 24576
    s_add_u32 s56, s56, 24576
    s_cmp_eq_u32 s55, s60
    s_cselect_b32 s61, 122880, 0
    s_sub_u32 s55, s55, s61
    s_sub_u32 s56, s56, s61
    s_add_u32 s59, s59, 1
    s_cmp_lt_u32 s59, 28
    s_cbranch_scc1 L_wout_lloop
    s_and_b32 s44, s46, 1
    s_lshl_b32 s44, s44, 13
    s_cmp_ge_u32 s2, 32
    s_cbranch_scc1 L_mp0_ct49
    s_getpc_b64 s[64:65]
L_mp0_pc50:
    s_add_u32 s64, s64, L_wout_epi-L_mp0_pc50
    s_addc_u32 s65, s65, 0
    v_and_b32 v60, 63, v0
    v_lshl_add_u32 v60, v60, 7, s44
    v_min_u32 v60, L_text_end-L_wout_epi-4, v60
    v_mov_b32 v61, s65
    v_add_co_u32 v60, vcc, s64, v60
    s_nop 1
    v_addc_co_u32 v61, vcc, 0, v61, vcc
    global_load_dword v62, v[60:61], off
L_mp0_ct49:
    s_waitcnt vmcnt(12)
    s_barrier
    s_waitcnt vmcnt(6)
    s_barrier
    s_waitcnt vmcnt(0)
    s_barrier
    s_endpgm
L_wout_comp:
    s_setprio 1
    s_sub_u32 s46, s46, 4
    s_lshr_b32 s50, s46, 1
    s_and_b32 s51, s46, 1
    v_and_b32 v3, 31, v1
    v_lshrrev_b32 v4, 5, v1
    v_and_b32 v5, 15, v1
    v_lshrrev_b32_e64 v6, 4, v1
    s_mul_i32 s52, s50, 4096
    v_lshl_add_u32 v7, v5, 4, s52
    v_lshl_add_u32 v88, v6, 9, v7
    v_mul_u32_u24 v5, 4096, v4
    v_and_b32_e64 v6, 1, v6
    v_lshl_add_u32 v5, v6, 9, v5
    v_lshl_add_u32 v5, v6, 5, v5
    v_bfe_u32 v6, v1, 2, 2
    v_lshl_add_u32 v5, v6, 6, v5
    v_bfe_u32 v6, v1, 1, 1
    v_lshl_add_u32 v5, v6, 3, v5
    v_and_b32_e64 v6, 1, v1
    v_lshl_add_u32 v5, v6, 4, v5
    s_mul_i32 s52, s51, 1024
    s_add_u32 s52, s52, 8192
    v_add_u32 v90, s52, v5
    v_xor_b32_e64 v91, 32, v90
    s_waitcnt lgkmcnt(0)
    s_add_u32 s36, s28, 0x1500000
    s_addc_u32 s37, s29, 0
    s_and_b32 s37, s37, 0xffff
    s_mov_b32 s38, 0x800000
    s_mov_b32 s39, 0x20000
    s_mov_b32 s32, s24
    s_and_b32 s33, s25, 0xffff
    s_mov_b32 s34, 0x400000
    s_mov_b32 s35, 0x20000
    v_lshlrev_b32_e64 v94, 4, v1
    s_lshl_b32 s60, s31, 7
    s_lshl_b32 s61, s51, 6
    s_add_u32 s60, s60, s61
    s_lshl_b32 s61, s30, 1
    s_add_u32 s61, s61, s50
    s_lshl_b32 s62, s61, 16
    s_lshl_b32 s63, s60, 1
    s_add_u32 s63, s63, s62
    s_lshl_b32 s64, s60, 6
    s_add_u32 s64, s64, s62
    s_add_u32 s65, s64, 4194304
    s_lshl_b32 s66, s50, 13
    s_add_u32 s66, s66, 131072
    v_and_b32 v5, 15, v3
    s_lshl_b32 s67, s51, 3
    v_xor_b32 v5, s67, v5
    v_lshlrev_b32_e64 v5, 4, v5
    v_lshl_add_u32 v5, v3, 8, v5
    v_lshl_add_u32 v5, v4, 3, v5
    v_add_u32 v95, s66, v5
    s_lshl_b32 s67, s51, 8
    s_add_u32 s67, s67, 147456
    v_lshl_add_u32 v96, v4, 4, s67
    s_mov_b32 s53, 0
    v_add_u32 v89, s53, v88
    v_add_u32 v92, s53, v90
    v_add_u32 v93, s53, v91
    s_cmp_lg_u32 s3, 4
    s_cbranch_scc1 L_mp0_wd51
    s_add_u32 s96, s28, 0x3a00000
    s_addc_u32 s97, s29, 0
    s_and_b32 s97, s97, 0xffff
    s_mov_b32 s98, 0x200000
    s_mov_b32 s99, 0x20000
    s_lshr_b32 s100, s30, 1
    s_lshl_b32 s100, s100, 8
    s_add_u32 s100, s100, 40960
    s_lshl_b32 s100, s100, 5
    v_lshlrev_b32_e64 v254, 7, v1
    s_mov_b32 s101, 0x100000
    s_bfm_b64 exec, 56, 0
L_mp0_wf52:
    buffer_load_dwordx2 v[252:253], v254, s[96:99], s100 offen sc1
    s_waitcnt vmcnt(0)
    v_cmp_ne_u64 vcc, s[84:85], v[252:253]
    s_sub_u32 s101, s101, 1
    s_nop 3
    s_cbranch_vccz L_mp0_we53
    s_mov_b64 exec, vcc
    s_sleep 1
    s_cmp_lg_u32 s101, 0
    s_cbranch_scc1 L_mp0_wf52
L_mp0_we53:
    s_mov_b64 exec, -1
L_mp0_wd51:
    s_barrier
    s_cmp_lg_u32 s46, 1
    s_cbranch_scc1 L_mp0_ev54
    s_mov_b32 s80, s28
    s_and_b32 s81, s29, 0xffff
    s_mov_b32 s82, 0x40000
    s_mov_b32 s83, 0x20000
    v_lshlrev_b32 v100, 4, v3
    v_lshl_add_u32 v100, v4, 13, v100
    s_lshl_b32 s68, s31, 9
    s_add_u32 s68, s68, 176128
    s_add_u32 s69, s68, 16384
    buffer_load_dwordx4 v[116:119], v100, s[80:83], s68 offen sc1
    buffer_load_dwordx4 v[120:123], v100, s[80:83], s69 offen sc1
    v_cvt_f32_u32 v102, v4
    v_add_u32 v103, 147456, v94
    s_waitcnt vmcnt(0)
    v_pk_add_f32 v[116:117], v[116:117], v[120:121]
    v_pk_add_f32 v[118:119], v[118:119], v[122:123]
    v_cvt_pk_bf16_f32 v120, v116, v117
    v_lshlrev_b32 v116, 16, v120
    v_and_b32 v117, 0xffff0000, v120
    v_cvt_pk_bf16_f32 v120, v118, v119
    v_lshlrev_b32_e64 v118, 16, v120
    v_and_b32 v119, 0xffff0000, v120
    v_add_f32 v116, v102, v116
    v_add_f32 v117, v102, v117
    v_add_f32 v118, v102, v118
    v_add_f32 v119, v102, v119
    v_cvt_pk_bf16_f32 v120, v116, v117
    v_lshlrev_b32_e64 v116, 16, v120
    v_and_b32 v117, 0xffff0000, v120
    v_cvt_pk_bf16_f32 v120, v118, v119
    v_lshlrev_b32_e64 v118, 16, v120
    v_and_b32 v119, 0xffff0000, v120
    ds_write_b128 v103, v[116:119]
    s_waitcnt lgkmcnt(0)
L_mp0_ev54:
    s_barrier
    ds_read_b128 v[40:43], v89 offset:0
    ds_read_b64_tr_b16 v[56:57], v92 offset:0
    ds_read_b64_tr_b16 v[58:59], v92 offset:2048
    ds_read_b128 v[44:47], v89 offset:256
    ds_read_b64_tr_b16 v[60:61], v93 offset:0
    ds_read_b64_tr_b16 v[62:63], v93 offset:2048
    ds_read_b64_tr_b16 v[64:65], v92 offset:256
    ds_read_b64_tr_b16 v[66:67], v92 offset:2304
    ds_read_b64_tr_b16 v[68:69], v93 offset:256
    ds_read_b64_tr_b16 v[70:71], v93 offset:2304
    s_waitcnt lgkmcnt(7)
    v_mfma_f32_16x16x32_bf16 v[8:11], v[56:59], v[40:43], 0
    ds_read_b128 v[48:51], v89 offset:2048
    ds_read_b64_tr_b16 v[72:73], v92 offset:8192
    s_waitcnt lgkmcnt(8)
    v_mfma_f32_16x16x32_bf16 v[12:15], v[56:59], v[44:47], 0
    ds_read_b64_tr_b16 v[74:75], v92 offset:10240
    ds_read_b128 v[52:55], v89 offset:2304
    s_waitcnt lgkmcnt(8)
    v_mfma_f32_16x16x32_bf16 v[16:19], v[60:63], v[40:43], 0
    ds_read_b64_tr_b16 v[76:77], v93 offset:8192
    v_mfma_f32_16x16x32_bf16 v[20:23], v[60:63], v[44:47], 0
    ds_read_b64_tr_b16 v[78:79], v93 offset:10240
    ds_read_b64_tr_b16 v[80:81], v92 offset:8448
    s_waitcnt lgkmcnt(9)
    v_mfma_f32_16x16x32_bf16 v[24:27], v[64:67], v[40:43], 0
    ds_read_b64_tr_b16 v[82:83], v92 offset:10496
    ds_read_b64_tr_b16 v[84:85], v93 offset:8448
    v_mfma_f32_16x16x32_bf16 v[28:31], v[64:67], v[44:47], 0
    ds_read_b64_tr_b16 v[86:87], v93 offset:10496
    s_waitcnt lgkmcnt(9)
    v_mfma_f32_16x16x32_bf16 v[32:35], v[68:71], v[40:43], 0
    s_add_u32 s53, s53, 24576
    s_cmp_eq_u32 s53, 122880
    v_mfma_f32_16x16x32_bf16 v[36:39], v[68:71], v[44:47], 0
    s_cselect_b32 s53, 0, s53
    v_add_u32 v89, s53, v88
    v_add_u32 v92, s53, v90
    v_add_u32_e64 v93, s53, v91
    s_barrier
    s_waitcnt lgkmcnt(7)
    v_mfma_f32_16x16x32_bf16 v[8:11], v[72:75], v[48:51], v[8:11]
    ds_read_b128 v[40:43], v89 offset:0
    ds_read_b64_tr_b16 v[56:57], v92 offset:0
    s_waitcnt lgkmcnt(8)
    v_mfma_f32_16x16x32_bf16 v[12:15], v[72:75], v[52:55], v[12:15]
    ds_read_b64_tr_b16 v[58:59], v92 offset:2048
    s_waitcnt lgkmcnt(7)
    v_mfma_f32_16x16x32_bf16 v[16:19], v[76:79], v[48:51], v[16:19]
    ds_read_b128 v[44:47], v89 offset:256
    v_mfma_f32_16x16x32_bf16 v[20:23], v[76:79], v[52:55], v[20:23]
    ds_read_b64_tr_b16 v[60:61], v93 offset:0
    s_waitcnt lgkmcnt(7)
    v_mfma_f32_16x16x32_bf16 v[24:27], v[80:83], v[48:51], v[24:27]
    ds_read_b64_tr_b16 v[62:63], v93 offset:2048
    ds_read_b64_tr_b16 v[64:65], v92 offset:256
    v_mfma_f32_16x16x32_bf16 v[28:31], v[80:83], v[52:55], v[28:31]
    ds_read_b64_tr_b16 v[66:67], v92 offset:2304
    s_waitcnt lgkmcnt(8)
    v_mfma_f32_16x16x32_bf16 v[32:35], v[84:87], v[48:51], v[32:35]
    ds_read_b64_tr_b16 v[68:69], v93 offset:256
    v_mfma_f32_16x16x32_bf16 v[36:39], v[84:87], v[52:55], v[36:39]
    ds_read_b64_tr_b16 v[70:71], v93 offset:2304
    s_mov_b32 s54, 13
L_wout_loop:
    s_waitcnt lgkmcnt(7)
    v_mfma_f32_16x16x32_bf16 v[8:11], v[56:59], v[40:43], v[8:11]
    ds_read_b128 v[48:51], v89 offset:2048
    ds_read_b64_tr_b16 v[72:73], v92 offset:8192
    s_waitcnt lgkmcnt(8)
    v_mfma_f32_16x16x32_bf16 v[12:15], v[56:59], v[44:47], v[12:15]
    ds_read_b64_tr_b16 v[74:75], v92 offset:10240
    ds_read_b128 v[52:55], v89 offset:2304
    s_waitcnt lgkmcnt(8)
    v_mfma_f32_16x16x32_bf16 v[16:19], v[60:63], v[40:43], v[16:19]
    ds_read_b64_tr_b16 v[76:77], v93 offset:8192
    v_mfma_f32_16x16x32_bf16 v[20:23], v[60:63], v[44:47], v[20:23]
    ds_read_b64_tr_b16 v[78:79], v93 offset:10240
    ds_read_b64_tr_b16 v[80:81], v92 offset:8448
    s_waitcnt lgkmcnt(9)
    v_mfma_f32_16x16x32_bf16 v[24:27], v[64:67], v[40:43], v[24:27]
    ds_read_b64_tr_b16 v[82:83], v92 offset:10496
    ds_read_b64_tr_b16 v[84:85], v93 offset:8448
    v_mfma_f32_16x16x32_bf16 v[28:31], v[64:67], v[44:47], v[28:31]
    ds_read_b64_tr_b16 v[86:87], v93 offset:10496
    s_waitcnt lgkmcnt(9)
    v_mfma_f32_16x16x32_bf16 v[32:35], v[68:71], v[40:43], v[32:35]
    s_add_u32 s53, s53, 24576
    s_cmp_eq_u32 s53, 122880
    v_mfma_f32_16x16x32_bf16 v[36:39], v[68:71], v[44:47], v[36:39]
    s_cselect_b32 s53, 0, s53
    v_add_u32 v89, s53, v88
    v_add_u32 v92, s53, v90
    v_add_u32 v93, s53, v91
    s_barrier
    s_waitcnt lgkmcnt(7)
    v_mfma_f32_16x16x32_bf16 v[8:11], v[72:75], v[48:51], v[8:11]
    ds_read_b128 v[40:43], v89 offset:0
    ds_read_b64_tr_b16 v[56:57], v92 offset:0
    s_waitcnt lgkmcnt(8)
    v_mfma_f32_16x16x32_bf16 v[12:15], v[72:75], v[52:55], v[12:15]
    ds_read_b64_tr_b16 v[58:59], v92 offset:2048
    s_waitcnt lgkmcnt(7)
    v_mfma_f32_16x16x32_bf16 v[16:19], v[76:79], v[48:51], v[16:19]
    ds_read_b128 v[44:47], v89 offset:256
    v_mfma_f32_16x16x32_bf16 v[20:23], v[76:79], v[52:55], v[20:23]
    ds_read_b64_tr_b16 v[60:61], v93 offset:0
    s_waitcnt lgkmcnt(7)
    v_mfma_f32_16x16x32_bf16 v[24:27], v[80:83], v[48:51], v[24:27]
    ds_read_b64_tr_b16 v[62:63], v93 offset:2048
    ds_read_b64_tr_b16 v[64:65], v92 offset:256
    v_mfma_f32_16x16x32_bf16 v[28:31], v[80:83], v[52:55], v[28:31]
    ds_read_b64_tr_b16 v[66:67], v92 offset:2304
    s_waitcnt lgkmcnt(8)
    v_mfma_f32_16x16x32_bf16 v[32:35], v[84:87], v[48:51], v[32:35]
    ds_read_b64_tr_b16 v[68:69], v93 offset:256
    v_mfma_f32_16x16x32_bf16 v[36:39], v[84:87], v[52:55], v[36:39]
    ds_read_b64_tr_b16 v[70:71], v93 offset:2304
    s_waitcnt lgkmcnt(7)
    v_mfma_f32_16x16x32_bf16 v[8:11], v[56:59], v[40:43], v[8:11]
    ds_read_b128 v[48:51], v89 offset:2048
    ds_read_b64_tr_b16 v[72:73], v92 offset:8192
    s_waitcnt lgkmcnt(8)
    v_mfma_f32_16x16x32_bf16 v[12:15], v[56:59], v[44:47], v[12:15]
    ds_read_b64_tr_b16 v[74:75], v92 offset:10240
    ds_read_b128 v[52:55], v89 offset:2304
    s_waitcnt lgkmcnt(8)
    v_mfma_f32_16x16x32_bf16 v[16:19], v[60:63], v[40:43], v[16:19]
    ds_read_b64_tr_b16 v[76:77], v93 offset:8192
    v_mfma_f32_16x16x32_bf16 v[20:23], v[60:63], v[44:47], v[20:23]
    ds_read_b64_tr_b16 v[78:79], v93 offset:10240
    ds_read_b64_tr_b16 v[80:81], v92 offset:8448
    s_waitcnt lgkmcnt(9)
    v_mfma_f32_16x16x32_bf16 v[24:27], v[64:67], v[40:43], v[24:27]
    ds_read_b64_tr_b16 v[82:83], v92 offset:10496
    ds_read_b64_tr_b16 v[84:85], v93 offset:8448
    v_mfma_f32_16x16x32_bf16 v[28:31], v[64:67], v[44:47], v[28:31]
    ds_read_b64_tr_b16 v[86:87], v93 offset:10496
    s_waitcnt lgkmcnt(9)
    v_mfma_f32_16x16x32_bf16 v[32:35], v[68:71], v[40:43], v[32:35]
    s_add_u32 s53, s53, 24576
    s_cmp_eq_u32 s53, 122880
    v_mfma_f32_16x16x32_bf16 v[36:39], v[68:71], v[44:47], v[36:39]
    s_cselect_b32 s53, 0, s53
    v_add_u32 v89, s53, v88
    v_add_u32 v92, s53, v90
    v_add_u32_e64 v93, s53, v91
    s_barrier
    s_waitcnt lgkmcnt(7)
    v_mfma_f32_16x16x32_bf16 v[8:11], v[72:75], v[48:51], v[8:11]
    ds_read_b128 v[40:43], v89 offset:0
    ds_read_b64_tr_b16 v[56:57], v92 offset:0
    s_waitcnt lgkmcnt(8)
    v_mfma_f32_16x16x32_bf16 v[12:15], v[72:75], v[52:55], v[12:15]
    ds_read_b64_tr_b16 v[58:59], v92 offset:2048
    ds_read_b128 v[44:47], v89 offset:256
    s_waitcnt lgkmcnt(8)
    v_mfma_f32_16x16x32_bf16 v[16:19], v[76:79], v[48:51], v[16:19]
    ds_read_b64_tr_b16 v[60:61], v93 offset:0
    v_mfma_f32_16x16x32_bf16 v[20:23], v[76:79], v[52:55], v[20:23]
    ds_read_b64_tr_b16 v[62:63], v93 offset:2048
    ds_read_b64_tr_b16 v[64:65], v92 offset:256
    s_waitcnt lgkmcnt(9)
    v_mfma_f32_16x16x32_bf16 v[24:27], v[80:83], v[48:51], v[24:27]
    ds_read_b64_tr_b16 v[66:67], v92 offset:2304
    ds_read_b64_tr_b16 v[68:69], v93 offset:256
    v_mfma_f32_16x16x32_bf16 v[28:31], v[80:83], v[52:55], v[28:31]
    ds_read_b64_tr_b16 v[70:71], v93 offset:2304
    s_waitcnt lgkmcnt(9)
    v_mfma_f32_16x16x32_bf16 v[32:35], v[84:87], v[48:51], v[32:35]
    s_sub_u32 s54, s54, 1
    s_cmp_lg_u32 s54, 0
    v_mfma_f32_16x16x32_bf16 v[36:39], v[84:87], v[52:55], v[36:39]
    s_cbranch_scc1 L_wout_loop
L_wout_epi:
    s_nop 0
    ds_read_b128 v[116:119], v96 offset:0
    ds_read_b128 v[120:123], v96 offset:32
    ds_read_b128 v[124:127], v96 offset:64
    ds_read_b128 v[128:131], v96 offset:96
    ds_read_b128 v[132:135], v96 offset:128
    ds_read_b128 v[136:139], v96 offset:160
    ds_read_b128 v[140:143], v96 offset:192
    ds_read_b128 v[144:147], v96 offset:224
    v_xor_b32_e64 v97, 0, v95
    ds_read_b64 v[100:101], v97
    v_xor_b32_e64 v97, 16, v95
    ds_read_b64 v[102:103], v97
    v_xor_b32_e64 v97, 32, v95
    ds_read_b64 v[104:105], v97
    v_xor_b32_e64 v97, 48, v95
    ds_read_b64 v[106:107], v97
    v_xor_b32_e64 v97, 64, v95
    ds_read_b64 v[108:109], v97
    v_xor_b32 v97, 80, v95
    ds_read_b64 v[110:111], v97
    v_xor_b32 v97, 96, v95
    ds_read_b64 v[112:113], v97
    v_xor_b32 v97, 112, v95
    ds_read_b64 v[114:115], v97
    s_waitcnt lgkmcnt(7)
    v_mfma_f32_16x16x32_bf16 v[8:11], v[56:59], v[40:43], v[8:11]
    ds_read_b128 v[48:51], v89 offset:2048
    ds_read_b64_tr_b16 v[72:73], v92 offset:8192
    s_waitcnt lgkmcnt(8)
    v_mfma_f32_16x16x32_bf16 v[12:15], v[56:59], v[44:47], v[12:15]
    ds_read_b64_tr_b16 v[74:75], v92 offset:10240
    s_waitcnt lgkmcnt(7)
    v_mfma_f32_16x16x32_bf16 v[16:19], v[60:63], v[40:43], v[16:19]
    ds_read_b128 v[52:55], v89 offset:2304
    v_mfma_f32_16x16x32_bf16 v[20:23], v[60:63], v[44:47], v[20:23]
    ds_read_b64_tr_b16 v[76:77], v93 offset:8192
    s_waitcnt lgkmcnt(7)
    v_mfma_f32_16x16x32_bf16 v[24:27], v[64:67], v[40:43], v[24:27]
    ds_read_b64_tr_b16 v[78:79], v93 offset:10240
    ds_read_b64_tr_b16 v[80:81], v92 offset:8448
    v_mfma_f32_16x16x32_bf16 v[28:31], v[64:67], v[44:47], v[28:31]
    ds_read_b64_tr_b16 v[82:83], v92 offset:10496
    s_waitcnt lgkmcnt(8)
    v_mfma_f32_16x16x32_bf16 v[32:35], v[68:71], v[40:43], v[32:35]
    ds_read_b64_tr_b16 v[84:85], v93 offset:8448
    v_mfma_f32_16x16x32_bf16 v[36:39], v[68:71], v[44:47], v[36:39]
    ds_read_b64_tr_b16 v[86:87], v93 offset:10496
    s_waitcnt lgkmcnt(7)
    v_mfma_f32_16x16x32_bf16 v[8:11], v[72:75], v[48:51], v[8:11]
    s_waitcnt lgkmcnt(6)
    v_mfma_f32_16x16x32_bf16 v[12:15], v[72:75], v[52:55], v[12:15]
    s_waitcnt lgkmcnt(4)
    v_mfma_f32_16x16x32_bf16 v[16:19], v[76:79], v[48:51], v[16:19]
    v_mfma_f32_16x16x32_bf16 v[20:23], v[76:79], v[52:55], v[20:23]
    s_waitcnt lgkmcnt(2)
    v_mfma_f32_16x16x32_bf16 v[24:27], v[80:83], v[48:51], v[24:27]
    v_mfma_f32_16x16x32_bf16 v[28:31], v[80:83], v[52:55], v[28:31]
    s_waitcnt lgkmcnt(0)
    v_mfma_f32_16x16x32_bf16 v[32:35], v[84:87], v[48:51], v[32:35]
    v_mfma_f32_16x16x32_bf16 v[36:39], v[84:87], v[52:55], v[36:39]
    s_nop 7
    v_permlane16_swap_b32 v8, v12
    v_permlane16_swap_b32 v9, v13
    v_permlane16_swap_b32 v10, v14
    v_permlane16_swap_b32 v11, v15
    v_permlane16_swap_b32 v16, v20
    v_permlane16_swap_b32 v17, v21
    v_permlane16_swap_b32 v18, v22
    v_permlane16_swap_b32 v19, v23
    v_permlane16_swap_b32 v24, v28
    v_permlane16_swap_b32 v25, v29
    v_permlane16_swap_b32 v26, v30
    v_permlane16_swap_b32 v27, v31
    v_permlane16_swap_b32 v32, v36
    v_permlane16_swap_b32 v33, v37
    v_permlane16_swap_b32 v34, v38
    v_permlane16_swap_b32 v35, v39
    s_nop 1
    s_waitcnt lgkmcnt(0)
    v_lshlrev_b32 v40, 16, v100
    v_and_b32 v41, 0xffff0000, v100
    v_pk_fma_f32 v[8:9], v[8:9], v[116:117], v[40:41]
    v_lshlrev_b32_e64 v42, 16, v101
    v_and_b32 v43, 0xffff0000, v101
    v_pk_fma_f32 v[10:11], v[10:11], v[118:119], v[42:43]
    v_lshlrev_b32_e64 v44, 16, v102
    v_and_b32 v45, 0xffff0000, v102
    v_pk_fma_f32 v[12:13], v[12:13], v[120:121], v[44:45]
    v_lshlrev_b32_e64 v46, 16, v103
    v_and_b32 v47, 0xffff0000, v103
    v_pk_fma_f32 v[14:15], v[14:15], v[122:123], v[46:47]
    v_lshlrev_b32_e64 v40, 16, v104
    v_and_b32 v41, 0xffff0000, v104
    v_pk_fma_f32 v[16:17], v[16:17], v[124:125], v[40:41]
    v_lshlrev_b32_e64 v42, 16, v105
    v_and_b32 v43, 0xffff0000, v105
    v_pk_fma_f32 v[18:19], v[18:19], v[126:127], v[42:43]
    v_lshlrev_b32_e64 v44, 16, v106
    v_and_b32 v45, 0xffff0000, v106
    v_pk_fma_f32 v[20:21], v[20:21], v[128:129], v[44:45]
    v_lshlrev_b32_e64 v46, 16, v107
    v_and_b32 v47, 0xffff0000, v107
    v_pk_fma_f32 v[22:23], v[22:23], v[130:131], v[46:47]
    v_lshlrev_b32_e64 v40, 16, v108
    v_and_b32 v41, 0xffff0000, v108
    v_pk_fma_f32 v[24:25], v[24:25], v[132:133], v[40:41]
    v_lshlrev_b32_e64 v42, 16, v109
    v_and_b32 v43, 0xffff0000, v109
    v_pk_fma_f32 v[26:27], v[26:27], v[134:135], v[42:43]
    v_lshlrev_b32_e64 v44, 16, v110
    v_and_b32 v45, 0xffff0000, v110
    v_pk_fma_f32 v[28:29], v[28:29], v[136:137], v[44:45]
    v_lshlrev_b32_e64 v46, 16, v111
    v_and_b32 v47, 0xffff0000, v111
    v_pk_fma_f32 v[30:31], v[30:31], v[138:139], v[46:47]
    v_lshlrev_b32_e64 v40, 16, v112
    v_and_b32 v41, 0xffff0000, v112
    v_pk_fma_f32 v[32:33], v[32:33], v[140:141], v[40:41]
    v_lshlrev_b32_e64 v42, 16, v113
    v_and_b32 v43, 0xffff0000, v113
    v_pk_fma_f32 v[34:35], v[34:35], v[142:143], v[42:43]
    v_lshlrev_b32_e64 v44, 16, v114
    v_and_b32 v45, 0xffff0000, v114
    v_pk_fma_f32 v[36:37], v[36:37], v[144:145], v[44:45]
    v_lshlrev_b32_e64 v46, 16, v115
    v_and_b32 v47, 0xffff0000, v115
    v_pk_fma_f32 v[38:39], v[38:39], v[146:147], v[46:47]
    v_cvt_pk_bf16_f32 v100, v8, v9
    v_cvt_pk_bf16_f32 v101, v10, v11
    v_cvt_pk_bf16_f32 v102, v12, v13
    v_cvt_pk_bf16_f32 v103, v14, v15
    v_cvt_pk_bf16_f32 v104, v16, v17
    v_cvt_pk_bf16_f32 v105, v18, v19
    v_cvt_pk_bf16_f32 v106, v20, v21
    v_cvt_pk_bf16_f32 v107, v22, v23
    v_xor_b32_e64 v97, 0, v95
    ds_write_b64 v97, v[100:101]
    v_xor_b32_e64 v97, 16, v95
    ds_write_b64 v97, v[102:103]
    v_xor_b32_e64 v97, 32, v95
    ds_write_b64 v97, v[104:105]
    v_xor_b32_e64 v97, 48, v95
    ds_write_b64 v97, v[106:107]
    v_cvt_pk_bf16_f32 v108, v24, v25
    v_cvt_pk_bf16_f32 v109, v26, v27
    v_cvt_pk_bf16_f32 v110, v28, v29
    v_cvt_pk_bf16_f32 v111, v30, v31
    v_cvt_pk_bf16_f32 v112, v32, v33
    v_cvt_pk_bf16_f32 v113, v34, v35
    v_cvt_pk_bf16_f32 v114, v36, v37
    v_cvt_pk_bf16_f32 v115, v38, v39
    v_xor_b32_e64 v97, 64, v95
    ds_write_b64 v97, v[108:109]
    v_xor_b32 v97, 80, v95
    ds_write_b64 v97, v[110:111]
    v_xor_b32 v97, 96, v95
    ds_write_b64 v97, v[112:113]
    v_xor_b32 v97, 112, v95
    ds_write_b64 v97, v[114:115]
    v_lshrrev_b32 v5, 3, v1
    v_and_b32 v6, 7, v1
    s_lshl_b32 s67, s51, 3
    v_or_b32 v7, s67, v6
    v_xor_b32 v7, v7, v5
    v_lshlrev_b32 v7, 4, v7
    v_lshl_add_u32 v7, v5, 8, v7
    v_add_u32_e64 v7, s66, v7
    v_xor_b32 v97, 128, v7
    v_lshlrev_b32_e64 v5, 11, v5
    v_lshl_add_u32 v5, v6, 4, v5
    s_waitcnt lgkmcnt(0)
    ds_read_b128 v[116:119], v7 offset:0
    ds_read_b128 v[120:123], v97 offset:2048
    ds_read_b128 v[124:127], v7 offset:4096
    ds_read_b128 v[128:131], v97 offset:6144
    s_waitcnt lgkmcnt(3)
    buffer_store_dwordx4 v[116:119], v5, s[32:35], s63 offen sc1
    s_add_u32 s63, s63, 16384
    s_waitcnt lgkmcnt(2)
    buffer_store_dwordx4 v[120:123], v5, s[32:35], s63 offen sc1
    s_add_u32 s63, s63, 16384
    s_waitcnt lgkmcnt(1)
    buffer_store_dwordx4 v[124:127], v5, s[32:35], s63 offen sc1
    s_add_u32 s63, s63, 16384
    s_waitcnt lgkmcnt(0)
    buffer_store_dwordx4 v[128:131], v5, s[32:35], s63 offen sc1
    s_add_u32 s63, s63, 16384
    s_or_b32 s67, s2, s46
    s_cbranch_scc1 L_mp0_ep55
    s_add_u32 s96, s28, 0x3c000
    s_addc_u32 s97, s29, 0
    s_and_b32 s97, s97, 0xffff
    s_mov_b32 s98, 0x8
    s_mov_b32 s99, 0x20000
    v_mov_b32 v252, s84
    v_mov_b32 v253, s85
    v_mov_b32_e64 v254, 0
    s_mov_b64 exec, 1
    buffer_store_dwordx2 v[252:253], v254, s[96:99], 0 offen sc1
    s_mov_b64 exec, -1
L_mp0_ep55:
    s_endpgm
L_mp0_end:
    s_endpgm
L_text_end:
    s_endpgm
.section .rodata,"a"
.p2align 6
.amdhsa_kernel mp0_kernel
  .amdhsa_next_free_vgpr 255
  .amdhsa_next_free_sgpr 102
  .amdhsa_accum_offset 256
  .amdhsa_group_segment_fixed_size 0
  .amdhsa_kernarg_size 104
  .amdhsa_user_sgpr_count 2
  .amdhsa_user_sgpr_kernarg_segment_ptr 1
  .amdhsa_system_sgpr_workgroup_id_x 1
.end_amdhsa_kernel
```
